```python
import torch

def _softmax(x, axis=-1):
    return torch.softmax(x, dim=axis)
def _gelu(x):
    return torch.nn.functional.gelu(x, approximate="tanh")
def _silu(x):
    return torch.nn.functional.silu(x)
def _sigmoid(x):
    return torch.sigmoid(x)
def _layernorm(x, axis=-1, eps=1e-5):
    m = x.mean(dim=axis, keepdim=True)
    v = x.var(dim=axis, keepdim=True, unbiased=False)
    return (x - m) / torch.sqrt(v + eps)
def _scatter_add(tgt, idx, src, axis=0):
    return tgt.clone().index_add_(axis, idx, src)
def _segment_sum(src, seg, n):
    out = torch.zeros((n,) + src.shape[1:], dtype=src.dtype)
    return out.index_add_(0, seg, src)
def _pad(x, pw):
    flat = tuple(v for pair in reversed(pw) for v in pair)
    return torch.nn.functional.pad(x, flat)

kernel_name = 'gated_mix__sliding_local_dilated__mixer_s_mlp__prompt'

def setup_inputs():

    _w = (lambda a: (lambda t: t.to(torch.bfloat16) if t.is_floating_point() else t)(torch.as_tensor(a)))
    def _A_setup():
        B, S, D = 1, 2048, 576
        return {
            "x": _w((lambda *s: torch.randn(*s, dtype=torch.bfloat16) * 0.05)(B, S, D)),
            "wqkv": _w((lambda *s: torch.randn(*s, dtype=torch.bfloat16) * 1.6)(D, 3 * D)),
            "wo": _w((lambda *s: torch.randn(*s, dtype=torch.bfloat16) * 0.05)(D, D)),
        }
    _A_in = _A_setup()

    def _B_setup():
        B, S, D, F = 1, 2048, 576, 4608
        return {
            "x":  _w((lambda *s: torch.randn(*s, dtype=torch.bfloat16) * 0.05)(B, S, D)),
            "w1": _w((lambda *s: torch.randn(*s, dtype=torch.bfloat16) * 3.2)(D, D) * (D ** -0.5)),
            "w2": _w((lambda *s: torch.randn(*s, dtype=torch.bfloat16) * 3.2)(D, D) * (D ** -0.5)),
            "w3": _w((lambda *s: torch.randn(*s, dtype=torch.bfloat16) * 3.2)(D, F) * (D ** -0.5)),
            "w4": _w((lambda *s: torch.randn(*s, dtype=torch.bfloat16) * 3.2)(F, D) * (F ** -0.5)),
        }
    _B_in = _B_setup()

    return {
        "A_x": _A_in["x"],
        "A_wqkv": _A_in["wqkv"],
        "A_wo": _A_in["wo"],
        "B_x": _B_in["x"],
        "B_w1": _B_in["w1"],
        "B_w2": _B_in["w2"],
        "B_w3": _B_in["w3"],
        "B_w4": _B_in["w4"],
        "gate_w": _w((lambda *s: torch.randn(*s, dtype=torch.bfloat16) * 0.05)(576) * 16.0),
    }

def reference(A_x, A_wqkv, A_wo, B_x, B_w1, B_w2, B_w3, B_w4, gate_w):
    def _A_ref(x, wqkv, wo):
        B, S, D = x.shape
        H = 32; Dh = D // H
        W, dil = 8, 2
        qkv = (lambda x, *d: x.permute(*d))((x @ wqkv).reshape(B, S, 3, H, Dh), 2, 0, 3, 1, 4)
        q, k, v = qkv[0], qkv[1], qkv[2]
        scale = Dh ** -0.5
        pos = torch.arange(S)
        off = torch.arange(W) * dil
        idx = pos[:, None] - off[None, :]
        mask = idx >= 0
        idx_c = torch.where(mask, idx, 0).reshape(-1)
        kg = k[:, :, idx_c, :].reshape(B, H, S, W, Dh)
        vg = v[:, :, idx_c, :].reshape(B, H, S, W, Dh)
        logits = torch.einsum("bhsd,bhswd->bhsw", q, kg) * scale
        logits = torch.where(mask[None, None, :, :], logits, -1e9)
        attn = _softmax(logits, axis=-1)
        o = torch.einsum("bhsw,bhswd->bhsd", attn, vg)
        return (lambda x, *d: x.permute(*d))(o, 0, 2, 1, 3).reshape(B, S, D) @ wo

    def _B_ref(x, w1, w2, w3, w4):
        B, S, D = x.shape
        h = _gelu(_layernorm(x, axis=-1) @ w1)
        c = D // 4
        g0 = _pad(h[:, :, 0*c:1*c], ((0, 0), (1, 0), (0, 0)))[:, :S, :]
        g1 = _pad(h[:, :, 1*c:2*c], ((0, 0), (0, 1), (0, 0)))[:, 1:, :]
        g2 = _pad(h[:, :, 2*c:3*c], ((0, 0), (2, 0), (0, 0)))[:, :S, :]
        g3 = _pad(h[:, :, 3*c:   ], ((0, 0), (0, 2), (0, 0)))[:, 2:, :]
        hs = torch.concatenate([g0, g1, g2, g3], axis=-1) @ w2
        x1 = x + hs
        h2 = _gelu(_layernorm(x1, axis=-1) @ w3) @ w4
        return x1 + h2

    x = A_x
    g = _sigmoid((x * gate_w).sum(-1, keepdims=True))
    a = _A_ref(x, A_wqkv, A_wo)
    b = _B_ref(x, B_w1, B_w2, B_w3, B_w4)
    return g * a + (1 - g) * b
```

```asm
; @launch grid=(256,1,1) block=(256,1,1) lds=163840
.amdgcn_target "amdgcn-amd-amdhsa--gfx950"
.text
.globl gated_mix__sliding_local_dilated__mixer_s_mlp__prompt_kernel
.p2align 8
.type gated_mix__sliding_local_dilated__mixer_s_mlp__prompt_kernel,@function
gated_mix__sliding_local_dilated__mixer_s_mlp__prompt_kernel:

s_cmp_ge_u32 s2, 256
s_cbranch_scc1 L_end
s_load_dwordx2 s[40:41], s[0:1], 0
s_load_dwordx2 s[72:73], s[0:1], 88
s_load_dwordx2 s[44:45], s[0:1], 8
s_load_dwordx2 s[48:49], s[0:1], 32
s_load_dwordx2 s[76:77], s[0:1], 64
s_load_dwordx2 s[52:53], s[0:1], 40
s_load_dwordx2 s[56:57], s[0:1], 48
s_load_dwordx2 s[60:61], s[0:1], 56
s_load_dwordx2 s[64:65], s[0:1], 16
s_load_dwordx2 s[68:69], s[0:1], 72
s_load_dwordx2 s[80:81], s[0:1], 80
s_mov_b32 s42, 2359296
s_mov_b32 s43, 0x20000
s_mov_b32 s46, 1990656
s_mov_b32 s47, 0x20000
s_mov_b32 s50, 663552
s_mov_b32 s51, 0x20000
s_mov_b32 s54, 663552
s_mov_b32 s55, 0x20000
s_mov_b32 s58, 5308416
s_mov_b32 s59, 0x20000
s_mov_b32 s62, 5308416
s_mov_b32 s63, 0x20000
s_mov_b32 s66, 663552
s_mov_b32 s67, 0x20000
s_mov_b32 s70, 2359296
s_mov_b32 s71, 0x20000
s_mov_b32 s74, 4194304
s_mov_b32 s75, 0x20000
s_mov_b32 s78, 1152
s_mov_b32 s79, 0x20000
s_mov_b32 s82, 256
s_mov_b32 s83, 0x20000
v_lshrrev_b32 v1, 6, v0
v_mov_b32 v2, v0
v_readfirstlane_b32 s3, v1
v_and_b32 v0, 63, v0
s_and_b32 s7, s2, 7
s_lshr_b32 s8, s2, 3
s_lshr_b32 s4, s7, 1
s_lshl_b32 s4, s4, 2
s_lshr_b32 s9, s8, 3
s_add_u32 s4, s4, s9
s_and_b32 s7, s7, 1
s_lshl_b32 s5, s7, 3
s_and_b32 s8, s8, 7
s_add_u32 s5, s5, s8
s_lshr_b32 s13, s5, 1
s_and_b32 s14, s13, 1
s_lshr_b32 s15, s5, 2
v_cmp_eq_u32 vcc, 0, v2
v_mov_b32 v3, 1073741824
v_mov_b32 v4, 0
v_cndmask_b32 v253, v3, v4, vcc
s_lshr_b32 s7, s2, 3
s_lshl_b32 s7, s7, 2
s_add_u32 s7, s7, s3
s_mul_i32 s7, s7, 5
v_add_u32 v6, s7, v0
v_lshlrev_b32 v6, 7, v6
v_min_u32 v6, 69376, v6
s_getpc_b64 s[34:35]
L_pc_1:
s_sub_u32 s34, s34, L_pc_1 - gated_mix__sliding_local_dilated__mixer_s_mlp__prompt_kernel
s_subb_u32 s35, s35, 0
v_mov_b32 v7, s35
v_add_co_u32 v6, vcc, s34, v6
s_nop 1
v_addc_co_u32 v7, vcc, 0, v7, vcc
s_mov_b64 exec, 31
global_load_dword v252, v[6:7], off
s_mov_b64 exec, -1
s_bitcmp1_b32 s5, 0
s_cbranch_scc1 L_roleB
s_lshl_b32 s16, s4, 7
s_lshl_b32 s7, s3, 5
s_add_u32 s16, s16, s7
v_bfe_u32 v240, v0, 2, 3
v_lshrrev_b32 v241, 5, v0
v_lshlrev_b32 v241, 6, v241
v_and_b32 v242, 3, v0
s_movk_i32 s12, 1152
v_lshrrev_b32 v243, 2, v240
v_sub_u32 v243, 0, v243
v_and_b32 v243, 3, v243
v_xor_b32 v243, v242, v243
v_lshl_add_u32 v243, v243, 4, v241
v_add_u32 v244, s16, v240
v_mul_lo_u32 v244, v244, s12
v_add_u32 v9, v244, v243
v_lshrrev_b32 v243, 2, v240
v_sub_u32 v243, 2, v243
v_and_b32 v243, 3, v243
v_xor_b32 v243, v242, v243
v_lshl_add_u32 v243, v243, 4, v241
v_add_u32 v244, s16, v240
v_add_u32 v244, 8, v244
v_mul_lo_u32 v244, v244, s12
v_add_u32 v10, v244, v243
v_subrev_u32 v10, 1024, v10
v_lshrrev_b32 v243, 2, v240
v_sub_u32 v243, 0, v243
v_and_b32 v243, 3, v243
v_xor_b32 v243, v242, v243
v_lshl_add_u32 v243, v243, 4, v241
v_add_u32 v244, s16, v240
v_add_u32 v244, 16, v244
v_mul_lo_u32 v244, v244, s12
v_add_u32 v11, v244, v243
v_subrev_u32 v11, 2048, v11
v_lshrrev_b32 v243, 2, v240
v_sub_u32 v243, 2, v243
v_and_b32 v243, 3, v243
v_xor_b32 v243, v242, v243
v_lshl_add_u32 v243, v243, 4, v241
v_add_u32 v244, s16, v240
v_add_u32 v244, 24, v244
v_mul_lo_u32 v244, v244, s12
v_add_u32 v12, v244, v243
v_subrev_u32 v12, 3072, v12
s_lshl_b32 s7, s4, 7
s_sub_u32 s7, s7, 16
s_and_b32 s8, s3, 1
s_lshl_b32 s9, s8, 3
s_add_u32 s7, s7, s9
v_lshrrev_b32 v243, 2, v240
s_lshl_b32 s9, s8, 1
v_sub_u32 v243, s9, v243
v_and_b32 v243, 3, v243
v_xor_b32 v243, v242, v243
v_lshl_add_u32 v243, v243, 4, v241
v_add_u32 v244, s7, v240
v_mul_lo_u32 v244, v244, s12
v_add_u32 v13, v244, v243
s_lshl_b32 s17, s3, 12
s_add_u32 s17, s17, 98304
s_lshl_b32 s98, s8, 10
s_add_u32 s98, s98, 114688
s_lshl_b32 s18, s3, 13
s_waitcnt lgkmcnt(0)
s_lshl_b32 s8, s4, 22
s_add_u32 s72, s72, s8
s_addc_u32 s73, s73, 0
s_load_dword s6, s[72:73], 0
s_add_u32 m0, s17, 0
s_mov_b32 s19, 0
v_lshrrev_b32 v240, 5, v0
buffer_load_dwordx4 v9, s[40:43], s19 offen offset:0 lds
v_and_b32 v241, 31, v0
s_lshr_b32 s7, s3, 1
s_lshl_b32 s7, s7, 5
s_and_b32 s9, s3, 1
s_lshl_b32 s9, s9, 2
buffer_load_dwordx4 v10, s[40:43], s19 offen offset:1024 lds
s_add_u32 s7, s7, s9
s_mul_i32 s10, s13, 144
s_movk_i32 s9, 3456
v_add_u32 v242, s7, v240
v_mul_lo_u32 v242, v242, s9
buffer_load_dwordx4 v11, s[40:43], s19 offen offset:2048 lds
v_add_u32 v242, s10, v242
v_add_u32 v243, 0, v240
v_lshlrev_b32 v243, 1, v243
v_xor_b32 v243, v241, v243
v_min_u32 v243, 26, v243
buffer_load_dwordx4 v12, s[40:43], s19 offen offset:3072 lds
v_mul_u32_u24 v244, 57, v243
v_lshrrev_b32 v244, 9, v244
v_mul_u32_u24 v244, 1008, v244
v_lshl_add_u32 v244, v243, 4, v244
v_add_u32 v244, v242, v244
s_mov_b32 m0, s98
v_add_u32 v1, 0, v244
v_add_u32 v243, 2, v240
v_lshlrev_b32 v243, 1, v243
v_xor_b32 v243, v241, v243
v_min_u32 v243, 26, v243
s_nop 0
buffer_load_dwordx4 v13, s[40:43], s19 offen lds
v_mul_u32_u24 v244, 57, v243
v_lshrrev_b32 v244, 9, v244
v_mul_u32_u24 v244, 1008, v244
v_lshl_add_u32 v244, v243, 4, v244
v_add_u32 v244, v242, v244
v_add_u32 v2, 5888, v244
v_add_u32 v243, 4, v240
v_lshlrev_b32 v243, 1, v243
v_xor_b32 v243, v241, v243
v_min_u32 v243, 26, v243
v_mul_u32_u24 v244, 57, v243
v_lshrrev_b32 v244, 9, v244
v_mul_u32_u24 v244, 1008, v244
v_lshl_add_u32 v244, v243, 4, v244
v_add_u32 v244, v242, v244
v_add_u32 v3, 25600, v244
v_add_u32 v243, 6, v240
v_lshlrev_b32 v243, 1, v243
v_xor_b32 v243, v241, v243
v_min_u32 v243, 26, v243
v_mul_u32_u24 v244, 57, v243
v_lshrrev_b32 v244, 9, v244
v_mul_u32_u24 v244, 1008, v244
v_lshl_add_u32 v244, v243, 4, v244
v_add_u32 v244, v242, v244
v_add_u32 v4, 31488, v244
v_add_u32 v243, 0, v240
v_lshlrev_b32 v243, 1, v243
v_xor_b32 v243, v241, v243
v_min_u32 v243, 26, v243
v_mul_u32_u24 v244, 57, v243
v_lshrrev_b32 v244, 9, v244
v_mul_u32_u24 v244, 1008, v244
v_lshl_add_u32 v244, v243, 4, v244
v_add_u32 v244, v242, v244
v_add_u32 v5, 55296, v244
v_add_u32 v243, 2, v240
v_lshlrev_b32 v243, 1, v243
v_xor_b32 v243, v241, v243
v_min_u32 v243, 26, v243
v_mul_u32_u24 v244, 57, v243
v_lshrrev_b32 v244, 9, v244
v_mul_u32_u24 v244, 1008, v244
v_lshl_add_u32 v244, v243, 4, v244
v_add_u32 v244, v242, v244
v_add_u32 v6, 61184, v244
v_add_u32 v243, 4, v240
v_lshlrev_b32 v243, 1, v243
v_xor_b32 v243, v241, v243
v_min_u32 v243, 26, v243
v_mul_u32_u24 v244, 57, v243
v_lshrrev_b32 v244, 9, v244
v_mul_u32_u24 v244, 1008, v244
v_lshl_add_u32 v244, v243, 4, v244
v_add_u32 v244, v242, v244
v_add_u32 v7, 80896, v244
v_add_u32 v243, 6, v240
v_lshlrev_b32 v243, 1, v243
v_xor_b32 v243, v241, v243
v_min_u32 v243, 26, v243
v_mul_u32_u24 v244, 57, v243
v_lshrrev_b32 v244, 9, v244
v_mul_u32_u24 v244, 1008, v244
v_lshl_add_u32 v244, v243, 4, v244
v_add_u32 v244, v242, v244
v_add_u32 v8, 86784, v244
s_mov_b32 s19, 0
s_add_u32 m0, s18, 0
s_nop 0
buffer_load_dwordx4 v1, s[44:47], s19 offen offset:0 lds
buffer_load_dwordx4 v2, s[44:47], s19 offen offset:1024 lds
buffer_load_dwordx4 v3, s[44:47], s19 offen offset:2048 lds
buffer_load_dwordx4 v4, s[44:47], s19 offen offset:3072 lds
s_add_u32 m0, s18, 4096
s_nop 0
buffer_load_dwordx4 v5, s[44:47], s19 offen offset:0 lds
buffer_load_dwordx4 v6, s[44:47], s19 offen offset:1024 lds
buffer_load_dwordx4 v7, s[44:47], s19 offen offset:2048 lds
buffer_load_dwordx4 v8, s[44:47], s19 offen offset:3072 lds
v_lshlrev_b32 v240, 4, v0
s_mov_b32 m0, 153600
s_nop 0
buffer_load_dwordx4 v240, s[76:79], 0 offen lds
buffer_load_dwordx4 v240, s[76:79], 0 offen offset:1024 lds
s_lshl_b32 s8, s4, 22
s_sub_u32 s76, s72, s8
s_subb_u32 s77, s73, 0
s_mov_b32 s78, 4194304
s_mov_b32 s79, 0x20000
s_waitcnt lgkmcnt(0)
s_mul_i32 s6, s6, 0x9E3779B1
s_add_u32 s6, s6, 0x7F4A7C15
s_or_b32 s7, s4, s5
s_cmp_eq_u32 s7, 0
s_cselect_b32 s7, 4, 1073741824
s_max_u32 s8, s6, 1
v_mov_b32 v240, s8
buffer_store_dword v240, v253, s[80:83], s7 offen sc1
s_lshl_b32 s7, s4, 3
s_add_u32 s7, s7, s13
s_lshl_b32 s7, s7, 2
s_add_u32 s100, s7, s3
s_mul_i32 s7, s100, 31
s_add_u32 s7, s7, 0
v_add_u32 v240, s7, v0
v_lshlrev_b32 v240, 7, v240
v_mov_b32 v241, 1073741824
v_cmp_gt_u32 vcc, 31, v0
s_nop 1
v_cndmask_b32 v240, v241, v240, vcc
buffer_load_dword v252, v240, s[44:47], 0 offen
s_mov_b32 s19, 128
s_add_u32 m0, s17, 18432
s_nop 0
buffer_load_dwordx4 v9, s[40:43], s19 offen offset:0 lds
buffer_load_dwordx4 v10, s[40:43], s19 offen offset:1024 lds
buffer_load_dwordx4 v11, s[40:43], s19 offen offset:2048 lds
buffer_load_dwordx4 v12, s[40:43], s19 offen offset:3072 lds
s_add_u32 m0, s98, 18432
s_nop 0
buffer_load_dwordx4 v13, s[40:43], s19 offen lds
s_mov_b32 s19, 221184
s_add_u32 m0, s18, 32768
s_nop 0
buffer_load_dwordx4 v1, s[44:47], s19 offen offset:0 lds
buffer_load_dwordx4 v2, s[44:47], s19 offen offset:1024 lds
buffer_load_dwordx4 v3, s[44:47], s19 offen offset:2048 lds
buffer_load_dwordx4 v4, s[44:47], s19 offen offset:3072 lds
s_add_u32 m0, s18, 36864
s_nop 0
buffer_load_dwordx4 v5, s[44:47], s19 offen offset:0 lds
buffer_load_dwordx4 v6, s[44:47], s19 offen offset:1024 lds
buffer_load_dwordx4 v7, s[44:47], s19 offen offset:2048 lds
buffer_load_dwordx4 v8, s[44:47], s19 offen offset:3072 lds
v_and_b32 v240, 15, v0
v_lshrrev_b32 v241, 4, v0
v_lshrrev_b32 v243, 2, v240
v_sub_u32 v243, 0, v243
v_and_b32 v243, 3, v243
v_xor_b32 v243, v241, v243
v_lshlrev_b32 v242, 4, v243
v_and_b32 v243, 7, v240
v_lshl_add_u32 v242, v243, 6, v242
v_lshrrev_b32 v243, 3, v240
v_lshl_add_u32 v15, v243, 10, v242
v_add_u32 v14, s17, v15
v_add_u32 v15, 114688, v15
v_lshlrev_b32 v251, 4, v241
v_add_u32 v251, 153600, v251
v_lshrrev_b32 v242, 2, v240
v_lshl_add_u32 v242, v241, 2, v242
v_and_b32 v243, 7, v242
v_lshlrev_b32 v243, 1, v243
v_lshlrev_b32 v242, 9, v242
v_and_b32 v244, 3, v0
v_add_u32 v245, 0, v244
v_lshrrev_b32 v246, 1, v245
v_add_u32 v246, 0, v246
v_xor_b32 v246, v246, v243
v_and_b32 v245, 1, v245
v_lshlrev_b32 v245, 3, v245
v_lshl_add_u32 v245, v246, 4, v245
v_add_u32 v16, v242, v245
v_add_u32 v32, 0x10000, v16
v_add_u32 v245, 0, v244
v_lshrrev_b32 v246, 1, v245
v_add_u32 v246, 9, v246
v_xor_b32 v246, v246, v243
v_and_b32 v245, 1, v245
v_lshlrev_b32 v245, 3, v245
v_lshl_add_u32 v245, v246, 4, v245
v_add_u32 v20, v242, v245
v_add_u32 v36, 0x10000, v20
v_add_u32 v245, 0, v244
v_lshrrev_b32 v246, 1, v245
v_add_u32 v246, 18, v246
v_xor_b32 v246, v246, v243
v_and_b32 v245, 1, v245
v_lshlrev_b32 v245, 3, v245
v_lshl_add_u32 v245, v246, 4, v245
v_add_u32 v25, v242, v245
v_add_u32 v41, 0x10000, v25
v_add_u32 v245, 5, v244
v_lshrrev_b32 v246, 1, v245
v_add_u32 v246, 0, v246
v_xor_b32 v246, v246, v243
v_and_b32 v245, 1, v245
v_lshlrev_b32 v245, 3, v245
v_lshl_add_u32 v245, v246, 4, v245
v_add_u32 v17, v242, v245
v_add_u32 v33, 0x10000, v17
v_add_u32 v245, 5, v244
v_lshrrev_b32 v246, 1, v245
v_add_u32 v246, 9, v246
v_xor_b32 v246, v246, v243
v_and_b32 v245, 1, v245
v_lshlrev_b32 v245, 3, v245
v_lshl_add_u32 v245, v246, 4, v245
v_add_u32 v21, v242, v245
v_add_u32 v37, 0x10000, v21
v_add_u32 v245, 5, v244
v_lshrrev_b32 v246, 1, v245
v_add_u32 v246, 18, v246
v_xor_b32 v246, v246, v243
v_and_b32 v245, 1, v245
v_lshlrev_b32 v245, 3, v245
v_lshl_add_u32 v245, v246, 4, v245
v_add_u32 v26, v242, v245
v_add_u32 v42, 0x10000, v26
v_add_u32 v245, 9, v244
v_lshrrev_b32 v246, 1, v245
v_add_u32 v246, 0, v246
v_xor_b32 v246, v246, v243
v_and_b32 v245, 1, v245
v_lshlrev_b32 v245, 3, v245
v_lshl_add_u32 v245, v246, 4, v245
v_add_u32 v18, v242, v245
v_add_u32 v34, 0x10000, v18
v_add_u32 v245, 9, v244
v_lshrrev_b32 v246, 1, v245
v_add_u32 v246, 9, v246
v_xor_b32 v246, v246, v243
v_and_b32 v245, 1, v245
v_lshlrev_b32 v245, 3, v245
v_lshl_add_u32 v245, v246, 4, v245
v_add_u32 v22, v242, v245
v_add_u32 v38, 0x10000, v22
v_add_u32 v245, 9, v244
v_lshrrev_b32 v246, 1, v245
v_add_u32 v246, 18, v246
v_xor_b32 v246, v246, v243
v_and_b32 v245, 1, v245
v_lshlrev_b32 v245, 3, v245
v_lshl_add_u32 v245, v246, 4, v245
v_add_u32 v27, v242, v245
v_add_u32 v43, 0x10000, v27
v_add_u32 v245, 14, v244
v_lshrrev_b32 v246, 1, v245
v_add_u32 v246, 0, v246
v_xor_b32 v246, v246, v243
v_and_b32 v245, 1, v245
v_lshlrev_b32 v245, 3, v245
v_lshl_add_u32 v245, v246, 4, v245
v_add_u32 v19, v242, v245
v_add_u32 v35, 0x10000, v19
v_add_u32 v245, 14, v244
v_lshrrev_b32 v246, 1, v245
v_add_u32 v246, 9, v246
v_xor_b32 v246, v246, v243
v_and_b32 v245, 1, v245
v_lshlrev_b32 v245, 3, v245
v_lshl_add_u32 v245, v246, 4, v245
v_add_u32 v23, v242, v245
v_add_u32 v39, 0x10000, v23
v_add_u32 v245, 14, v244
v_lshrrev_b32 v246, 1, v245
v_add_u32 v246, 18, v246
v_xor_b32 v246, v246, v243
v_and_b32 v245, 1, v245
v_lshlrev_b32 v245, 3, v245
v_lshl_add_u32 v245, v246, 4, v245
v_add_u32 v28, v242, v245
v_add_u32 v44, 0x10000, v28
v_and_b32 v247, 1, v244
v_mul_u32_u24 v247, 9, v247
v_add_u32 v247, 4, v247
v_lshrrev_b32 v248, 1, v244
v_mul_u32_u24 v248, 9, v248
v_mov_b32 v245, v247
v_lshrrev_b32 v246, 1, v245
v_add_u32 v246, v248, v246
v_xor_b32 v246, v246, v243
v_and_b32 v245, 1, v245
v_lshlrev_b32 v245, 3, v245
v_lshl_add_u32 v245, v246, 4, v245
v_add_u32 v24, v242, v245
v_add_u32 v40, 0x10000, v24
v_mov_b32 v245, v247
v_lshrrev_b32 v246, 1, v245
v_add_u32 v246, 18, v246
v_xor_b32 v246, v246, v243
v_and_b32 v245, 1, v245
v_lshlrev_b32 v245, 3, v245
v_lshl_add_u32 v245, v246, 4, v245
v_add_u32 v29, v242, v245
v_add_u32 v45, 0x10000, v29
s_mul_i32 s7, s3, 5
s_lshr_b32 s8, s3, 1
s_sub_u32 s7, s7, s8
v_add_u32 v245, s7, v244
v_lshrrev_b32 v246, 1, v245
v_add_u32 v246, 9, v246
v_xor_b32 v246, v246, v243
v_and_b32 v245, 1, v245
v_lshlrev_b32 v245, 3, v245
v_lshl_add_u32 v245, v246, 4, v245
v_add_u32 v30, v242, v245
v_add_u32 v46, 0x10000, v30
v_add_u32 v245, s7, v244
v_lshrrev_b32 v246, 1, v245
v_add_u32 v246, 18, v246
v_xor_b32 v246, v246, v243
v_and_b32 v245, 1, v245
v_lshlrev_b32 v245, 3, v245
v_lshl_add_u32 v245, v246, 4, v245
v_add_u32 v31, v242, v245
v_add_u32 v47, 0x10000, v31
s_waitcnt vmcnt(15)
s_barrier
ds_read_b128 v[184:187], v14 offset:0
ds_read_b128 v[188:191], v14 offset:2048
ds_read_b128 v[192:195], v15 offset:0
ds_read_b64_tr_b16 v[208:209], v16 offset:0
ds_read_b64_tr_b16 v[210:211], v16 offset:8192
ds_read_b64_tr_b16 v[212:213], v17 offset:0
ds_read_b64_tr_b16 v[214:215], v17 offset:8192
ds_read_b64_tr_b16 v[216:217], v18 offset:0
ds_read_b64_tr_b16 v[218:219], v18 offset:8192
ds_read_b64_tr_b16 v[220:221], v19 offset:0
ds_read_b64_tr_b16 v[222:223], v19 offset:8192
ds_read_b64_tr_b16 v[224:225], v30 offset:0
ds_read_b64_tr_b16 v[226:227], v30 offset:8192
ds_read_b64_tr_b16 v[228:229], v20 offset:0
ds_read_b64_tr_b16 v[230:231], v20 offset:8192
s_waitcnt lgkmcnt(8)
v_mfma_f32_16x16x32_bf16 v[48:51], v[208:211], v[184:187], 0
ds_read_b64_tr_b16 v[232:233], v21 offset:0
v_mfma_f32_16x16x32_bf16 v[52:55], v[208:211], v[188:191], 0
ds_read_b64_tr_b16 v[234:235], v21 offset:8192
v_mfma_f32_16x16x32_bf16 v[56:59], v[212:215], v[184:187], 0
ds_read_b64_tr_b16 v[236:237], v22 offset:0
v_mfma_f32_16x16x32_bf16 v[60:63], v[212:215], v[188:191], 0
ds_read_b64_tr_b16 v[238:239], v22 offset:8192
s_waitcnt lgkmcnt(8)
v_mfma_f32_16x16x32_bf16 v[64:67], v[216:219], v[184:187], 0
ds_read_b64_tr_b16 v[208:209], v23 offset:0
v_mfma_f32_16x16x32_bf16 v[68:71], v[216:219], v[188:191], 0
ds_read_b64_tr_b16 v[210:211], v23 offset:8192
v_mfma_f32_16x16x32_bf16 v[72:75], v[220:223], v[184:187], 0
ds_read_b64_tr_b16 v[212:213], v31 offset:0
v_mfma_f32_16x16x32_bf16 v[76:79], v[220:223], v[188:191], 0
ds_read_b64_tr_b16 v[214:215], v31 offset:8192
s_waitcnt lgkmcnt(8)
v_mfma_f32_16x16x32_bf16 v[168:171], v[224:227], v[192:195], 0
ds_read_b64_tr_b16 v[216:217], v24 offset:0
ds_read_b64_tr_b16 v[218:219], v24 offset:8192
v_mfma_f32_16x16x32_bf16 v[80:83], v[228:231], v[184:187], 0
ds_read_b64_tr_b16 v[220:221], v25 offset:0
v_mfma_f32_16x16x32_bf16 v[84:87], v[228:231], v[188:191], 0
ds_read_b64_tr_b16 v[222:223], v25 offset:8192
s_waitcnt lgkmcnt(8)
v_mfma_f32_16x16x32_bf16 v[88:91], v[232:235], v[184:187], 0
ds_read_b64_tr_b16 v[224:225], v26 offset:0
v_mfma_f32_16x16x32_bf16 v[92:95], v[232:235], v[188:191], 0
ds_read_b64_tr_b16 v[226:227], v26 offset:8192
v_mfma_f32_16x16x32_bf16 v[96:99], v[236:239], v[184:187], 0
ds_read_b64_tr_b16 v[228:229], v27 offset:0
v_mfma_f32_16x16x32_bf16 v[100:103], v[236:239], v[188:191], 0
ds_read_b64_tr_b16 v[230:231], v27 offset:8192
s_waitcnt lgkmcnt(8)
v_mfma_f32_16x16x32_bf16 v[104:107], v[208:211], v[184:187], 0
ds_read_b64_tr_b16 v[232:233], v28 offset:0
v_mfma_f32_16x16x32_bf16 v[108:111], v[208:211], v[188:191], 0
ds_read_b64_tr_b16 v[234:235], v28 offset:8192
v_mfma_f32_16x16x32_bf16 v[172:175], v[192:195], v[212:215], 0
ds_read_b64_tr_b16 v[236:237], v29 offset:0
ds_read_b64_tr_b16 v[238:239], v29 offset:8192
s_waitcnt lgkmcnt(8)
v_mfma_f32_16x16x32_bf16 v[112:115], v[216:219], v[184:187], 0
ds_read_b128 v[208:211], v251 offset:0
v_mfma_f32_16x16x32_bf16 v[116:119], v[216:219], v[188:191], 0
v_mfma_f32_16x16x32_bf16 v[176:179], v[216:219], v[192:195], 0
v_mfma_f32_16x16x32_bf16 v[120:123], v[184:187], v[220:223], 0
ds_read_b128 v[196:199], v14 offset:512
v_mfma_f32_16x16x32_bf16 v[124:127], v[188:191], v[220:223], 0
ds_read_b128 v[200:203], v14 offset:2560
ds_read_b128 v[204:207], v15 offset:512
ds_read_b64_tr_b16 v[212:213], v16 offset:16384
ds_read_b64_tr_b16 v[214:215], v16 offset:24576
s_waitcnt lgkmcnt(10)
v_mfma_f32_16x16x32_bf16 v[128:131], v[184:187], v[224:227], 0
ds_read_b64_tr_b16 v[216:217], v17 offset:16384
v_mfma_f32_16x16x32_bf16 v[132:135], v[188:191], v[224:227], 0
ds_read_b64_tr_b16 v[218:219], v17 offset:24576
v_mfma_f32_16x16x32_bf16 v[136:139], v[184:187], v[228:231], 0
ds_read_b64_tr_b16 v[220:221], v18 offset:16384
v_mfma_f32_16x16x32_bf16 v[140:143], v[188:191], v[228:231], 0
ds_read_b64_tr_b16 v[222:223], v18 offset:24576
s_mov_b32 s19, 256
s_add_u32 m0, s17, 36864
s_waitcnt lgkmcnt(10)
v_mfma_f32_16x16x32_bf16 v[144:147], v[184:187], v[232:235], 0
ds_read_b64_tr_b16 v[224:225], v19 offset:16384
v_mfma_f32_16x16x32_bf16 v[148:151], v[188:191], v[232:235], 0
ds_read_b64_tr_b16 v[226:227], v19 offset:24576
buffer_load_dwordx4 v9, s[40:43], s19 offen offset:0 lds
v_mfma_f32_16x16x32_bf16 v[152:155], v[184:187], v[236:239], 0
ds_read_b64_tr_b16 v[228:229], v30 offset:16384
v_mfma_f32_16x16x32_bf16 v[156:159], v[188:191], v[236:239], 0
ds_read_b64_tr_b16 v[230:231], v30 offset:24576
v_mfma_f32_16x16x32_bf16 v[180:183], v[192:195], v[236:239], 0
buffer_load_dwordx4 v10, s[40:43], s19 offen offset:1024 lds
s_waitcnt lgkmcnt(8)
v_mfma_f32_16x16x32_bf16 v[160:163], v[208:211], v[184:187], 0
ds_read_b64_tr_b16 v[232:233], v20 offset:16384
v_mfma_f32_16x16x32_bf16 v[164:167], v[208:211], v[188:191], 0
ds_read_b64_tr_b16 v[234:235], v20 offset:24576
buffer_load_dwordx4 v11, s[40:43], s19 offen offset:2048 lds
v_mfma_f32_16x16x32_bf16 v[48:51], v[212:215], v[196:199], v[48:51]
ds_read_b64_tr_b16 v[236:237], v21 offset:16384
v_mfma_f32_16x16x32_bf16 v[52:55], v[212:215], v[200:203], v[52:55]
ds_read_b64_tr_b16 v[238:239], v21 offset:24576
buffer_load_dwordx4 v12, s[40:43], s19 offen offset:3072 lds
s_waitcnt lgkmcnt(8)
v_mfma_f32_16x16x32_bf16 v[56:59], v[216:219], v[196:199], v[56:59]
ds_read_b64_tr_b16 v[208:209], v22 offset:16384
v_mfma_f32_16x16x32_bf16 v[60:63], v[216:219], v[200:203], v[60:63]
ds_read_b64_tr_b16 v[210:211], v22 offset:24576
s_add_u32 m0, s98, 36864
v_mfma_f32_16x16x32_bf16 v[64:67], v[220:223], v[196:199], v[64:67]
ds_read_b64_tr_b16 v[212:213], v23 offset:16384
v_mfma_f32_16x16x32_bf16 v[68:71], v[220:223], v[200:203], v[68:71]
ds_read_b64_tr_b16 v[214:215], v23 offset:24576
buffer_load_dwordx4 v13, s[40:43], s19 offen lds
s_waitcnt lgkmcnt(8)
v_mfma_f32_16x16x32_bf16 v[72:75], v[224:227], v[196:199], v[72:75]
ds_read_b64_tr_b16 v[216:217], v31 offset:16384
v_mfma_f32_16x16x32_bf16 v[76:79], v[224:227], v[200:203], v[76:79]
ds_read_b64_tr_b16 v[218:219], v31 offset:24576
v_mfma_f32_16x16x32_bf16 v[168:171], v[228:231], v[204:207], v[168:171]
ds_read_b64_tr_b16 v[220:221], v24 offset:16384
ds_read_b64_tr_b16 v[222:223], v24 offset:24576
s_mov_b32 s19, 442368
s_add_u32 m0, s18, 65536
s_waitcnt lgkmcnt(8)
v_mfma_f32_16x16x32_bf16 v[80:83], v[232:235], v[196:199], v[80:83]
ds_read_b64_tr_b16 v[224:225], v25 offset:16384
v_mfma_f32_16x16x32_bf16 v[84:87], v[232:235], v[200:203], v[84:87]
ds_read_b64_tr_b16 v[226:227], v25 offset:24576
buffer_load_dwordx4 v1, s[44:47], s19 offen offset:0 lds
v_mfma_f32_16x16x32_bf16 v[88:91], v[236:239], v[196:199], v[88:91]
ds_read_b64_tr_b16 v[228:229], v26 offset:16384
v_mfma_f32_16x16x32_bf16 v[92:95], v[236:239], v[200:203], v[92:95]
ds_read_b64_tr_b16 v[230:231], v26 offset:24576
buffer_load_dwordx4 v2, s[44:47], s19 offen offset:1024 lds
s_waitcnt lgkmcnt(8)
v_mfma_f32_16x16x32_bf16 v[96:99], v[208:211], v[196:199], v[96:99]
ds_read_b64_tr_b16 v[232:233], v27 offset:16384
v_mfma_f32_16x16x32_bf16 v[100:103], v[208:211], v[200:203], v[100:103]
ds_read_b64_tr_b16 v[234:235], v27 offset:24576
buffer_load_dwordx4 v3, s[44:47], s19 offen offset:2048 lds
v_mfma_f32_16x16x32_bf16 v[104:107], v[212:215], v[196:199], v[104:107]
ds_read_b64_tr_b16 v[236:237], v28 offset:16384
v_mfma_f32_16x16x32_bf16 v[108:111], v[212:215], v[200:203], v[108:111]
ds_read_b64_tr_b16 v[238:239], v28 offset:24576
buffer_load_dwordx4 v4, s[44:47], s19 offen offset:3072 lds
s_waitcnt lgkmcnt(8)
v_mfma_f32_16x16x32_bf16 v[172:175], v[204:207], v[216:219], v[172:175]
ds_read_b64_tr_b16 v[208:209], v29 offset:16384
ds_read_b64_tr_b16 v[210:211], v29 offset:24576
s_add_u32 m0, s18, 69632
v_mfma_f32_16x16x32_bf16 v[112:115], v[220:223], v[196:199], v[112:115]
ds_read_b128 v[212:215], v251 offset:64
v_mfma_f32_16x16x32_bf16 v[116:119], v[220:223], v[200:203], v[116:119]
v_mfma_f32_16x16x32_bf16 v[176:179], v[220:223], v[204:207], v[176:179]
buffer_load_dwordx4 v5, s[44:47], s19 offen offset:0 lds
s_waitcnt lgkmcnt(7)
v_mfma_f32_16x16x32_bf16 v[120:123], v[196:199], v[224:227], v[120:123]
s_waitcnt vmcnt(10)
s_barrier
ds_read_b128 v[184:187], v14 offset:18432
v_mfma_f32_16x16x32_bf16 v[124:127], v[200:203], v[224:227], v[124:127]
ds_read_b128 v[188:191], v14 offset:20480
ds_read_b128 v[192:195], v15 offset:18432
ds_read_b64_tr_b16 v[216:217], v16 offset:32768
ds_read_b64_tr_b16 v[218:219], v16 offset:40960
buffer_load_dwordx4 v6, s[44:47], s19 offen offset:1024 lds
v_mfma_f32_16x16x32_bf16 v[128:131], v[196:199], v[228:231], v[128:131]
ds_read_b64_tr_b16 v[220:221], v17 offset:32768
v_mfma_f32_16x16x32_bf16 v[132:135], v[200:203], v[228:231], v[132:135]
ds_read_b64_tr_b16 v[222:223], v17 offset:40960
buffer_load_dwordx4 v7, s[44:47], s19 offen offset:2048 lds
buffer_load_dwordx4 v8, s[44:47], s19 offen offset:3072 lds
s_waitcnt lgkmcnt(10)
v_mfma_f32_16x16x32_bf16 v[136:139], v[196:199], v[232:235], v[136:139]
ds_read_b64_tr_b16 v[224:225], v18 offset:32768
v_mfma_f32_16x16x32_bf16 v[140:143], v[200:203], v[232:235], v[140:143]
ds_read_b64_tr_b16 v[226:227], v18 offset:40960
v_mfma_f32_16x16x32_bf16 v[144:147], v[196:199], v[236:239], v[144:147]
ds_read_b64_tr_b16 v[228:229], v19 offset:32768
v_mfma_f32_16x16x32_bf16 v[148:151], v[200:203], v[236:239], v[148:151]
ds_read_b64_tr_b16 v[230:231], v19 offset:40960
s_waitcnt lgkmcnt(11)
v_mfma_f32_16x16x32_bf16 v[152:155], v[196:199], v[208:211], v[152:155]
ds_read_b64_tr_b16 v[232:233], v30 offset:32768
v_mfma_f32_16x16x32_bf16 v[156:159], v[200:203], v[208:211], v[156:159]
ds_read_b64_tr_b16 v[234:235], v30 offset:40960
v_mfma_f32_16x16x32_bf16 v[180:183], v[204:207], v[208:211], v[180:183]
v_mfma_f32_16x16x32_bf16 v[160:163], v[212:215], v[196:199], v[160:163]
ds_read_b64_tr_b16 v[236:237], v20 offset:32768
v_mfma_f32_16x16x32_bf16 v[164:167], v[212:215], v[200:203], v[164:167]
ds_read_b64_tr_b16 v[238:239], v20 offset:40960
s_waitcnt lgkmcnt(8)
v_mfma_f32_16x16x32_bf16 v[48:51], v[216:219], v[184:187], v[48:51]
ds_read_b64_tr_b16 v[208:209], v21 offset:32768
v_mfma_f32_16x16x32_bf16 v[52:55], v[216:219], v[188:191], v[52:55]
ds_read_b64_tr_b16 v[210:211], v21 offset:40960
v_mfma_f32_16x16x32_bf16 v[56:59], v[220:223], v[184:187], v[56:59]
ds_read_b64_tr_b16 v[212:213], v22 offset:32768
v_mfma_f32_16x16x32_bf16 v[60:63], v[220:223], v[188:191], v[60:63]
ds_read_b64_tr_b16 v[214:215], v22 offset:40960
s_barrier
s_waitcnt lgkmcnt(8)
v_mfma_f32_16x16x32_bf16 v[64:67], v[224:227], v[184:187], v[64:67]
ds_read_b64_tr_b16 v[216:217], v23 offset:32768
v_mfma_f32_16x16x32_bf16 v[68:71], v[224:227], v[188:191], v[68:71]
ds_read_b64_tr_b16 v[218:219], v23 offset:40960
v_mfma_f32_16x16x32_bf16 v[72:75], v[228:231], v[184:187], v[72:75]
ds_read_b64_tr_b16 v[220:221], v31 offset:32768
v_mfma_f32_16x16x32_bf16 v[76:79], v[228:231], v[188:191], v[76:79]
ds_read_b64_tr_b16 v[222:223], v31 offset:40960
s_waitcnt lgkmcnt(8)
v_mfma_f32_16x16x32_bf16 v[168:171], v[232:235], v[192:195], v[168:171]
ds_read_b64_tr_b16 v[224:225], v24 offset:32768
ds_read_b64_tr_b16 v[226:227], v24 offset:40960
v_mfma_f32_16x16x32_bf16 v[80:83], v[236:239], v[184:187], v[80:83]
ds_read_b64_tr_b16 v[228:229], v25 offset:32768
v_mfma_f32_16x16x32_bf16 v[84:87], v[236:239], v[188:191], v[84:87]
ds_read_b64_tr_b16 v[230:231], v25 offset:40960
s_waitcnt lgkmcnt(8)
v_mfma_f32_16x16x32_bf16 v[88:91], v[208:211], v[184:187], v[88:91]
ds_read_b64_tr_b16 v[232:233], v26 offset:32768
v_mfma_f32_16x16x32_bf16 v[92:95], v[208:211], v[188:191], v[92:95]
ds_read_b64_tr_b16 v[234:235], v26 offset:40960
v_mfma_f32_16x16x32_bf16 v[96:99], v[212:215], v[184:187], v[96:99]
ds_read_b64_tr_b16 v[236:237], v27 offset:32768
v_mfma_f32_16x16x32_bf16 v[100:103], v[212:215], v[188:191], v[100:103]
ds_read_b64_tr_b16 v[238:239], v27 offset:40960
s_waitcnt lgkmcnt(8)
v_mfma_f32_16x16x32_bf16 v[104:107], v[216:219], v[184:187], v[104:107]
ds_read_b64_tr_b16 v[208:209], v28 offset:32768
v_mfma_f32_16x16x32_bf16 v[108:111], v[216:219], v[188:191], v[108:111]
ds_read_b64_tr_b16 v[210:211], v28 offset:40960
v_mfma_f32_16x16x32_bf16 v[172:175], v[192:195], v[220:223], v[172:175]
ds_read_b64_tr_b16 v[212:213], v29 offset:32768
ds_read_b64_tr_b16 v[214:215], v29 offset:40960
s_waitcnt lgkmcnt(8)
v_mfma_f32_16x16x32_bf16 v[112:115], v[224:227], v[184:187], v[112:115]
ds_read_b128 v[216:219], v251 offset:128
v_mfma_f32_16x16x32_bf16 v[116:119], v[224:227], v[188:191], v[116:119]
v_mfma_f32_16x16x32_bf16 v[176:179], v[224:227], v[192:195], v[176:179]
v_mfma_f32_16x16x32_bf16 v[120:123], v[184:187], v[228:231], v[120:123]
ds_read_b128 v[196:199], v14 offset:18944
v_mfma_f32_16x16x32_bf16 v[124:127], v[188:191], v[228:231], v[124:127]
ds_read_b128 v[200:203], v14 offset:20992
ds_read_b128 v[204:207], v15 offset:18944
ds_read_b64_tr_b16 v[220:221], v16 offset:49152
ds_read_b64_tr_b16 v[222:223], v16 offset:57344
s_waitcnt lgkmcnt(10)
v_mfma_f32_16x16x32_bf16 v[128:131], v[184:187], v[232:235], v[128:131]
ds_read_b64_tr_b16 v[224:225], v17 offset:49152
v_mfma_f32_16x16x32_bf16 v[132:135], v[188:191], v[232:235], v[132:135]
ds_read_b64_tr_b16 v[226:227], v17 offset:57344
v_mfma_f32_16x16x32_bf16 v[136:139], v[184:187], v[236:239], v[136:139]
ds_read_b64_tr_b16 v[228:229], v18 offset:49152
v_mfma_f32_16x16x32_bf16 v[140:143], v[188:191], v[236:239], v[140:143]
ds_read_b64_tr_b16 v[230:231], v18 offset:57344
s_mov_b32 s19, 384
s_add_u32 m0, s17, 0
s_waitcnt lgkmcnt(10)
v_mfma_f32_16x16x32_bf16 v[144:147], v[184:187], v[208:211], v[144:147]
ds_read_b64_tr_b16 v[232:233], v19 offset:49152
v_mfma_f32_16x16x32_bf16 v[148:151], v[188:191], v[208:211], v[148:151]
ds_read_b64_tr_b16 v[234:235], v19 offset:57344
buffer_load_dwordx4 v9, s[40:43], s19 offen offset:0 lds
v_mfma_f32_16x16x32_bf16 v[152:155], v[184:187], v[212:215], v[152:155]
ds_read_b64_tr_b16 v[236:237], v30 offset:49152
v_mfma_f32_16x16x32_bf16 v[156:159], v[188:191], v[212:215], v[156:159]
ds_read_b64_tr_b16 v[238:239], v30 offset:57344
v_mfma_f32_16x16x32_bf16 v[180:183], v[192:195], v[212:215], v[180:183]
buffer_load_dwordx4 v10, s[40:43], s19 offen offset:1024 lds
s_waitcnt lgkmcnt(8)
v_mfma_f32_16x16x32_bf16 v[160:163], v[216:219], v[184:187], v[160:163]
ds_read_b64_tr_b16 v[208:209], v20 offset:49152
v_mfma_f32_16x16x32_bf16 v[164:167], v[216:219], v[188:191], v[164:167]
ds_read_b64_tr_b16 v[210:211], v20 offset:57344
buffer_load_dwordx4 v11, s[40:43], s19 offen offset:2048 lds
v_mfma_f32_16x16x32_bf16 v[48:51], v[220:223], v[196:199], v[48:51]
ds_read_b64_tr_b16 v[212:213], v21 offset:49152
v_mfma_f32_16x16x32_bf16 v[52:55], v[220:223], v[200:203], v[52:55]
ds_read_b64_tr_b16 v[214:215], v21 offset:57344
buffer_load_dwordx4 v12, s[40:43], s19 offen offset:3072 lds
s_waitcnt lgkmcnt(8)
v_mfma_f32_16x16x32_bf16 v[56:59], v[224:227], v[196:199], v[56:59]
ds_read_b64_tr_b16 v[216:217], v22 offset:49152
v_mfma_f32_16x16x32_bf16 v[60:63], v[224:227], v[200:203], v[60:63]
ds_read_b64_tr_b16 v[218:219], v22 offset:57344
s_add_u32 m0, s98, 0
v_mfma_f32_16x16x32_bf16 v[64:67], v[228:231], v[196:199], v[64:67]
ds_read_b64_tr_b16 v[220:221], v23 offset:49152
v_mfma_f32_16x16x32_bf16 v[68:71], v[228:231], v[200:203], v[68:71]
ds_read_b64_tr_b16 v[222:223], v23 offset:57344
buffer_load_dwordx4 v13, s[40:43], s19 offen lds
s_waitcnt lgkmcnt(8)
v_mfma_f32_16x16x32_bf16 v[72:75], v[232:235], v[196:199], v[72:75]
ds_read_b64_tr_b16 v[224:225], v31 offset:49152
v_mfma_f32_16x16x32_bf16 v[76:79], v[232:235], v[200:203], v[76:79]
ds_read_b64_tr_b16 v[226:227], v31 offset:57344
v_mfma_f32_16x16x32_bf16 v[168:171], v[236:239], v[204:207], v[168:171]
ds_read_b64_tr_b16 v[228:229], v24 offset:49152
ds_read_b64_tr_b16 v[230:231], v24 offset:57344
s_mov_b32 s19, 663552
s_add_u32 m0, s18, 0
s_waitcnt lgkmcnt(8)
v_mfma_f32_16x16x32_bf16 v[80:83], v[208:211], v[196:199], v[80:83]
ds_read_b64_tr_b16 v[232:233], v25 offset:49152
v_mfma_f32_16x16x32_bf16 v[84:87], v[208:211], v[200:203], v[84:87]
ds_read_b64_tr_b16 v[234:235], v25 offset:57344
buffer_load_dwordx4 v1, s[44:47], s19 offen offset:0 lds
v_mfma_f32_16x16x32_bf16 v[88:91], v[212:215], v[196:199], v[88:91]
ds_read_b64_tr_b16 v[236:237], v26 offset:49152
v_mfma_f32_16x16x32_bf16 v[92:95], v[212:215], v[200:203], v[92:95]
ds_read_b64_tr_b16 v[238:239], v26 offset:57344
buffer_load_dwordx4 v2, s[44:47], s19 offen offset:1024 lds
s_waitcnt lgkmcnt(8)
v_mfma_f32_16x16x32_bf16 v[96:99], v[216:219], v[196:199], v[96:99]
ds_read_b64_tr_b16 v[208:209], v27 offset:49152
v_mfma_f32_16x16x32_bf16 v[100:103], v[216:219], v[200:203], v[100:103]
ds_read_b64_tr_b16 v[210:211], v27 offset:57344
buffer_load_dwordx4 v3, s[44:47], s19 offen offset:2048 lds
v_mfma_f32_16x16x32_bf16 v[104:107], v[220:223], v[196:199], v[104:107]
ds_read_b64_tr_b16 v[212:213], v28 offset:49152
v_mfma_f32_16x16x32_bf16 v[108:111], v[220:223], v[200:203], v[108:111]
ds_read_b64_tr_b16 v[214:215], v28 offset:57344
buffer_load_dwordx4 v4, s[44:47], s19 offen offset:3072 lds
s_waitcnt lgkmcnt(8)
v_mfma_f32_16x16x32_bf16 v[172:175], v[204:207], v[224:227], v[172:175]
ds_read_b64_tr_b16 v[216:217], v29 offset:49152
ds_read_b64_tr_b16 v[218:219], v29 offset:57344
s_add_u32 m0, s18, 4096
v_mfma_f32_16x16x32_bf16 v[112:115], v[228:231], v[196:199], v[112:115]
ds_read_b128 v[220:223], v251 offset:192
v_mfma_f32_16x16x32_bf16 v[116:119], v[228:231], v[200:203], v[116:119]
v_mfma_f32_16x16x32_bf16 v[176:179], v[228:231], v[204:207], v[176:179]
buffer_load_dwordx4 v5, s[44:47], s19 offen offset:0 lds
s_waitcnt lgkmcnt(7)
v_mfma_f32_16x16x32_bf16 v[120:123], v[196:199], v[232:235], v[120:123]
s_waitcnt vmcnt(10)
s_barrier
ds_read_b128 v[184:187], v14 offset:36864
v_mfma_f32_16x16x32_bf16 v[124:127], v[200:203], v[232:235], v[124:127]
ds_read_b128 v[188:191], v14 offset:38912
ds_read_b128 v[192:195], v15 offset:36864
ds_read_b64_tr_b16 v[224:225], v32 offset:0
ds_read_b64_tr_b16 v[226:227], v32 offset:8192
buffer_load_dwordx4 v6, s[44:47], s19 offen offset:1024 lds
v_mfma_f32_16x16x32_bf16 v[128:131], v[196:199], v[236:239], v[128:131]
ds_read_b64_tr_b16 v[228:229], v33 offset:0
v_mfma_f32_16x16x32_bf16 v[132:135], v[200:203], v[236:239], v[132:135]
ds_read_b64_tr_b16 v[230:231], v33 offset:8192
buffer_load_dwordx4 v7, s[44:47], s19 offen offset:2048 lds
buffer_load_dwordx4 v8, s[44:47], s19 offen offset:3072 lds
s_waitcnt lgkmcnt(10)
v_mfma_f32_16x16x32_bf16 v[136:139], v[196:199], v[208:211], v[136:139]
ds_read_b64_tr_b16 v[232:233], v34 offset:0
v_mfma_f32_16x16x32_bf16 v[140:143], v[200:203], v[208:211], v[140:143]
ds_read_b64_tr_b16 v[234:235], v34 offset:8192
v_mfma_f32_16x16x32_bf16 v[144:147], v[196:199], v[212:215], v[144:147]
ds_read_b64_tr_b16 v[236:237], v35 offset:0
v_mfma_f32_16x16x32_bf16 v[148:151], v[200:203], v[212:215], v[148:151]
ds_read_b64_tr_b16 v[238:239], v35 offset:8192
s_waitcnt lgkmcnt(11)
v_mfma_f32_16x16x32_bf16 v[152:155], v[196:199], v[216:219], v[152:155]
ds_read_b64_tr_b16 v[208:209], v46 offset:0
v_mfma_f32_16x16x32_bf16 v[156:159], v[200:203], v[216:219], v[156:159]
ds_read_b64_tr_b16 v[210:211], v46 offset:8192
v_mfma_f32_16x16x32_bf16 v[180:183], v[204:207], v[216:219], v[180:183]
v_mfma_f32_16x16x32_bf16 v[160:163], v[220:223], v[196:199], v[160:163]
ds_read_b64_tr_b16 v[212:213], v36 offset:0
v_mfma_f32_16x16x32_bf16 v[164:167], v[220:223], v[200:203], v[164:167]
ds_read_b64_tr_b16 v[214:215], v36 offset:8192
s_waitcnt lgkmcnt(8)
v_mfma_f32_16x16x32_bf16 v[48:51], v[224:227], v[184:187], v[48:51]
ds_read_b64_tr_b16 v[216:217], v37 offset:0
v_mfma_f32_16x16x32_bf16 v[52:55], v[224:227], v[188:191], v[52:55]
ds_read_b64_tr_b16 v[218:219], v37 offset:8192
v_mfma_f32_16x16x32_bf16 v[56:59], v[228:231], v[184:187], v[56:59]
ds_read_b64_tr_b16 v[220:221], v38 offset:0
v_mfma_f32_16x16x32_bf16 v[60:63], v[228:231], v[188:191], v[60:63]
ds_read_b64_tr_b16 v[222:223], v38 offset:8192
s_barrier
s_waitcnt lgkmcnt(8)
v_mfma_f32_16x16x32_bf16 v[64:67], v[232:235], v[184:187], v[64:67]
ds_read_b64_tr_b16 v[224:225], v39 offset:0
v_mfma_f32_16x16x32_bf16 v[68:71], v[232:235], v[188:191], v[68:71]
ds_read_b64_tr_b16 v[226:227], v39 offset:8192
v_mfma_f32_16x16x32_bf16 v[72:75], v[236:239], v[184:187], v[72:75]
ds_read_b64_tr_b16 v[228:229], v47 offset:0
v_mfma_f32_16x16x32_bf16 v[76:79], v[236:239], v[188:191], v[76:79]
ds_read_b64_tr_b16 v[230:231], v47 offset:8192
s_waitcnt lgkmcnt(8)
v_mfma_f32_16x16x32_bf16 v[168:171], v[208:211], v[192:195], v[168:171]
ds_read_b64_tr_b16 v[232:233], v40 offset:0
ds_read_b64_tr_b16 v[234:235], v40 offset:8192
v_mfma_f32_16x16x32_bf16 v[80:83], v[212:215], v[184:187], v[80:83]
ds_read_b64_tr_b16 v[236:237], v41 offset:0
v_mfma_f32_16x16x32_bf16 v[84:87], v[212:215], v[188:191], v[84:87]
ds_read_b64_tr_b16 v[238:239], v41 offset:8192
s_waitcnt lgkmcnt(8)
v_mfma_f32_16x16x32_bf16 v[88:91], v[216:219], v[184:187], v[88:91]
ds_read_b64_tr_b16 v[208:209], v42 offset:0
v_mfma_f32_16x16x32_bf16 v[92:95], v[216:219], v[188:191], v[92:95]
ds_read_b64_tr_b16 v[210:211], v42 offset:8192
v_mfma_f32_16x16x32_bf16 v[96:99], v[220:223], v[184:187], v[96:99]
ds_read_b64_tr_b16 v[212:213], v43 offset:0
v_mfma_f32_16x16x32_bf16 v[100:103], v[220:223], v[188:191], v[100:103]
ds_read_b64_tr_b16 v[214:215], v43 offset:8192
s_waitcnt lgkmcnt(8)
v_mfma_f32_16x16x32_bf16 v[104:107], v[224:227], v[184:187], v[104:107]
ds_read_b64_tr_b16 v[216:217], v44 offset:0
v_mfma_f32_16x16x32_bf16 v[108:111], v[224:227], v[188:191], v[108:111]
ds_read_b64_tr_b16 v[218:219], v44 offset:8192
v_mfma_f32_16x16x32_bf16 v[172:175], v[192:195], v[228:231], v[172:175]
ds_read_b64_tr_b16 v[220:221], v45 offset:0
ds_read_b64_tr_b16 v[222:223], v45 offset:8192
s_waitcnt lgkmcnt(8)
v_mfma_f32_16x16x32_bf16 v[112:115], v[232:235], v[184:187], v[112:115]
ds_read_b128 v[224:227], v251 offset:256
v_mfma_f32_16x16x32_bf16 v[116:119], v[232:235], v[188:191], v[116:119]
v_mfma_f32_16x16x32_bf16 v[176:179], v[232:235], v[192:195], v[176:179]
v_mfma_f32_16x16x32_bf16 v[120:123], v[184:187], v[236:239], v[120:123]
ds_read_b128 v[196:199], v14 offset:37376
v_mfma_f32_16x16x32_bf16 v[124:127], v[188:191], v[236:239], v[124:127]
ds_read_b128 v[200:203], v14 offset:39424
ds_read_b128 v[204:207], v15 offset:37376
ds_read_b64_tr_b16 v[228:229], v32 offset:16384
ds_read_b64_tr_b16 v[230:231], v32 offset:24576
s_waitcnt lgkmcnt(10)
v_mfma_f32_16x16x32_bf16 v[128:131], v[184:187], v[208:211], v[128:131]
ds_read_b64_tr_b16 v[232:233], v33 offset:16384
v_mfma_f32_16x16x32_bf16 v[132:135], v[188:191], v[208:211], v[132:135]
ds_read_b64_tr_b16 v[234:235], v33 offset:24576
v_mfma_f32_16x16x32_bf16 v[136:139], v[184:187], v[212:215], v[136:139]
ds_read_b64_tr_b16 v[236:237], v34 offset:16384
v_mfma_f32_16x16x32_bf16 v[140:143], v[188:191], v[212:215], v[140:143]
ds_read_b64_tr_b16 v[238:239], v34 offset:24576
s_mov_b32 s19, 512
s_add_u32 m0, s17, 18432
s_waitcnt lgkmcnt(10)
v_mfma_f32_16x16x32_bf16 v[144:147], v[184:187], v[216:219], v[144:147]
ds_read_b64_tr_b16 v[208:209], v35 offset:16384
v_mfma_f32_16x16x32_bf16 v[148:151], v[188:191], v[216:219], v[148:151]
ds_read_b64_tr_b16 v[210:211], v35 offset:24576
buffer_load_dwordx4 v9, s[40:43], s19 offen offset:0 lds
v_mfma_f32_16x16x32_bf16 v[152:155], v[184:187], v[220:223], v[152:155]
ds_read_b64_tr_b16 v[212:213], v46 offset:16384
v_mfma_f32_16x16x32_bf16 v[156:159], v[188:191], v[220:223], v[156:159]
ds_read_b64_tr_b16 v[214:215], v46 offset:24576
v_mfma_f32_16x16x32_bf16 v[180:183], v[192:195], v[220:223], v[180:183]
buffer_load_dwordx4 v10, s[40:43], s19 offen offset:1024 lds
s_waitcnt lgkmcnt(8)
v_mfma_f32_16x16x32_bf16 v[160:163], v[224:227], v[184:187], v[160:163]
ds_read_b64_tr_b16 v[216:217], v36 offset:16384
v_mfma_f32_16x16x32_bf16 v[164:167], v[224:227], v[188:191], v[164:167]
ds_read_b64_tr_b16 v[218:219], v36 offset:24576
buffer_load_dwordx4 v11, s[40:43], s19 offen offset:2048 lds
v_mfma_f32_16x16x32_bf16 v[48:51], v[228:231], v[196:199], v[48:51]
ds_read_b64_tr_b16 v[220:221], v37 offset:16384
v_mfma_f32_16x16x32_bf16 v[52:55], v[228:231], v[200:203], v[52:55]
ds_read_b64_tr_b16 v[222:223], v37 offset:24576
buffer_load_dwordx4 v12, s[40:43], s19 offen offset:3072 lds
s_waitcnt lgkmcnt(8)
v_mfma_f32_16x16x32_bf16 v[56:59], v[232:235], v[196:199], v[56:59]
ds_read_b64_tr_b16 v[224:225], v38 offset:16384
v_mfma_f32_16x16x32_bf16 v[60:63], v[232:235], v[200:203], v[60:63]
ds_read_b64_tr_b16 v[226:227], v38 offset:24576
s_add_u32 m0, s98, 18432
v_mfma_f32_16x16x32_bf16 v[64:67], v[236:239], v[196:199], v[64:67]
ds_read_b64_tr_b16 v[228:229], v39 offset:16384
v_mfma_f32_16x16x32_bf16 v[68:71], v[236:239], v[200:203], v[68:71]
ds_read_b64_tr_b16 v[230:231], v39 offset:24576
buffer_load_dwordx4 v13, s[40:43], s19 offen lds
s_waitcnt lgkmcnt(8)
v_mfma_f32_16x16x32_bf16 v[72:75], v[208:211], v[196:199], v[72:75]
ds_read_b64_tr_b16 v[232:233], v47 offset:16384
v_mfma_f32_16x16x32_bf16 v[76:79], v[208:211], v[200:203], v[76:79]
ds_read_b64_tr_b16 v[234:235], v47 offset:24576
v_mfma_f32_16x16x32_bf16 v[168:171], v[212:215], v[204:207], v[168:171]
ds_read_b64_tr_b16 v[236:237], v40 offset:16384
ds_read_b64_tr_b16 v[238:239], v40 offset:24576
s_mov_b32 s19, 884736
s_add_u32 m0, s18, 32768
s_waitcnt lgkmcnt(8)
v_mfma_f32_16x16x32_bf16 v[80:83], v[216:219], v[196:199], v[80:83]
ds_read_b64_tr_b16 v[208:209], v41 offset:16384
v_mfma_f32_16x16x32_bf16 v[84:87], v[216:219], v[200:203], v[84:87]
ds_read_b64_tr_b16 v[210:211], v41 offset:24576
buffer_load_dwordx4 v1, s[44:47], s19 offen offset:0 lds
v_mfma_f32_16x16x32_bf16 v[88:91], v[220:223], v[196:199], v[88:91]
ds_read_b64_tr_b16 v[212:213], v42 offset:16384
v_mfma_f32_16x16x32_bf16 v[92:95], v[220:223], v[200:203], v[92:95]
ds_read_b64_tr_b16 v[214:215], v42 offset:24576
buffer_load_dwordx4 v2, s[44:47], s19 offen offset:1024 lds
s_waitcnt lgkmcnt(8)
v_mfma_f32_16x16x32_bf16 v[96:99], v[224:227], v[196:199], v[96:99]
ds_read_b64_tr_b16 v[216:217], v43 offset:16384
v_mfma_f32_16x16x32_bf16 v[100:103], v[224:227], v[200:203], v[100:103]
ds_read_b64_tr_b16 v[218:219], v43 offset:24576
buffer_load_dwordx4 v3, s[44:47], s19 offen offset:2048 lds
v_mfma_f32_16x16x32_bf16 v[104:107], v[228:231], v[196:199], v[104:107]
ds_read_b64_tr_b16 v[220:221], v44 offset:16384
v_mfma_f32_16x16x32_bf16 v[108:111], v[228:231], v[200:203], v[108:111]
ds_read_b64_tr_b16 v[222:223], v44 offset:24576
buffer_load_dwordx4 v4, s[44:47], s19 offen offset:3072 lds
s_waitcnt lgkmcnt(8)
v_mfma_f32_16x16x32_bf16 v[172:175], v[204:207], v[232:235], v[172:175]
ds_read_b64_tr_b16 v[224:225], v45 offset:16384
ds_read_b64_tr_b16 v[226:227], v45 offset:24576
s_add_u32 m0, s18, 36864
v_mfma_f32_16x16x32_bf16 v[112:115], v[236:239], v[196:199], v[112:115]
ds_read_b128 v[228:231], v251 offset:320
v_mfma_f32_16x16x32_bf16 v[116:119], v[236:239], v[200:203], v[116:119]
v_mfma_f32_16x16x32_bf16 v[176:179], v[236:239], v[204:207], v[176:179]
buffer_load_dwordx4 v5, s[44:47], s19 offen offset:0 lds
s_waitcnt lgkmcnt(7)
v_mfma_f32_16x16x32_bf16 v[120:123], v[196:199], v[208:211], v[120:123]
s_waitcnt vmcnt(10)
s_barrier
ds_read_b128 v[184:187], v14 offset:0
v_mfma_f32_16x16x32_bf16 v[124:127], v[200:203], v[208:211], v[124:127]
ds_read_b128 v[188:191], v14 offset:2048
ds_read_b128 v[192:195], v15 offset:0
ds_read_b64_tr_b16 v[232:233], v16 offset:0
ds_read_b64_tr_b16 v[234:235], v16 offset:8192
buffer_load_dwordx4 v6, s[44:47], s19 offen offset:1024 lds
v_mfma_f32_16x16x32_bf16 v[128:131], v[196:199], v[212:215], v[128:131]
ds_read_b64_tr_b16 v[236:237], v17 offset:0
v_mfma_f32_16x16x32_bf16 v[132:135], v[200:203], v[212:215], v[132:135]
ds_read_b64_tr_b16 v[238:239], v17 offset:8192
buffer_load_dwordx4 v7, s[44:47], s19 offen offset:2048 lds
buffer_load_dwordx4 v8, s[44:47], s19 offen offset:3072 lds
s_waitcnt lgkmcnt(10)
v_mfma_f32_16x16x32_bf16 v[136:139], v[196:199], v[216:219], v[136:139]
ds_read_b64_tr_b16 v[208:209], v18 offset:0
v_mfma_f32_16x16x32_bf16 v[140:143], v[200:203], v[216:219], v[140:143]
ds_read_b64_tr_b16 v[210:211], v18 offset:8192
v_mfma_f32_16x16x32_bf16 v[144:147], v[196:199], v[220:223], v[144:147]
ds_read_b64_tr_b16 v[212:213], v19 offset:0
v_mfma_f32_16x16x32_bf16 v[148:151], v[200:203], v[220:223], v[148:151]
ds_read_b64_tr_b16 v[214:215], v19 offset:8192
s_waitcnt lgkmcnt(11)
v_mfma_f32_16x16x32_bf16 v[152:155], v[196:199], v[224:227], v[152:155]
ds_read_b64_tr_b16 v[216:217], v30 offset:0
v_mfma_f32_16x16x32_bf16 v[156:159], v[200:203], v[224:227], v[156:159]
ds_read_b64_tr_b16 v[218:219], v30 offset:8192
v_mfma_f32_16x16x32_bf16 v[180:183], v[204:207], v[224:227], v[180:183]
v_mfma_f32_16x16x32_bf16 v[160:163], v[228:231], v[196:199], v[160:163]
ds_read_b64_tr_b16 v[220:221], v20 offset:0
v_mfma_f32_16x16x32_bf16 v[164:167], v[228:231], v[200:203], v[164:167]
ds_read_b64_tr_b16 v[222:223], v20 offset:8192
s_waitcnt lgkmcnt(8)
v_mfma_f32_16x16x32_bf16 v[48:51], v[232:235], v[184:187], v[48:51]
ds_read_b64_tr_b16 v[224:225], v21 offset:0
v_mfma_f32_16x16x32_bf16 v[52:55], v[232:235], v[188:191], v[52:55]
ds_read_b64_tr_b16 v[226:227], v21 offset:8192
v_mfma_f32_16x16x32_bf16 v[56:59], v[236:239], v[184:187], v[56:59]
ds_read_b64_tr_b16 v[228:229], v22 offset:0
v_mfma_f32_16x16x32_bf16 v[60:63], v[236:239], v[188:191], v[60:63]
ds_read_b64_tr_b16 v[230:231], v22 offset:8192
s_barrier
s_waitcnt lgkmcnt(8)
v_mfma_f32_16x16x32_bf16 v[64:67], v[208:211], v[184:187], v[64:67]
ds_read_b64_tr_b16 v[232:233], v23 offset:0
v_mfma_f32_16x16x32_bf16 v[68:71], v[208:211], v[188:191], v[68:71]
ds_read_b64_tr_b16 v[234:235], v23 offset:8192
v_mfma_f32_16x16x32_bf16 v[72:75], v[212:215], v[184:187], v[72:75]
ds_read_b64_tr_b16 v[236:237], v31 offset:0
v_mfma_f32_16x16x32_bf16 v[76:79], v[212:215], v[188:191], v[76:79]
ds_read_b64_tr_b16 v[238:239], v31 offset:8192
s_waitcnt lgkmcnt(8)
v_mfma_f32_16x16x32_bf16 v[168:171], v[216:219], v[192:195], v[168:171]
ds_read_b64_tr_b16 v[208:209], v24 offset:0
ds_read_b64_tr_b16 v[210:211], v24 offset:8192
s_mov_b32 s19, 640
s_add_u32 m0, s17, 36864
v_mfma_f32_16x16x32_bf16 v[80:83], v[220:223], v[184:187], v[80:83]
ds_read_b64_tr_b16 v[212:213], v25 offset:0
v_mfma_f32_16x16x32_bf16 v[84:87], v[220:223], v[188:191], v[84:87]
ds_read_b64_tr_b16 v[214:215], v25 offset:8192
buffer_load_dwordx4 v9, s[40:43], s19 offen offset:0 lds
s_waitcnt lgkmcnt(8)
v_mfma_f32_16x16x32_bf16 v[88:91], v[224:227], v[184:187], v[88:91]
ds_read_b64_tr_b16 v[216:217], v26 offset:0
v_mfma_f32_16x16x32_bf16 v[92:95], v[224:227], v[188:191], v[92:95]
ds_read_b64_tr_b16 v[218:219], v26 offset:8192
buffer_load_dwordx4 v10, s[40:43], s19 offen offset:1024 lds
v_mfma_f32_16x16x32_bf16 v[96:99], v[228:231], v[184:187], v[96:99]
ds_read_b64_tr_b16 v[220:221], v27 offset:0
v_mfma_f32_16x16x32_bf16 v[100:103], v[228:231], v[188:191], v[100:103]
ds_read_b64_tr_b16 v[222:223], v27 offset:8192
s_waitcnt lgkmcnt(8)
v_mfma_f32_16x16x32_bf16 v[104:107], v[232:235], v[184:187], v[104:107]
ds_read_b64_tr_b16 v[224:225], v28 offset:0
v_mfma_f32_16x16x32_bf16 v[108:111], v[232:235], v[188:191], v[108:111]
ds_read_b64_tr_b16 v[226:227], v28 offset:8192
buffer_load_dwordx4 v11, s[40:43], s19 offen offset:2048 lds
v_mfma_f32_16x16x32_bf16 v[172:175], v[192:195], v[236:239], v[172:175]
ds_read_b64_tr_b16 v[228:229], v29 offset:0
ds_read_b64_tr_b16 v[230:231], v29 offset:8192
s_waitcnt lgkmcnt(8)
v_mfma_f32_16x16x32_bf16 v[112:115], v[208:211], v[184:187], v[112:115]
ds_read_b128 v[232:235], v251 offset:384
v_mfma_f32_16x16x32_bf16 v[116:119], v[208:211], v[188:191], v[116:119]
v_mfma_f32_16x16x32_bf16 v[176:179], v[208:211], v[192:195], v[176:179]
buffer_load_dwordx4 v12, s[40:43], s19 offen offset:3072 lds
s_add_u32 m0, s98, 36864
v_mfma_f32_16x16x32_bf16 v[120:123], v[184:187], v[212:215], v[120:123]
ds_read_b128 v[196:199], v14 offset:512
v_mfma_f32_16x16x32_bf16 v[124:127], v[188:191], v[212:215], v[124:127]
ds_read_b128 v[200:203], v14 offset:2560
ds_read_b128 v[204:207], v15 offset:512
ds_read_b64_tr_b16 v[236:237], v16 offset:16384
ds_read_b64_tr_b16 v[238:239], v16 offset:24576
s_waitcnt lgkmcnt(10)
v_mfma_f32_16x16x32_bf16 v[128:131], v[184:187], v[216:219], v[128:131]
ds_read_b64_tr_b16 v[208:209], v17 offset:16384
v_mfma_f32_16x16x32_bf16 v[132:135], v[188:191], v[216:219], v[132:135]
ds_read_b64_tr_b16 v[210:211], v17 offset:24576
buffer_load_dwordx4 v13, s[40:43], s19 offen lds
v_mfma_f32_16x16x32_bf16 v[136:139], v[184:187], v[220:223], v[136:139]
ds_read_b64_tr_b16 v[212:213], v18 offset:16384
v_mfma_f32_16x16x32_bf16 v[140:143], v[188:191], v[220:223], v[140:143]
ds_read_b64_tr_b16 v[214:215], v18 offset:24576
s_mov_b32 s19, 1105920
s_add_u32 m0, s18, 65536
s_waitcnt lgkmcnt(10)
v_mfma_f32_16x16x32_bf16 v[144:147], v[184:187], v[224:227], v[144:147]
ds_read_b64_tr_b16 v[216:217], v19 offset:16384
v_mfma_f32_16x16x32_bf16 v[148:151], v[188:191], v[224:227], v[148:151]
ds_read_b64_tr_b16 v[218:219], v19 offset:24576
v_mfma_f32_16x16x32_bf16 v[152:155], v[184:187], v[228:231], v[152:155]
ds_read_b64_tr_b16 v[220:221], v30 offset:16384
v_mfma_f32_16x16x32_bf16 v[156:159], v[188:191], v[228:231], v[156:159]
ds_read_b64_tr_b16 v[222:223], v30 offset:24576
v_mfma_f32_16x16x32_bf16 v[180:183], v[192:195], v[228:231], v[180:183]
buffer_load_dwordx4 v1, s[44:47], s19 offen offset:0 lds
s_waitcnt lgkmcnt(8)
v_mfma_f32_16x16x32_bf16 v[160:163], v[232:235], v[184:187], v[160:163]
ds_read_b64_tr_b16 v[224:225], v20 offset:16384
v_mfma_f32_16x16x32_bf16 v[164:167], v[232:235], v[188:191], v[164:167]
ds_read_b64_tr_b16 v[226:227], v20 offset:24576
buffer_load_dwordx4 v2, s[44:47], s19 offen offset:1024 lds
v_mfma_f32_16x16x32_bf16 v[48:51], v[236:239], v[196:199], v[48:51]
ds_read_b64_tr_b16 v[228:229], v21 offset:16384
v_mfma_f32_16x16x32_bf16 v[52:55], v[236:239], v[200:203], v[52:55]
ds_read_b64_tr_b16 v[230:231], v21 offset:24576
s_waitcnt lgkmcnt(8)
v_mfma_f32_16x16x32_bf16 v[56:59], v[208:211], v[196:199], v[56:59]
ds_read_b64_tr_b16 v[232:233], v22 offset:16384
v_mfma_f32_16x16x32_bf16 v[60:63], v[208:211], v[200:203], v[60:63]
ds_read_b64_tr_b16 v[234:235], v22 offset:24576
buffer_load_dwordx4 v3, s[44:47], s19 offen offset:2048 lds
v_mfma_f32_16x16x32_bf16 v[64:67], v[212:215], v[196:199], v[64:67]
ds_read_b64_tr_b16 v[236:237], v23 offset:16384
v_mfma_f32_16x16x32_bf16 v[68:71], v[212:215], v[200:203], v[68:71]
ds_read_b64_tr_b16 v[238:239], v23 offset:24576
s_waitcnt lgkmcnt(8)
v_mfma_f32_16x16x32_bf16 v[72:75], v[216:219], v[196:199], v[72:75]
ds_read_b64_tr_b16 v[208:209], v31 offset:16384
v_mfma_f32_16x16x32_bf16 v[76:79], v[216:219], v[200:203], v[76:79]
ds_read_b64_tr_b16 v[210:211], v31 offset:24576
buffer_load_dwordx4 v4, s[44:47], s19 offen offset:3072 lds
v_mfma_f32_16x16x32_bf16 v[168:171], v[220:223], v[204:207], v[168:171]
ds_read_b64_tr_b16 v[212:213], v24 offset:16384
ds_read_b64_tr_b16 v[214:215], v24 offset:24576
s_add_u32 m0, s18, 69632
s_waitcnt lgkmcnt(8)
v_mfma_f32_16x16x32_bf16 v[80:83], v[224:227], v[196:199], v[80:83]
ds_read_b64_tr_b16 v[216:217], v25 offset:16384
v_mfma_f32_16x16x32_bf16 v[84:87], v[224:227], v[200:203], v[84:87]
ds_read_b64_tr_b16 v[218:219], v25 offset:24576
v_mfma_f32_16x16x32_bf16 v[88:91], v[228:231], v[196:199], v[88:91]
ds_read_b64_tr_b16 v[220:221], v26 offset:16384
v_mfma_f32_16x16x32_bf16 v[92:95], v[228:231], v[200:203], v[92:95]
ds_read_b64_tr_b16 v[222:223], v26 offset:24576
buffer_load_dwordx4 v5, s[44:47], s19 offen offset:0 lds
s_waitcnt lgkmcnt(8)
v_mfma_f32_16x16x32_bf16 v[96:99], v[232:235], v[196:199], v[96:99]
ds_read_b64_tr_b16 v[224:225], v27 offset:16384
v_mfma_f32_16x16x32_bf16 v[100:103], v[232:235], v[200:203], v[100:103]
ds_read_b64_tr_b16 v[226:227], v27 offset:24576
v_mfma_f32_16x16x32_bf16 v[104:107], v[236:239], v[196:199], v[104:107]
ds_read_b64_tr_b16 v[228:229], v28 offset:16384
v_mfma_f32_16x16x32_bf16 v[108:111], v[236:239], v[200:203], v[108:111]
ds_read_b64_tr_b16 v[230:231], v28 offset:24576
buffer_load_dwordx4 v6, s[44:47], s19 offen offset:1024 lds
s_waitcnt lgkmcnt(8)
v_mfma_f32_16x16x32_bf16 v[172:175], v[204:207], v[208:211], v[172:175]
ds_read_b64_tr_b16 v[232:233], v29 offset:16384
ds_read_b64_tr_b16 v[234:235], v29 offset:24576
buffer_load_dwordx4 v7, s[44:47], s19 offen offset:2048 lds
v_mfma_f32_16x16x32_bf16 v[112:115], v[212:215], v[196:199], v[112:115]
ds_read_b128 v[236:239], v251 offset:448
v_mfma_f32_16x16x32_bf16 v[116:119], v[212:215], v[200:203], v[116:119]
v_mfma_f32_16x16x32_bf16 v[176:179], v[212:215], v[204:207], v[176:179]
s_waitcnt lgkmcnt(7)
v_mfma_f32_16x16x32_bf16 v[120:123], v[196:199], v[216:219], v[120:123]
s_waitcnt vmcnt(12)
s_barrier
ds_read_b128 v[184:187], v14 offset:18432
v_mfma_f32_16x16x32_bf16 v[124:127], v[200:203], v[216:219], v[124:127]
ds_read_b128 v[188:191], v14 offset:20480
ds_read_b128 v[192:195], v15 offset:18432
ds_read_b64_tr_b16 v[208:209], v16 offset:32768
ds_read_b64_tr_b16 v[210:211], v16 offset:40960
buffer_load_dwordx4 v8, s[44:47], s19 offen offset:3072 lds
s_mul_i32 s7, s100, 81
s_add_u32 s7, s7, 0
v_mfma_f32_16x16x32_bf16 v[128:131], v[196:199], v[220:223], v[128:131]
ds_read_b64_tr_b16 v[212:213], v17 offset:32768
v_mfma_f32_16x16x32_bf16 v[132:135], v[200:203], v[220:223], v[132:135]
ds_read_b64_tr_b16 v[214:215], v17 offset:40960
v_add_u32 v240, s7, v0
v_lshlrev_b32 v240, 7, v240
v_mov_b32 v241, 1073741824
s_waitcnt lgkmcnt(10)
v_mfma_f32_16x16x32_bf16 v[136:139], v[196:199], v[224:227], v[136:139]
ds_read_b64_tr_b16 v[216:217], v18 offset:32768
v_mfma_f32_16x16x32_bf16 v[140:143], v[200:203], v[224:227], v[140:143]
ds_read_b64_tr_b16 v[218:219], v18 offset:40960
v_cmp_gt_u32 vcc, 41, v0
s_nop 1
v_cndmask_b32 v240, v241, v240, vcc
v_mfma_f32_16x16x32_bf16 v[144:147], v[196:199], v[228:231], v[144:147]
ds_read_b64_tr_b16 v[220:221], v19 offset:32768
v_mfma_f32_16x16x32_bf16 v[148:151], v[200:203], v[228:231], v[148:151]
ds_read_b64_tr_b16 v[222:223], v19 offset:40960
buffer_load_dword v252, v240, s[56:59], 0 offen
s_mul_i32 s7, s100, 81
s_add_u32 s7, s7, 41
v_add_u32 v240, s7, v0
s_waitcnt lgkmcnt(11)
v_mfma_f32_16x16x32_bf16 v[152:155], v[196:199], v[232:235], v[152:155]
ds_read_b64_tr_b16 v[224:225], v30 offset:32768
v_mfma_f32_16x16x32_bf16 v[156:159], v[200:203], v[232:235], v[156:159]
ds_read_b64_tr_b16 v[226:227], v30 offset:40960
v_mfma_f32_16x16x32_bf16 v[180:183], v[204:207], v[232:235], v[180:183]
v_lshlrev_b32 v240, 7, v240
v_mov_b32 v241, 1073741824
v_mfma_f32_16x16x32_bf16 v[160:163], v[236:239], v[196:199], v[160:163]
ds_read_b64_tr_b16 v[228:229], v20 offset:32768
v_mfma_f32_16x16x32_bf16 v[164:167], v[236:239], v[200:203], v[164:167]
ds_read_b64_tr_b16 v[230:231], v20 offset:40960
v_cmp_gt_u32 vcc, 40, v0
s_nop 1
v_cndmask_b32 v240, v241, v240, vcc
buffer_load_dword v252, v240, s[56:59], 0 offen
s_waitcnt lgkmcnt(8)
v_mfma_f32_16x16x32_bf16 v[48:51], v[208:211], v[184:187], v[48:51]
ds_read_b64_tr_b16 v[232:233], v21 offset:32768
v_mfma_f32_16x16x32_bf16 v[52:55], v[208:211], v[188:191], v[52:55]
ds_read_b64_tr_b16 v[234:235], v21 offset:40960
v_mfma_f32_16x16x32_bf16 v[56:59], v[212:215], v[184:187], v[56:59]
ds_read_b64_tr_b16 v[236:237], v22 offset:32768
v_mfma_f32_16x16x32_bf16 v[60:63], v[212:215], v[188:191], v[60:63]
ds_read_b64_tr_b16 v[238:239], v22 offset:40960
s_barrier
s_waitcnt lgkmcnt(8)
v_mfma_f32_16x16x32_bf16 v[64:67], v[216:219], v[184:187], v[64:67]
ds_read_b64_tr_b16 v[208:209], v23 offset:32768
v_mfma_f32_16x16x32_bf16 v[68:71], v[216:219], v[188:191], v[68:71]
ds_read_b64_tr_b16 v[210:211], v23 offset:40960
v_mfma_f32_16x16x32_bf16 v[72:75], v[220:223], v[184:187], v[72:75]
ds_read_b64_tr_b16 v[212:213], v31 offset:32768
v_mfma_f32_16x16x32_bf16 v[76:79], v[220:223], v[188:191], v[76:79]
ds_read_b64_tr_b16 v[214:215], v31 offset:40960
s_waitcnt lgkmcnt(8)
v_mfma_f32_16x16x32_bf16 v[168:171], v[224:227], v[192:195], v[168:171]
ds_read_b64_tr_b16 v[216:217], v24 offset:32768
ds_read_b64_tr_b16 v[218:219], v24 offset:40960
v_mfma_f32_16x16x32_bf16 v[80:83], v[228:231], v[184:187], v[80:83]
ds_read_b64_tr_b16 v[220:221], v25 offset:32768
v_mfma_f32_16x16x32_bf16 v[84:87], v[228:231], v[188:191], v[84:87]
ds_read_b64_tr_b16 v[222:223], v25 offset:40960
s_waitcnt lgkmcnt(8)
v_mfma_f32_16x16x32_bf16 v[88:91], v[232:235], v[184:187], v[88:91]
ds_read_b64_tr_b16 v[224:225], v26 offset:32768
v_mfma_f32_16x16x32_bf16 v[92:95], v[232:235], v[188:191], v[92:95]
ds_read_b64_tr_b16 v[226:227], v26 offset:40960
v_mfma_f32_16x16x32_bf16 v[96:99], v[236:239], v[184:187], v[96:99]
ds_read_b64_tr_b16 v[228:229], v27 offset:32768
v_mfma_f32_16x16x32_bf16 v[100:103], v[236:239], v[188:191], v[100:103]
ds_read_b64_tr_b16 v[230:231], v27 offset:40960
s_waitcnt lgkmcnt(8)
v_mfma_f32_16x16x32_bf16 v[104:107], v[208:211], v[184:187], v[104:107]
ds_read_b64_tr_b16 v[232:233], v28 offset:32768
v_mfma_f32_16x16x32_bf16 v[108:111], v[208:211], v[188:191], v[108:111]
ds_read_b64_tr_b16 v[234:235], v28 offset:40960
v_mfma_f32_16x16x32_bf16 v[172:175], v[192:195], v[212:215], v[172:175]
ds_read_b64_tr_b16 v[236:237], v29 offset:32768
ds_read_b64_tr_b16 v[238:239], v29 offset:40960
s_waitcnt lgkmcnt(8)
v_mfma_f32_16x16x32_bf16 v[112:115], v[216:219], v[184:187], v[112:115]
ds_read_b128 v[208:211], v251 offset:512
v_mfma_f32_16x16x32_bf16 v[116:119], v[216:219], v[188:191], v[116:119]
v_mfma_f32_16x16x32_bf16 v[176:179], v[216:219], v[192:195], v[176:179]
v_mfma_f32_16x16x32_bf16 v[120:123], v[184:187], v[220:223], v[120:123]
ds_read_b128 v[196:199], v14 offset:18944
v_mfma_f32_16x16x32_bf16 v[124:127], v[188:191], v[220:223], v[124:127]
ds_read_b128 v[200:203], v14 offset:20992
ds_read_b128 v[204:207], v15 offset:18944
ds_read_b64_tr_b16 v[212:213], v16 offset:49152
ds_read_b64_tr_b16 v[214:215], v16 offset:57344
s_waitcnt lgkmcnt(10)
v_mfma_f32_16x16x32_bf16 v[128:131], v[184:187], v[224:227], v[128:131]
ds_read_b64_tr_b16 v[216:217], v17 offset:49152
v_mfma_f32_16x16x32_bf16 v[132:135], v[188:191], v[224:227], v[132:135]
ds_read_b64_tr_b16 v[218:219], v17 offset:57344
v_mfma_f32_16x16x32_bf16 v[136:139], v[184:187], v[228:231], v[136:139]
ds_read_b64_tr_b16 v[220:221], v18 offset:49152
v_mfma_f32_16x16x32_bf16 v[140:143], v[188:191], v[228:231], v[140:143]
ds_read_b64_tr_b16 v[222:223], v18 offset:57344
s_mov_b32 s19, 768
s_add_u32 m0, s17, 0
s_waitcnt lgkmcnt(10)
v_mfma_f32_16x16x32_bf16 v[144:147], v[184:187], v[232:235], v[144:147]
ds_read_b64_tr_b16 v[224:225], v19 offset:49152
v_mfma_f32_16x16x32_bf16 v[148:151], v[188:191], v[232:235], v[148:151]
ds_read_b64_tr_b16 v[226:227], v19 offset:57344
buffer_load_dwordx4 v9, s[40:43], s19 offen offset:0 lds
v_mfma_f32_16x16x32_bf16 v[152:155], v[184:187], v[236:239], v[152:155]
ds_read_b64_tr_b16 v[228:229], v30 offset:49152
v_mfma_f32_16x16x32_bf16 v[156:159], v[188:191], v[236:239], v[156:159]
ds_read_b64_tr_b16 v[230:231], v30 offset:57344
v_mfma_f32_16x16x32_bf16 v[180:183], v[192:195], v[236:239], v[180:183]
buffer_load_dwordx4 v10, s[40:43], s19 offen offset:1024 lds
s_waitcnt lgkmcnt(8)
v_mfma_f32_16x16x32_bf16 v[160:163], v[208:211], v[184:187], v[160:163]
ds_read_b64_tr_b16 v[232:233], v20 offset:49152
v_mfma_f32_16x16x32_bf16 v[164:167], v[208:211], v[188:191], v[164:167]
ds_read_b64_tr_b16 v[234:235], v20 offset:57344
buffer_load_dwordx4 v11, s[40:43], s19 offen offset:2048 lds
v_mfma_f32_16x16x32_bf16 v[48:51], v[212:215], v[196:199], v[48:51]
ds_read_b64_tr_b16 v[236:237], v21 offset:49152
v_mfma_f32_16x16x32_bf16 v[52:55], v[212:215], v[200:203], v[52:55]
ds_read_b64_tr_b16 v[238:239], v21 offset:57344
buffer_load_dwordx4 v12, s[40:43], s19 offen offset:3072 lds
s_waitcnt lgkmcnt(8)
v_mfma_f32_16x16x32_bf16 v[56:59], v[216:219], v[196:199], v[56:59]
ds_read_b64_tr_b16 v[208:209], v22 offset:49152
v_mfma_f32_16x16x32_bf16 v[60:63], v[216:219], v[200:203], v[60:63]
ds_read_b64_tr_b16 v[210:211], v22 offset:57344
s_add_u32 m0, s98, 0
v_mfma_f32_16x16x32_bf16 v[64:67], v[220:223], v[196:199], v[64:67]
ds_read_b64_tr_b16 v[212:213], v23 offset:49152
v_mfma_f32_16x16x32_bf16 v[68:71], v[220:223], v[200:203], v[68:71]
ds_read_b64_tr_b16 v[214:215], v23 offset:57344
buffer_load_dwordx4 v13, s[40:43], s19 offen lds
s_waitcnt lgkmcnt(8)
v_mfma_f32_16x16x32_bf16 v[72:75], v[224:227], v[196:199], v[72:75]
ds_read_b64_tr_b16 v[216:217], v31 offset:49152
v_mfma_f32_16x16x32_bf16 v[76:79], v[224:227], v[200:203], v[76:79]
ds_read_b64_tr_b16 v[218:219], v31 offset:57344
v_mfma_f32_16x16x32_bf16 v[168:171], v[228:231], v[204:207], v[168:171]
ds_read_b64_tr_b16 v[220:221], v24 offset:49152
ds_read_b64_tr_b16 v[222:223], v24 offset:57344
s_mov_b32 s19, 1327104
s_add_u32 m0, s18, 0
s_waitcnt lgkmcnt(8)
v_mfma_f32_16x16x32_bf16 v[80:83], v[232:235], v[196:199], v[80:83]
ds_read_b64_tr_b16 v[224:225], v25 offset:49152
v_mfma_f32_16x16x32_bf16 v[84:87], v[232:235], v[200:203], v[84:87]
ds_read_b64_tr_b16 v[226:227], v25 offset:57344
buffer_load_dwordx4 v1, s[44:47], s19 offen offset:0 lds
v_mfma_f32_16x16x32_bf16 v[88:91], v[236:239], v[196:199], v[88:91]
ds_read_b64_tr_b16 v[228:229], v26 offset:49152
v_mfma_f32_16x16x32_bf16 v[92:95], v[236:239], v[200:203], v[92:95]
ds_read_b64_tr_b16 v[230:231], v26 offset:57344
buffer_load_dwordx4 v2, s[44:47], s19 offen offset:1024 lds
s_waitcnt lgkmcnt(8)
v_mfma_f32_16x16x32_bf16 v[96:99], v[208:211], v[196:199], v[96:99]
ds_read_b64_tr_b16 v[232:233], v27 offset:49152
v_mfma_f32_16x16x32_bf16 v[100:103], v[208:211], v[200:203], v[100:103]
ds_read_b64_tr_b16 v[234:235], v27 offset:57344
buffer_load_dwordx4 v3, s[44:47], s19 offen offset:2048 lds
v_mfma_f32_16x16x32_bf16 v[104:107], v[212:215], v[196:199], v[104:107]
ds_read_b64_tr_b16 v[236:237], v28 offset:49152
v_mfma_f32_16x16x32_bf16 v[108:111], v[212:215], v[200:203], v[108:111]
ds_read_b64_tr_b16 v[238:239], v28 offset:57344
buffer_load_dwordx4 v4, s[44:47], s19 offen offset:3072 lds
s_waitcnt lgkmcnt(8)
v_mfma_f32_16x16x32_bf16 v[172:175], v[204:207], v[216:219], v[172:175]
ds_read_b64_tr_b16 v[208:209], v29 offset:49152
ds_read_b64_tr_b16 v[210:211], v29 offset:57344
s_add_u32 m0, s18, 4096
v_mfma_f32_16x16x32_bf16 v[112:115], v[220:223], v[196:199], v[112:115]
ds_read_b128 v[212:215], v251 offset:576
v_mfma_f32_16x16x32_bf16 v[116:119], v[220:223], v[200:203], v[116:119]
v_mfma_f32_16x16x32_bf16 v[176:179], v[220:223], v[204:207], v[176:179]
buffer_load_dwordx4 v5, s[44:47], s19 offen offset:0 lds
s_waitcnt lgkmcnt(7)
v_mfma_f32_16x16x32_bf16 v[120:123], v[196:199], v[224:227], v[120:123]
s_waitcnt vmcnt(12)
s_barrier
ds_read_b128 v[184:187], v14 offset:36864
v_mfma_f32_16x16x32_bf16 v[124:127], v[200:203], v[224:227], v[124:127]
ds_read_b128 v[188:191], v14 offset:38912
ds_read_b128 v[192:195], v15 offset:36864
ds_read_b64_tr_b16 v[216:217], v32 offset:0
ds_read_b64_tr_b16 v[218:219], v32 offset:8192
buffer_load_dwordx4 v6, s[44:47], s19 offen offset:1024 lds
v_mfma_f32_16x16x32_bf16 v[128:131], v[196:199], v[228:231], v[128:131]
ds_read_b64_tr_b16 v[220:221], v33 offset:0
v_mfma_f32_16x16x32_bf16 v[132:135], v[200:203], v[228:231], v[132:135]
ds_read_b64_tr_b16 v[222:223], v33 offset:8192
buffer_load_dwordx4 v7, s[44:47], s19 offen offset:2048 lds
buffer_load_dwordx4 v8, s[44:47], s19 offen offset:3072 lds
s_waitcnt lgkmcnt(10)
v_mfma_f32_16x16x32_bf16 v[136:139], v[196:199], v[232:235], v[136:139]
ds_read_b64_tr_b16 v[224:225], v34 offset:0
v_mfma_f32_16x16x32_bf16 v[140:143], v[200:203], v[232:235], v[140:143]
ds_read_b64_tr_b16 v[226:227], v34 offset:8192
v_mfma_f32_16x16x32_bf16 v[144:147], v[196:199], v[236:239], v[144:147]
ds_read_b64_tr_b16 v[228:229], v35 offset:0
v_mfma_f32_16x16x32_bf16 v[148:151], v[200:203], v[236:239], v[148:151]
ds_read_b64_tr_b16 v[230:231], v35 offset:8192
s_waitcnt lgkmcnt(11)
v_mfma_f32_16x16x32_bf16 v[152:155], v[196:199], v[208:211], v[152:155]
ds_read_b64_tr_b16 v[232:233], v46 offset:0
v_mfma_f32_16x16x32_bf16 v[156:159], v[200:203], v[208:211], v[156:159]
ds_read_b64_tr_b16 v[234:235], v46 offset:8192
v_mfma_f32_16x16x32_bf16 v[180:183], v[204:207], v[208:211], v[180:183]
v_mfma_f32_16x16x32_bf16 v[160:163], v[212:215], v[196:199], v[160:163]
ds_read_b64_tr_b16 v[236:237], v36 offset:0
v_mfma_f32_16x16x32_bf16 v[164:167], v[212:215], v[200:203], v[164:167]
ds_read_b64_tr_b16 v[238:239], v36 offset:8192
s_waitcnt lgkmcnt(8)
v_mfma_f32_16x16x32_bf16 v[48:51], v[216:219], v[184:187], v[48:51]
ds_read_b64_tr_b16 v[208:209], v37 offset:0
v_mfma_f32_16x16x32_bf16 v[52:55], v[216:219], v[188:191], v[52:55]
ds_read_b64_tr_b16 v[210:211], v37 offset:8192
v_mfma_f32_16x16x32_bf16 v[56:59], v[220:223], v[184:187], v[56:59]
ds_read_b64_tr_b16 v[212:213], v38 offset:0
v_mfma_f32_16x16x32_bf16 v[60:63], v[220:223], v[188:191], v[60:63]
ds_read_b64_tr_b16 v[214:215], v38 offset:8192
s_barrier
s_waitcnt lgkmcnt(8)
v_mfma_f32_16x16x32_bf16 v[64:67], v[224:227], v[184:187], v[64:67]
ds_read_b64_tr_b16 v[216:217], v39 offset:0
v_mfma_f32_16x16x32_bf16 v[68:71], v[224:227], v[188:191], v[68:71]
ds_read_b64_tr_b16 v[218:219], v39 offset:8192
v_mfma_f32_16x16x32_bf16 v[72:75], v[228:231], v[184:187], v[72:75]
ds_read_b64_tr_b16 v[220:221], v47 offset:0
v_mfma_f32_16x16x32_bf16 v[76:79], v[228:231], v[188:191], v[76:79]
ds_read_b64_tr_b16 v[222:223], v47 offset:8192
s_waitcnt lgkmcnt(8)
v_mfma_f32_16x16x32_bf16 v[168:171], v[232:235], v[192:195], v[168:171]
ds_read_b64_tr_b16 v[224:225], v40 offset:0
ds_read_b64_tr_b16 v[226:227], v40 offset:8192
v_mfma_f32_16x16x32_bf16 v[80:83], v[236:239], v[184:187], v[80:83]
ds_read_b64_tr_b16 v[228:229], v41 offset:0
v_mfma_f32_16x16x32_bf16 v[84:87], v[236:239], v[188:191], v[84:87]
ds_read_b64_tr_b16 v[230:231], v41 offset:8192
s_waitcnt lgkmcnt(8)
v_mfma_f32_16x16x32_bf16 v[88:91], v[208:211], v[184:187], v[88:91]
ds_read_b64_tr_b16 v[232:233], v42 offset:0
v_mfma_f32_16x16x32_bf16 v[92:95], v[208:211], v[188:191], v[92:95]
ds_read_b64_tr_b16 v[234:235], v42 offset:8192
v_mfma_f32_16x16x32_bf16 v[96:99], v[212:215], v[184:187], v[96:99]
ds_read_b64_tr_b16 v[236:237], v43 offset:0
v_mfma_f32_16x16x32_bf16 v[100:103], v[212:215], v[188:191], v[100:103]
ds_read_b64_tr_b16 v[238:239], v43 offset:8192
s_waitcnt lgkmcnt(8)
v_mfma_f32_16x16x32_bf16 v[104:107], v[216:219], v[184:187], v[104:107]
ds_read_b64_tr_b16 v[208:209], v44 offset:0
v_mfma_f32_16x16x32_bf16 v[108:111], v[216:219], v[188:191], v[108:111]
ds_read_b64_tr_b16 v[210:211], v44 offset:8192
v_mfma_f32_16x16x32_bf16 v[172:175], v[192:195], v[220:223], v[172:175]
ds_read_b64_tr_b16 v[212:213], v45 offset:0
ds_read_b64_tr_b16 v[214:215], v45 offset:8192
s_waitcnt lgkmcnt(8)
v_mfma_f32_16x16x32_bf16 v[112:115], v[224:227], v[184:187], v[112:115]
ds_read_b128 v[216:219], v251 offset:640
v_mfma_f32_16x16x32_bf16 v[116:119], v[224:227], v[188:191], v[116:119]
v_mfma_f32_16x16x32_bf16 v[176:179], v[224:227], v[192:195], v[176:179]
v_mfma_f32_16x16x32_bf16 v[120:123], v[184:187], v[228:231], v[120:123]
ds_read_b128 v[196:199], v14 offset:37376
v_mfma_f32_16x16x32_bf16 v[124:127], v[188:191], v[228:231], v[124:127]
ds_read_b128 v[200:203], v14 offset:39424
ds_read_b128 v[204:207], v15 offset:37376
ds_read_b64_tr_b16 v[220:221], v32 offset:16384
ds_read_b64_tr_b16 v[222:223], v32 offset:24576
s_waitcnt lgkmcnt(10)
v_mfma_f32_16x16x32_bf16 v[128:131], v[184:187], v[232:235], v[128:131]
ds_read_b64_tr_b16 v[224:225], v33 offset:16384
v_mfma_f32_16x16x32_bf16 v[132:135], v[188:191], v[232:235], v[132:135]
ds_read_b64_tr_b16 v[226:227], v33 offset:24576
v_mfma_f32_16x16x32_bf16 v[136:139], v[184:187], v[236:239], v[136:139]
ds_read_b64_tr_b16 v[228:229], v34 offset:16384
v_mfma_f32_16x16x32_bf16 v[140:143], v[188:191], v[236:239], v[140:143]
ds_read_b64_tr_b16 v[230:231], v34 offset:24576
s_mov_b32 s19, 896
s_add_u32 m0, s17, 18432
s_waitcnt lgkmcnt(10)
v_mfma_f32_16x16x32_bf16 v[144:147], v[184:187], v[208:211], v[144:147]
ds_read_b64_tr_b16 v[232:233], v35 offset:16384
v_mfma_f32_16x16x32_bf16 v[148:151], v[188:191], v[208:211], v[148:151]
ds_read_b64_tr_b16 v[234:235], v35 offset:24576
buffer_load_dwordx4 v9, s[40:43], s19 offen offset:0 lds
v_mfma_f32_16x16x32_bf16 v[152:155], v[184:187], v[212:215], v[152:155]
ds_read_b64_tr_b16 v[236:237], v46 offset:16384
v_mfma_f32_16x16x32_bf16 v[156:159], v[188:191], v[212:215], v[156:159]
ds_read_b64_tr_b16 v[238:239], v46 offset:24576
v_mfma_f32_16x16x32_bf16 v[180:183], v[192:195], v[212:215], v[180:183]
buffer_load_dwordx4 v10, s[40:43], s19 offen offset:1024 lds
s_waitcnt lgkmcnt(8)
v_mfma_f32_16x16x32_bf16 v[160:163], v[216:219], v[184:187], v[160:163]
ds_read_b64_tr_b16 v[208:209], v36 offset:16384
v_mfma_f32_16x16x32_bf16 v[164:167], v[216:219], v[188:191], v[164:167]
ds_read_b64_tr_b16 v[210:211], v36 offset:24576
buffer_load_dwordx4 v11, s[40:43], s19 offen offset:2048 lds
v_mfma_f32_16x16x32_bf16 v[48:51], v[220:223], v[196:199], v[48:51]
ds_read_b64_tr_b16 v[212:213], v37 offset:16384
v_mfma_f32_16x16x32_bf16 v[52:55], v[220:223], v[200:203], v[52:55]
ds_read_b64_tr_b16 v[214:215], v37 offset:24576
buffer_load_dwordx4 v12, s[40:43], s19 offen offset:3072 lds
s_waitcnt lgkmcnt(8)
v_mfma_f32_16x16x32_bf16 v[56:59], v[224:227], v[196:199], v[56:59]
ds_read_b64_tr_b16 v[216:217], v38 offset:16384
v_mfma_f32_16x16x32_bf16 v[60:63], v[224:227], v[200:203], v[60:63]
ds_read_b64_tr_b16 v[218:219], v38 offset:24576
s_add_u32 m0, s98, 18432
v_mfma_f32_16x16x32_bf16 v[64:67], v[228:231], v[196:199], v[64:67]
ds_read_b64_tr_b16 v[220:221], v39 offset:16384
v_mfma_f32_16x16x32_bf16 v[68:71], v[228:231], v[200:203], v[68:71]
ds_read_b64_tr_b16 v[222:223], v39 offset:24576
buffer_load_dwordx4 v13, s[40:43], s19 offen lds
s_waitcnt lgkmcnt(8)
v_mfma_f32_16x16x32_bf16 v[72:75], v[232:235], v[196:199], v[72:75]
ds_read_b64_tr_b16 v[224:225], v47 offset:16384
v_mfma_f32_16x16x32_bf16 v[76:79], v[232:235], v[200:203], v[76:79]
ds_read_b64_tr_b16 v[226:227], v47 offset:24576
v_mfma_f32_16x16x32_bf16 v[168:171], v[236:239], v[204:207], v[168:171]
ds_read_b64_tr_b16 v[228:229], v40 offset:16384
ds_read_b64_tr_b16 v[230:231], v40 offset:24576
s_mov_b32 s19, 1548288
s_add_u32 m0, s18, 32768
s_waitcnt lgkmcnt(8)
v_mfma_f32_16x16x32_bf16 v[80:83], v[208:211], v[196:199], v[80:83]
ds_read_b64_tr_b16 v[232:233], v41 offset:16384
v_mfma_f32_16x16x32_bf16 v[84:87], v[208:211], v[200:203], v[84:87]
ds_read_b64_tr_b16 v[234:235], v41 offset:24576
buffer_load_dwordx4 v1, s[44:47], s19 offen offset:0 lds
v_mfma_f32_16x16x32_bf16 v[88:91], v[212:215], v[196:199], v[88:91]
ds_read_b64_tr_b16 v[236:237], v42 offset:16384
v_mfma_f32_16x16x32_bf16 v[92:95], v[212:215], v[200:203], v[92:95]
ds_read_b64_tr_b16 v[238:239], v42 offset:24576
buffer_load_dwordx4 v2, s[44:47], s19 offen offset:1024 lds
s_waitcnt lgkmcnt(8)
v_mfma_f32_16x16x32_bf16 v[96:99], v[216:219], v[196:199], v[96:99]
ds_read_b64_tr_b16 v[208:209], v43 offset:16384
v_mfma_f32_16x16x32_bf16 v[100:103], v[216:219], v[200:203], v[100:103]
ds_read_b64_tr_b16 v[210:211], v43 offset:24576
buffer_load_dwordx4 v3, s[44:47], s19 offen offset:2048 lds
v_mfma_f32_16x16x32_bf16 v[104:107], v[220:223], v[196:199], v[104:107]
ds_read_b64_tr_b16 v[212:213], v44 offset:16384
v_mfma_f32_16x16x32_bf16 v[108:111], v[220:223], v[200:203], v[108:111]
ds_read_b64_tr_b16 v[214:215], v44 offset:24576
buffer_load_dwordx4 v4, s[44:47], s19 offen offset:3072 lds
s_waitcnt lgkmcnt(8)
v_mfma_f32_16x16x32_bf16 v[172:175], v[204:207], v[224:227], v[172:175]
ds_read_b64_tr_b16 v[216:217], v45 offset:16384
ds_read_b64_tr_b16 v[218:219], v45 offset:24576
s_add_u32 m0, s18, 36864
v_mfma_f32_16x16x32_bf16 v[112:115], v[228:231], v[196:199], v[112:115]
ds_read_b128 v[220:223], v251 offset:704
v_mfma_f32_16x16x32_bf16 v[116:119], v[228:231], v[200:203], v[116:119]
v_mfma_f32_16x16x32_bf16 v[176:179], v[228:231], v[204:207], v[176:179]
buffer_load_dwordx4 v5, s[44:47], s19 offen offset:0 lds
s_waitcnt lgkmcnt(7)
v_mfma_f32_16x16x32_bf16 v[120:123], v[196:199], v[232:235], v[120:123]
s_waitcnt vmcnt(10)
s_barrier
ds_read_b128 v[184:187], v14 offset:0
v_mfma_f32_16x16x32_bf16 v[124:127], v[200:203], v[232:235], v[124:127]
ds_read_b128 v[188:191], v14 offset:2048
ds_read_b128 v[192:195], v15 offset:0
ds_read_b64_tr_b16 v[224:225], v16 offset:0
ds_read_b64_tr_b16 v[226:227], v16 offset:8192
buffer_load_dwordx4 v6, s[44:47], s19 offen offset:1024 lds
v_mfma_f32_16x16x32_bf16 v[128:131], v[196:199], v[236:239], v[128:131]
ds_read_b64_tr_b16 v[228:229], v17 offset:0
v_mfma_f32_16x16x32_bf16 v[132:135], v[200:203], v[236:239], v[132:135]
ds_read_b64_tr_b16 v[230:231], v17 offset:8192
buffer_load_dwordx4 v7, s[44:47], s19 offen offset:2048 lds
buffer_load_dwordx4 v8, s[44:47], s19 offen offset:3072 lds
s_waitcnt lgkmcnt(10)
v_mfma_f32_16x16x32_bf16 v[136:139], v[196:199], v[208:211], v[136:139]
ds_read_b64_tr_b16 v[232:233], v18 offset:0
v_mfma_f32_16x16x32_bf16 v[140:143], v[200:203], v[208:211], v[140:143]
ds_read_b64_tr_b16 v[234:235], v18 offset:8192
v_mfma_f32_16x16x32_bf16 v[144:147], v[196:199], v[212:215], v[144:147]
ds_read_b64_tr_b16 v[236:237], v19 offset:0
v_mfma_f32_16x16x32_bf16 v[148:151], v[200:203], v[212:215], v[148:151]
ds_read_b64_tr_b16 v[238:239], v19 offset:8192
s_waitcnt lgkmcnt(11)
v_mfma_f32_16x16x32_bf16 v[152:155], v[196:199], v[216:219], v[152:155]
ds_read_b64_tr_b16 v[208:209], v30 offset:0
v_mfma_f32_16x16x32_bf16 v[156:159], v[200:203], v[216:219], v[156:159]
ds_read_b64_tr_b16 v[210:211], v30 offset:8192
v_mfma_f32_16x16x32_bf16 v[180:183], v[204:207], v[216:219], v[180:183]
v_mfma_f32_16x16x32_bf16 v[160:163], v[220:223], v[196:199], v[160:163]
ds_read_b64_tr_b16 v[212:213], v20 offset:0
v_mfma_f32_16x16x32_bf16 v[164:167], v[220:223], v[200:203], v[164:167]
ds_read_b64_tr_b16 v[214:215], v20 offset:8192
s_waitcnt lgkmcnt(8)
v_mfma_f32_16x16x32_bf16 v[48:51], v[224:227], v[184:187], v[48:51]
ds_read_b64_tr_b16 v[216:217], v21 offset:0
v_mfma_f32_16x16x32_bf16 v[52:55], v[224:227], v[188:191], v[52:55]
ds_read_b64_tr_b16 v[218:219], v21 offset:8192
v_mfma_f32_16x16x32_bf16 v[56:59], v[228:231], v[184:187], v[56:59]
ds_read_b64_tr_b16 v[220:221], v22 offset:0
v_mfma_f32_16x16x32_bf16 v[60:63], v[228:231], v[188:191], v[60:63]
ds_read_b64_tr_b16 v[222:223], v22 offset:8192
s_barrier
s_waitcnt lgkmcnt(8)
v_mfma_f32_16x16x32_bf16 v[64:67], v[232:235], v[184:187], v[64:67]
ds_read_b64_tr_b16 v[224:225], v23 offset:0
v_mfma_f32_16x16x32_bf16 v[68:71], v[232:235], v[188:191], v[68:71]
ds_read_b64_tr_b16 v[226:227], v23 offset:8192
v_mfma_f32_16x16x32_bf16 v[72:75], v[236:239], v[184:187], v[72:75]
ds_read_b64_tr_b16 v[228:229], v31 offset:0
v_mfma_f32_16x16x32_bf16 v[76:79], v[236:239], v[188:191], v[76:79]
ds_read_b64_tr_b16 v[230:231], v31 offset:8192
s_waitcnt lgkmcnt(8)
v_mfma_f32_16x16x32_bf16 v[168:171], v[208:211], v[192:195], v[168:171]
ds_read_b64_tr_b16 v[232:233], v24 offset:0
ds_read_b64_tr_b16 v[234:235], v24 offset:8192
v_mfma_f32_16x16x32_bf16 v[80:83], v[212:215], v[184:187], v[80:83]
ds_read_b64_tr_b16 v[236:237], v25 offset:0
v_mfma_f32_16x16x32_bf16 v[84:87], v[212:215], v[188:191], v[84:87]
ds_read_b64_tr_b16 v[238:239], v25 offset:8192
s_waitcnt lgkmcnt(8)
v_mfma_f32_16x16x32_bf16 v[88:91], v[216:219], v[184:187], v[88:91]
ds_read_b64_tr_b16 v[208:209], v26 offset:0
v_mfma_f32_16x16x32_bf16 v[92:95], v[216:219], v[188:191], v[92:95]
ds_read_b64_tr_b16 v[210:211], v26 offset:8192
v_mfma_f32_16x16x32_bf16 v[96:99], v[220:223], v[184:187], v[96:99]
ds_read_b64_tr_b16 v[212:213], v27 offset:0
v_mfma_f32_16x16x32_bf16 v[100:103], v[220:223], v[188:191], v[100:103]
ds_read_b64_tr_b16 v[214:215], v27 offset:8192
s_waitcnt lgkmcnt(8)
v_mfma_f32_16x16x32_bf16 v[104:107], v[224:227], v[184:187], v[104:107]
ds_read_b64_tr_b16 v[216:217], v28 offset:0
v_mfma_f32_16x16x32_bf16 v[108:111], v[224:227], v[188:191], v[108:111]
ds_read_b64_tr_b16 v[218:219], v28 offset:8192
v_mfma_f32_16x16x32_bf16 v[172:175], v[192:195], v[228:231], v[172:175]
ds_read_b64_tr_b16 v[220:221], v29 offset:0
ds_read_b64_tr_b16 v[222:223], v29 offset:8192
s_waitcnt lgkmcnt(8)
v_mfma_f32_16x16x32_bf16 v[112:115], v[232:235], v[184:187], v[112:115]
ds_read_b128 v[224:227], v251 offset:768
v_mfma_f32_16x16x32_bf16 v[116:119], v[232:235], v[188:191], v[116:119]
v_mfma_f32_16x16x32_bf16 v[176:179], v[232:235], v[192:195], v[176:179]
v_mfma_f32_16x16x32_bf16 v[120:123], v[184:187], v[236:239], v[120:123]
ds_read_b128 v[196:199], v14 offset:512
v_mfma_f32_16x16x32_bf16 v[124:127], v[188:191], v[236:239], v[124:127]
ds_read_b128 v[200:203], v14 offset:2560
ds_read_b128 v[204:207], v15 offset:512
ds_read_b64_tr_b16 v[228:229], v16 offset:16384
ds_read_b64_tr_b16 v[230:231], v16 offset:24576
s_waitcnt lgkmcnt(10)
v_mfma_f32_16x16x32_bf16 v[128:131], v[184:187], v[208:211], v[128:131]
ds_read_b64_tr_b16 v[232:233], v17 offset:16384
v_mfma_f32_16x16x32_bf16 v[132:135], v[188:191], v[208:211], v[132:135]
ds_read_b64_tr_b16 v[234:235], v17 offset:24576
v_mfma_f32_16x16x32_bf16 v[136:139], v[184:187], v[212:215], v[136:139]
ds_read_b64_tr_b16 v[236:237], v18 offset:16384
v_mfma_f32_16x16x32_bf16 v[140:143], v[188:191], v[212:215], v[140:143]
ds_read_b64_tr_b16 v[238:239], v18 offset:24576
s_mov_b32 s19, 1024
s_add_u32 m0, s17, 36864
s_waitcnt lgkmcnt(10)
v_mfma_f32_16x16x32_bf16 v[144:147], v[184:187], v[216:219], v[144:147]
ds_read_b64_tr_b16 v[208:209], v19 offset:16384
v_mfma_f32_16x16x32_bf16 v[148:151], v[188:191], v[216:219], v[148:151]
ds_read_b64_tr_b16 v[210:211], v19 offset:24576
buffer_load_dwordx4 v9, s[40:43], s19 offen offset:0 lds
v_mfma_f32_16x16x32_bf16 v[152:155], v[184:187], v[220:223], v[152:155]
ds_read_b64_tr_b16 v[212:213], v30 offset:16384
v_mfma_f32_16x16x32_bf16 v[156:159], v[188:191], v[220:223], v[156:159]
ds_read_b64_tr_b16 v[214:215], v30 offset:24576
v_mfma_f32_16x16x32_bf16 v[180:183], v[192:195], v[220:223], v[180:183]
buffer_load_dwordx4 v10, s[40:43], s19 offen offset:1024 lds
s_waitcnt lgkmcnt(8)
v_mfma_f32_16x16x32_bf16 v[160:163], v[224:227], v[184:187], v[160:163]
ds_read_b64_tr_b16 v[216:217], v20 offset:16384
v_mfma_f32_16x16x32_bf16 v[164:167], v[224:227], v[188:191], v[164:167]
ds_read_b64_tr_b16 v[218:219], v20 offset:24576
buffer_load_dwordx4 v11, s[40:43], s19 offen offset:2048 lds
v_mfma_f32_16x16x32_bf16 v[48:51], v[228:231], v[196:199], v[48:51]
ds_read_b64_tr_b16 v[220:221], v21 offset:16384
v_mfma_f32_16x16x32_bf16 v[52:55], v[228:231], v[200:203], v[52:55]
ds_read_b64_tr_b16 v[222:223], v21 offset:24576
buffer_load_dwordx4 v12, s[40:43], s19 offen offset:3072 lds
s_waitcnt lgkmcnt(8)
v_mfma_f32_16x16x32_bf16 v[56:59], v[232:235], v[196:199], v[56:59]
ds_read_b64_tr_b16 v[224:225], v22 offset:16384
v_mfma_f32_16x16x32_bf16 v[60:63], v[232:235], v[200:203], v[60:63]
ds_read_b64_tr_b16 v[226:227], v22 offset:24576
s_add_u32 m0, s98, 36864
v_mfma_f32_16x16x32_bf16 v[64:67], v[236:239], v[196:199], v[64:67]
ds_read_b64_tr_b16 v[228:229], v23 offset:16384
v_mfma_f32_16x16x32_bf16 v[68:71], v[236:239], v[200:203], v[68:71]
ds_read_b64_tr_b16 v[230:231], v23 offset:24576
buffer_load_dwordx4 v13, s[40:43], s19 offen lds
s_waitcnt lgkmcnt(8)
v_mfma_f32_16x16x32_bf16 v[72:75], v[208:211], v[196:199], v[72:75]
ds_read_b64_tr_b16 v[232:233], v31 offset:16384
v_mfma_f32_16x16x32_bf16 v[76:79], v[208:211], v[200:203], v[76:79]
ds_read_b64_tr_b16 v[234:235], v31 offset:24576
v_mfma_f32_16x16x32_bf16 v[168:171], v[212:215], v[204:207], v[168:171]
ds_read_b64_tr_b16 v[236:237], v24 offset:16384
ds_read_b64_tr_b16 v[238:239], v24 offset:24576
s_mov_b32 s19, 1769472
s_add_u32 m0, s18, 65536
s_waitcnt lgkmcnt(8)
v_mfma_f32_16x16x32_bf16 v[80:83], v[216:219], v[196:199], v[80:83]
ds_read_b64_tr_b16 v[208:209], v25 offset:16384
v_mfma_f32_16x16x32_bf16 v[84:87], v[216:219], v[200:203], v[84:87]
ds_read_b64_tr_b16 v[210:211], v25 offset:24576
buffer_load_dwordx4 v1, s[44:47], s19 offen offset:0 lds
v_mfma_f32_16x16x32_bf16 v[88:91], v[220:223], v[196:199], v[88:91]
ds_read_b64_tr_b16 v[212:213], v26 offset:16384
v_mfma_f32_16x16x32_bf16 v[92:95], v[220:223], v[200:203], v[92:95]
ds_read_b64_tr_b16 v[214:215], v26 offset:24576
buffer_load_dwordx4 v2, s[44:47], s19 offen offset:1024 lds
s_waitcnt lgkmcnt(8)
v_mfma_f32_16x16x32_bf16 v[96:99], v[224:227], v[196:199], v[96:99]
ds_read_b64_tr_b16 v[216:217], v27 offset:16384
v_mfma_f32_16x16x32_bf16 v[100:103], v[224:227], v[200:203], v[100:103]
ds_read_b64_tr_b16 v[218:219], v27 offset:24576
buffer_load_dwordx4 v3, s[44:47], s19 offen offset:2048 lds
v_mfma_f32_16x16x32_bf16 v[104:107], v[228:231], v[196:199], v[104:107]
ds_read_b64_tr_b16 v[220:221], v28 offset:16384
v_mfma_f32_16x16x32_bf16 v[108:111], v[228:231], v[200:203], v[108:111]
ds_read_b64_tr_b16 v[222:223], v28 offset:24576
buffer_load_dwordx4 v4, s[44:47], s19 offen offset:3072 lds
s_waitcnt lgkmcnt(8)
v_mfma_f32_16x16x32_bf16 v[172:175], v[204:207], v[232:235], v[172:175]
ds_read_b64_tr_b16 v[224:225], v29 offset:16384
ds_read_b64_tr_b16 v[226:227], v29 offset:24576
s_add_u32 m0, s18, 69632
v_mfma_f32_16x16x32_bf16 v[112:115], v[236:239], v[196:199], v[112:115]
ds_read_b128 v[228:231], v251 offset:832
v_mfma_f32_16x16x32_bf16 v[116:119], v[236:239], v[200:203], v[116:119]
v_mfma_f32_16x16x32_bf16 v[176:179], v[236:239], v[204:207], v[176:179]
buffer_load_dwordx4 v5, s[44:47], s19 offen offset:0 lds
s_waitcnt lgkmcnt(7)
v_mfma_f32_16x16x32_bf16 v[120:123], v[196:199], v[208:211], v[120:123]
s_waitcnt vmcnt(10)
s_barrier
ds_read_b128 v[184:187], v14 offset:18432
v_mfma_f32_16x16x32_bf16 v[124:127], v[200:203], v[208:211], v[124:127]
ds_read_b128 v[188:191], v14 offset:20480
ds_read_b128 v[192:195], v15 offset:18432
ds_read_b64_tr_b16 v[232:233], v16 offset:32768
ds_read_b64_tr_b16 v[234:235], v16 offset:40960
buffer_load_dwordx4 v6, s[44:47], s19 offen offset:1024 lds
v_mfma_f32_16x16x32_bf16 v[128:131], v[196:199], v[212:215], v[128:131]
ds_read_b64_tr_b16 v[236:237], v17 offset:32768
v_mfma_f32_16x16x32_bf16 v[132:135], v[200:203], v[212:215], v[132:135]
ds_read_b64_tr_b16 v[238:239], v17 offset:40960
buffer_load_dwordx4 v7, s[44:47], s19 offen offset:2048 lds
buffer_load_dwordx4 v8, s[44:47], s19 offen offset:3072 lds
s_waitcnt lgkmcnt(10)
v_mfma_f32_16x16x32_bf16 v[136:139], v[196:199], v[216:219], v[136:139]
ds_read_b64_tr_b16 v[208:209], v18 offset:32768
v_mfma_f32_16x16x32_bf16 v[140:143], v[200:203], v[216:219], v[140:143]
ds_read_b64_tr_b16 v[210:211], v18 offset:40960
v_mfma_f32_16x16x32_bf16 v[144:147], v[196:199], v[220:223], v[144:147]
ds_read_b64_tr_b16 v[212:213], v19 offset:32768
v_mfma_f32_16x16x32_bf16 v[148:151], v[200:203], v[220:223], v[148:151]
ds_read_b64_tr_b16 v[214:215], v19 offset:40960
s_waitcnt lgkmcnt(11)
v_mfma_f32_16x16x32_bf16 v[152:155], v[196:199], v[224:227], v[152:155]
ds_read_b64_tr_b16 v[216:217], v30 offset:32768
v_mfma_f32_16x16x32_bf16 v[156:159], v[200:203], v[224:227], v[156:159]
ds_read_b64_tr_b16 v[218:219], v30 offset:40960
v_mfma_f32_16x16x32_bf16 v[180:183], v[204:207], v[224:227], v[180:183]
v_mfma_f32_16x16x32_bf16 v[160:163], v[228:231], v[196:199], v[160:163]
ds_read_b64_tr_b16 v[220:221], v20 offset:32768
v_mfma_f32_16x16x32_bf16 v[164:167], v[228:231], v[200:203], v[164:167]
ds_read_b64_tr_b16 v[222:223], v20 offset:40960
s_waitcnt lgkmcnt(8)
v_mfma_f32_16x16x32_bf16 v[48:51], v[232:235], v[184:187], v[48:51]
ds_read_b64_tr_b16 v[224:225], v21 offset:32768
v_mfma_f32_16x16x32_bf16 v[52:55], v[232:235], v[188:191], v[52:55]
ds_read_b64_tr_b16 v[226:227], v21 offset:40960
v_mfma_f32_16x16x32_bf16 v[56:59], v[236:239], v[184:187], v[56:59]
ds_read_b64_tr_b16 v[228:229], v22 offset:32768
v_mfma_f32_16x16x32_bf16 v[60:63], v[236:239], v[188:191], v[60:63]
ds_read_b64_tr_b16 v[230:231], v22 offset:40960
s_waitcnt lgkmcnt(8)
v_mfma_f32_16x16x32_bf16 v[64:67], v[208:211], v[184:187], v[64:67]
ds_read_b64_tr_b16 v[232:233], v23 offset:32768
v_mfma_f32_16x16x32_bf16 v[68:71], v[208:211], v[188:191], v[68:71]
ds_read_b64_tr_b16 v[234:235], v23 offset:40960
s_mul_i32 s7, s100, 81
v_mfma_f32_16x16x32_bf16 v[72:75], v[212:215], v[184:187], v[72:75]
ds_read_b64_tr_b16 v[236:237], v31 offset:32768
v_mfma_f32_16x16x32_bf16 v[76:79], v[212:215], v[188:191], v[76:79]
ds_read_b64_tr_b16 v[238:239], v31 offset:40960
s_waitcnt lgkmcnt(8)
v_mfma_f32_16x16x32_bf16 v[168:171], v[216:219], v[192:195], v[168:171]
ds_read_b64_tr_b16 v[208:209], v24 offset:32768
ds_read_b64_tr_b16 v[210:211], v24 offset:40960
s_add_u32 s7, s7, 0
v_mfma_f32_16x16x32_bf16 v[80:83], v[220:223], v[184:187], v[80:83]
ds_read_b64_tr_b16 v[212:213], v25 offset:32768
v_mfma_f32_16x16x32_bf16 v[84:87], v[220:223], v[188:191], v[84:87]
ds_read_b64_tr_b16 v[214:215], v25 offset:40960
s_waitcnt lgkmcnt(8)
v_mfma_f32_16x16x32_bf16 v[88:91], v[224:227], v[184:187], v[88:91]
ds_read_b64_tr_b16 v[216:217], v26 offset:32768
v_mfma_f32_16x16x32_bf16 v[92:95], v[224:227], v[188:191], v[92:95]
ds_read_b64_tr_b16 v[218:219], v26 offset:40960
v_add_u32 v240, s7, v0
v_mfma_f32_16x16x32_bf16 v[96:99], v[228:231], v[184:187], v[96:99]
ds_read_b64_tr_b16 v[220:221], v27 offset:32768
v_mfma_f32_16x16x32_bf16 v[100:103], v[228:231], v[188:191], v[100:103]
ds_read_b64_tr_b16 v[222:223], v27 offset:40960
s_waitcnt lgkmcnt(8)
v_mfma_f32_16x16x32_bf16 v[104:107], v[232:235], v[184:187], v[104:107]
ds_read_b64_tr_b16 v[224:225], v28 offset:32768
v_mfma_f32_16x16x32_bf16 v[108:111], v[232:235], v[188:191], v[108:111]
ds_read_b64_tr_b16 v[226:227], v28 offset:40960
v_lshlrev_b32 v240, 7, v240
v_mfma_f32_16x16x32_bf16 v[172:175], v[192:195], v[236:239], v[172:175]
ds_read_b64_tr_b16 v[228:229], v29 offset:32768
ds_read_b64_tr_b16 v[230:231], v29 offset:40960
s_waitcnt lgkmcnt(8)
v_mfma_f32_16x16x32_bf16 v[112:115], v[208:211], v[184:187], v[112:115]
ds_read_b128 v[232:235], v251 offset:896
v_mfma_f32_16x16x32_bf16 v[116:119], v[208:211], v[188:191], v[116:119]
v_mfma_f32_16x16x32_bf16 v[176:179], v[208:211], v[192:195], v[176:179]
v_mov_b32 v241, 1073741824
v_mfma_f32_16x16x32_bf16 v[120:123], v[184:187], v[212:215], v[120:123]
ds_read_b128 v[196:199], v14 offset:18944
v_mfma_f32_16x16x32_bf16 v[124:127], v[188:191], v[212:215], v[124:127]
ds_read_b128 v[200:203], v14 offset:20992
ds_read_b128 v[204:207], v15 offset:18944
ds_read_b64_tr_b16 v[236:237], v16 offset:49152
ds_read_b64_tr_b16 v[238:239], v16 offset:57344
s_waitcnt lgkmcnt(10)
v_mfma_f32_16x16x32_bf16 v[128:131], v[184:187], v[216:219], v[128:131]
ds_read_b64_tr_b16 v[208:209], v17 offset:49152
v_mfma_f32_16x16x32_bf16 v[132:135], v[188:191], v[216:219], v[132:135]
ds_read_b64_tr_b16 v[210:211], v17 offset:57344
v_cmp_gt_u32 vcc, 41, v0
v_mfma_f32_16x16x32_bf16 v[136:139], v[184:187], v[220:223], v[136:139]
ds_read_b64_tr_b16 v[212:213], v18 offset:49152
v_mfma_f32_16x16x32_bf16 v[140:143], v[188:191], v[220:223], v[140:143]
ds_read_b64_tr_b16 v[214:215], v18 offset:57344
s_waitcnt lgkmcnt(10)
v_mfma_f32_16x16x32_bf16 v[144:147], v[184:187], v[224:227], v[144:147]
ds_read_b64_tr_b16 v[216:217], v19 offset:49152
v_mfma_f32_16x16x32_bf16 v[148:151], v[188:191], v[224:227], v[148:151]
ds_read_b64_tr_b16 v[218:219], v19 offset:57344
v_cndmask_b32 v240, v241, v240, vcc
v_mfma_f32_16x16x32_bf16 v[152:155], v[184:187], v[228:231], v[152:155]
ds_read_b64_tr_b16 v[220:221], v30 offset:49152
v_mfma_f32_16x16x32_bf16 v[156:159], v[188:191], v[228:231], v[156:159]
ds_read_b64_tr_b16 v[222:223], v30 offset:57344
v_mfma_f32_16x16x32_bf16 v[180:183], v[192:195], v[228:231], v[180:183]
s_waitcnt lgkmcnt(8)
v_mfma_f32_16x16x32_bf16 v[160:163], v[232:235], v[184:187], v[160:163]
ds_read_b64_tr_b16 v[224:225], v20 offset:49152
v_mfma_f32_16x16x32_bf16 v[164:167], v[232:235], v[188:191], v[164:167]
ds_read_b64_tr_b16 v[226:227], v20 offset:57344
buffer_load_dword v252, v240, s[60:63], 0 offen
v_mfma_f32_16x16x32_bf16 v[48:51], v[236:239], v[196:199], v[48:51]
ds_read_b64_tr_b16 v[228:229], v21 offset:49152
v_mfma_f32_16x16x32_bf16 v[52:55], v[236:239], v[200:203], v[52:55]
ds_read_b64_tr_b16 v[230:231], v21 offset:57344
s_waitcnt lgkmcnt(8)
v_mfma_f32_16x16x32_bf16 v[56:59], v[208:211], v[196:199], v[56:59]
ds_read_b64_tr_b16 v[232:233], v22 offset:49152
v_mfma_f32_16x16x32_bf16 v[60:63], v[208:211], v[200:203], v[60:63]
ds_read_b64_tr_b16 v[234:235], v22 offset:57344
s_mul_i32 s7, s100, 81
v_mfma_f32_16x16x32_bf16 v[64:67], v[212:215], v[196:199], v[64:67]
ds_read_b64_tr_b16 v[236:237], v23 offset:49152
v_mfma_f32_16x16x32_bf16 v[68:71], v[212:215], v[200:203], v[68:71]
ds_read_b64_tr_b16 v[238:239], v23 offset:57344
s_waitcnt lgkmcnt(8)
v_mfma_f32_16x16x32_bf16 v[72:75], v[216:219], v[196:199], v[72:75]
ds_read_b64_tr_b16 v[208:209], v31 offset:49152
v_mfma_f32_16x16x32_bf16 v[76:79], v[216:219], v[200:203], v[76:79]
ds_read_b64_tr_b16 v[210:211], v31 offset:57344
s_add_u32 s7, s7, 41
v_mfma_f32_16x16x32_bf16 v[168:171], v[220:223], v[204:207], v[168:171]
ds_read_b64_tr_b16 v[212:213], v24 offset:49152
ds_read_b64_tr_b16 v[214:215], v24 offset:57344
s_waitcnt lgkmcnt(8)
v_mfma_f32_16x16x32_bf16 v[80:83], v[224:227], v[196:199], v[80:83]
ds_read_b64_tr_b16 v[216:217], v25 offset:49152
v_mfma_f32_16x16x32_bf16 v[84:87], v[224:227], v[200:203], v[84:87]
ds_read_b64_tr_b16 v[218:219], v25 offset:57344
v_add_u32 v240, s7, v0
v_mfma_f32_16x16x32_bf16 v[88:91], v[228:231], v[196:199], v[88:91]
ds_read_b64_tr_b16 v[220:221], v26 offset:49152
v_mfma_f32_16x16x32_bf16 v[92:95], v[228:231], v[200:203], v[92:95]
ds_read_b64_tr_b16 v[222:223], v26 offset:57344
s_waitcnt lgkmcnt(8)
v_mfma_f32_16x16x32_bf16 v[96:99], v[232:235], v[196:199], v[96:99]
ds_read_b64_tr_b16 v[224:225], v27 offset:49152
v_mfma_f32_16x16x32_bf16 v[100:103], v[232:235], v[200:203], v[100:103]
ds_read_b64_tr_b16 v[226:227], v27 offset:57344
v_lshlrev_b32 v240, 7, v240
v_mfma_f32_16x16x32_bf16 v[104:107], v[236:239], v[196:199], v[104:107]
ds_read_b64_tr_b16 v[228:229], v28 offset:49152
v_mfma_f32_16x16x32_bf16 v[108:111], v[236:239], v[200:203], v[108:111]
ds_read_b64_tr_b16 v[230:231], v28 offset:57344
s_waitcnt lgkmcnt(8)
v_mfma_f32_16x16x32_bf16 v[172:175], v[204:207], v[208:211], v[172:175]
ds_read_b64_tr_b16 v[232:233], v29 offset:49152
ds_read_b64_tr_b16 v[234:235], v29 offset:57344
v_mov_b32 v241, 1073741824
v_mfma_f32_16x16x32_bf16 v[112:115], v[212:215], v[196:199], v[112:115]
ds_read_b128 v[236:239], v251 offset:960
v_mfma_f32_16x16x32_bf16 v[116:119], v[212:215], v[200:203], v[116:119]
v_mfma_f32_16x16x32_bf16 v[176:179], v[212:215], v[204:207], v[176:179]
s_waitcnt lgkmcnt(7)
v_mfma_f32_16x16x32_bf16 v[120:123], v[196:199], v[216:219], v[120:123]
s_waitcnt vmcnt(1)
s_barrier
ds_read_b128 v[184:187], v14 offset:36864
v_mfma_f32_16x16x32_bf16 v[124:127], v[200:203], v[216:219], v[124:127]
ds_read_b128 v[188:191], v14 offset:38912
ds_read_b128 v[192:195], v15 offset:36864
ds_read_b64_tr_b16 v[208:209], v32 offset:0
ds_read_b64_tr_b16 v[210:211], v32 offset:8192
v_cmp_gt_u32 vcc, 40, v0
v_mfma_f32_16x16x32_bf16 v[128:131], v[196:199], v[220:223], v[128:131]
ds_read_b64_tr_b16 v[212:213], v33 offset:0
v_mfma_f32_16x16x32_bf16 v[132:135], v[200:203], v[220:223], v[132:135]
ds_read_b64_tr_b16 v[214:215], v33 offset:8192
s_waitcnt lgkmcnt(10)
v_mfma_f32_16x16x32_bf16 v[136:139], v[196:199], v[224:227], v[136:139]
ds_read_b64_tr_b16 v[216:217], v34 offset:0
v_mfma_f32_16x16x32_bf16 v[140:143], v[200:203], v[224:227], v[140:143]
ds_read_b64_tr_b16 v[218:219], v34 offset:8192
v_cndmask_b32 v240, v241, v240, vcc
v_mfma_f32_16x16x32_bf16 v[144:147], v[196:199], v[228:231], v[144:147]
ds_read_b64_tr_b16 v[220:221], v35 offset:0
v_mfma_f32_16x16x32_bf16 v[148:151], v[200:203], v[228:231], v[148:151]
ds_read_b64_tr_b16 v[222:223], v35 offset:8192
s_waitcnt lgkmcnt(11)
v_mfma_f32_16x16x32_bf16 v[152:155], v[196:199], v[232:235], v[152:155]
ds_read_b64_tr_b16 v[224:225], v46 offset:0
v_mfma_f32_16x16x32_bf16 v[156:159], v[200:203], v[232:235], v[156:159]
ds_read_b64_tr_b16 v[226:227], v46 offset:8192
v_mfma_f32_16x16x32_bf16 v[180:183], v[204:207], v[232:235], v[180:183]
buffer_load_dword v252, v240, s[60:63], 0 offen
v_mfma_f32_16x16x32_bf16 v[160:163], v[236:239], v[196:199], v[160:163]
ds_read_b64_tr_b16 v[228:229], v36 offset:0
v_mfma_f32_16x16x32_bf16 v[164:167], v[236:239], v[200:203], v[164:167]
ds_read_b64_tr_b16 v[230:231], v36 offset:8192
s_waitcnt lgkmcnt(8)
v_mfma_f32_16x16x32_bf16 v[48:51], v[208:211], v[184:187], v[48:51]
ds_read_b64_tr_b16 v[232:233], v37 offset:0
v_mfma_f32_16x16x32_bf16 v[52:55], v[208:211], v[188:191], v[52:55]
ds_read_b64_tr_b16 v[234:235], v37 offset:8192
s_mul_i32 s7, s100, 11
v_mfma_f32_16x16x32_bf16 v[56:59], v[212:215], v[184:187], v[56:59]
ds_read_b64_tr_b16 v[236:237], v38 offset:0
v_mfma_f32_16x16x32_bf16 v[60:63], v[212:215], v[188:191], v[60:63]
ds_read_b64_tr_b16 v[238:239], v38 offset:8192
s_waitcnt lgkmcnt(8)
v_mfma_f32_16x16x32_bf16 v[64:67], v[216:219], v[184:187], v[64:67]
ds_read_b64_tr_b16 v[208:209], v39 offset:0
v_mfma_f32_16x16x32_bf16 v[68:71], v[216:219], v[188:191], v[68:71]
ds_read_b64_tr_b16 v[210:211], v39 offset:8192
s_add_u32 s7, s7, 0
v_mfma_f32_16x16x32_bf16 v[72:75], v[220:223], v[184:187], v[72:75]
ds_read_b64_tr_b16 v[212:213], v47 offset:0
v_mfma_f32_16x16x32_bf16 v[76:79], v[220:223], v[188:191], v[76:79]
ds_read_b64_tr_b16 v[214:215], v47 offset:8192
s_waitcnt lgkmcnt(8)
v_mfma_f32_16x16x32_bf16 v[168:171], v[224:227], v[192:195], v[168:171]
ds_read_b64_tr_b16 v[216:217], v40 offset:0
ds_read_b64_tr_b16 v[218:219], v40 offset:8192
v_add_u32 v240, s7, v0
v_mfma_f32_16x16x32_bf16 v[80:83], v[228:231], v[184:187], v[80:83]
ds_read_b64_tr_b16 v[220:221], v41 offset:0
v_mfma_f32_16x16x32_bf16 v[84:87], v[228:231], v[188:191], v[84:87]
ds_read_b64_tr_b16 v[222:223], v41 offset:8192
s_waitcnt lgkmcnt(8)
v_mfma_f32_16x16x32_bf16 v[88:91], v[232:235], v[184:187], v[88:91]
ds_read_b64_tr_b16 v[224:225], v42 offset:0
v_mfma_f32_16x16x32_bf16 v[92:95], v[232:235], v[188:191], v[92:95]
ds_read_b64_tr_b16 v[226:227], v42 offset:8192
v_lshlrev_b32 v240, 7, v240
v_mfma_f32_16x16x32_bf16 v[96:99], v[236:239], v[184:187], v[96:99]
ds_read_b64_tr_b16 v[228:229], v43 offset:0
v_mfma_f32_16x16x32_bf16 v[100:103], v[236:239], v[188:191], v[100:103]
ds_read_b64_tr_b16 v[230:231], v43 offset:8192
s_waitcnt lgkmcnt(8)
v_mfma_f32_16x16x32_bf16 v[104:107], v[208:211], v[184:187], v[104:107]
ds_read_b64_tr_b16 v[232:233], v44 offset:0
v_mfma_f32_16x16x32_bf16 v[108:111], v[208:211], v[188:191], v[108:111]
ds_read_b64_tr_b16 v[234:235], v44 offset:8192
v_mov_b32 v241, 1073741824
v_mfma_f32_16x16x32_bf16 v[172:175], v[192:195], v[212:215], v[172:175]
ds_read_b64_tr_b16 v[236:237], v45 offset:0
ds_read_b64_tr_b16 v[238:239], v45 offset:8192
s_waitcnt lgkmcnt(8)
v_mfma_f32_16x16x32_bf16 v[112:115], v[216:219], v[184:187], v[112:115]
ds_read_b128 v[208:211], v251 offset:1024
v_mfma_f32_16x16x32_bf16 v[116:119], v[216:219], v[188:191], v[116:119]
v_mfma_f32_16x16x32_bf16 v[176:179], v[216:219], v[192:195], v[176:179]
v_cmp_gt_u32 vcc, 11, v0
v_mfma_f32_16x16x32_bf16 v[120:123], v[184:187], v[220:223], v[120:123]
ds_read_b128 v[196:199], v14 offset:37376
v_mfma_f32_16x16x32_bf16 v[124:127], v[188:191], v[220:223], v[124:127]
ds_read_b128 v[200:203], v14 offset:39424
ds_read_b128 v[204:207], v15 offset:37376
ds_read_b64_tr_b16 v[212:213], v32 offset:16384
ds_read_b64_tr_b16 v[214:215], v32 offset:24576
s_waitcnt lgkmcnt(10)
v_mfma_f32_16x16x32_bf16 v[128:131], v[184:187], v[224:227], v[128:131]
ds_read_b64_tr_b16 v[216:217], v33 offset:16384
v_mfma_f32_16x16x32_bf16 v[132:135], v[188:191], v[224:227], v[132:135]
ds_read_b64_tr_b16 v[218:219], v33 offset:24576
v_cndmask_b32 v240, v241, v240, vcc
v_mfma_f32_16x16x32_bf16 v[136:139], v[184:187], v[228:231], v[136:139]
ds_read_b64_tr_b16 v[220:221], v34 offset:16384
v_mfma_f32_16x16x32_bf16 v[140:143], v[188:191], v[228:231], v[140:143]
ds_read_b64_tr_b16 v[222:223], v34 offset:24576
s_waitcnt lgkmcnt(10)
v_mfma_f32_16x16x32_bf16 v[144:147], v[184:187], v[232:235], v[144:147]
ds_read_b64_tr_b16 v[224:225], v35 offset:16384
v_mfma_f32_16x16x32_bf16 v[148:151], v[188:191], v[232:235], v[148:151]
ds_read_b64_tr_b16 v[226:227], v35 offset:24576
buffer_load_dword v252, v240, s[64:67], 0 offen
v_mfma_f32_16x16x32_bf16 v[152:155], v[184:187], v[236:239], v[152:155]
ds_read_b64_tr_b16 v[228:229], v46 offset:16384
v_mfma_f32_16x16x32_bf16 v[156:159], v[188:191], v[236:239], v[156:159]
ds_read_b64_tr_b16 v[230:231], v46 offset:24576
v_mfma_f32_16x16x32_bf16 v[180:183], v[192:195], v[236:239], v[180:183]
s_waitcnt lgkmcnt(8)
v_mfma_f32_16x16x32_bf16 v[160:163], v[208:211], v[184:187], v[160:163]
ds_read_b64_tr_b16 v[232:233], v36 offset:16384
v_mfma_f32_16x16x32_bf16 v[164:167], v[208:211], v[188:191], v[164:167]
ds_read_b64_tr_b16 v[234:235], v36 offset:24576
v_mfma_f32_16x16x32_bf16 v[48:51], v[212:215], v[196:199], v[48:51]
ds_read_b64_tr_b16 v[236:237], v37 offset:16384
v_mfma_f32_16x16x32_bf16 v[52:55], v[212:215], v[200:203], v[52:55]
ds_read_b64_tr_b16 v[238:239], v37 offset:24576
s_waitcnt lgkmcnt(8)
v_mfma_f32_16x16x32_bf16 v[56:59], v[216:219], v[196:199], v[56:59]
ds_read_b64_tr_b16 v[208:209], v38 offset:16384
v_mfma_f32_16x16x32_bf16 v[60:63], v[216:219], v[200:203], v[60:63]
ds_read_b64_tr_b16 v[210:211], v38 offset:24576
s_lshr_b32 s22, s100, 2
v_mfma_f32_16x16x32_bf16 v[64:67], v[220:223], v[196:199], v[64:67]
ds_read_b64_tr_b16 v[212:213], v39 offset:16384
v_mfma_f32_16x16x32_bf16 v[68:71], v[220:223], v[200:203], v[68:71]
ds_read_b64_tr_b16 v[214:215], v39 offset:24576
s_waitcnt lgkmcnt(8)
v_mfma_f32_16x16x32_bf16 v[72:75], v[224:227], v[196:199], v[72:75]
ds_read_b64_tr_b16 v[216:217], v47 offset:16384
v_mfma_f32_16x16x32_bf16 v[76:79], v[224:227], v[200:203], v[76:79]
ds_read_b64_tr_b16 v[218:219], v47 offset:24576
v_mfma_f32_16x16x32_bf16 v[168:171], v[228:231], v[204:207], v[168:171]
ds_read_b64_tr_b16 v[220:221], v40 offset:16384
ds_read_b64_tr_b16 v[222:223], v40 offset:24576
s_waitcnt lgkmcnt(8)
v_mfma_f32_16x16x32_bf16 v[80:83], v[232:235], v[196:199], v[80:83]
ds_read_b64_tr_b16 v[224:225], v41 offset:16384
v_mfma_f32_16x16x32_bf16 v[84:87], v[232:235], v[200:203], v[84:87]
ds_read_b64_tr_b16 v[226:227], v41 offset:24576
v_mfma_f32_16x16x32_bf16 v[88:91], v[236:239], v[196:199], v[88:91]
ds_read_b64_tr_b16 v[228:229], v42 offset:16384
v_mfma_f32_16x16x32_bf16 v[92:95], v[236:239], v[200:203], v[92:95]
ds_read_b64_tr_b16 v[230:231], v42 offset:24576
s_waitcnt lgkmcnt(8)
v_mfma_f32_16x16x32_bf16 v[96:99], v[208:211], v[196:199], v[96:99]
ds_read_b64_tr_b16 v[232:233], v43 offset:16384
v_mfma_f32_16x16x32_bf16 v[100:103], v[208:211], v[200:203], v[100:103]
ds_read_b64_tr_b16 v[234:235], v43 offset:24576
v_mfma_f32_16x16x32_bf16 v[104:107], v[212:215], v[196:199], v[104:107]
ds_read_b64_tr_b16 v[236:237], v44 offset:16384
v_mfma_f32_16x16x32_bf16 v[108:111], v[212:215], v[200:203], v[108:111]
ds_read_b64_tr_b16 v[238:239], v44 offset:24576
s_waitcnt lgkmcnt(8)
v_mfma_f32_16x16x32_bf16 v[172:175], v[204:207], v[216:219], v[172:175]
ds_read_b64_tr_b16 v[208:209], v45 offset:16384
ds_read_b64_tr_b16 v[210:211], v45 offset:24576
s_cmp_lt_u32 s22, 72
s_cselect_b32 s22, s22, 0x800000
v_mfma_f32_16x16x32_bf16 v[112:115], v[220:223], v[196:199], v[112:115]
ds_read_b128 v[212:215], v251 offset:1088
v_mfma_f32_16x16x32_bf16 v[116:119], v[220:223], v[200:203], v[116:119]
v_mfma_f32_16x16x32_bf16 v[176:179], v[220:223], v[204:207], v[176:179]
v_lshrrev_b32 v240, 3, v0
s_waitcnt lgkmcnt(7)
v_mfma_f32_16x16x32_bf16 v[120:123], v[196:199], v[224:227], v[120:123]
v_mfma_f32_16x16x32_bf16 v[124:127], v[200:203], v[224:227], v[124:127]
s_mul_i32 s7, s3, 144
v_mfma_f32_16x16x32_bf16 v[128:131], v[196:199], v[228:231], v[128:131]
v_mfma_f32_16x16x32_bf16 v[132:135], v[200:203], v[228:231], v[132:135]
v_add_u32 v240, s7, v240
s_waitcnt lgkmcnt(3)
v_mfma_f32_16x16x32_bf16 v[136:139], v[196:199], v[232:235], v[136:139]
v_mfma_f32_16x16x32_bf16 v[140:143], v[200:203], v[232:235], v[140:143]
v_mul_u32_u24 v240, 9216, v240
v_and_b32 v241, 7, v0
v_mfma_f32_16x16x32_bf16 v[144:147], v[196:199], v[236:239], v[144:147]
v_mfma_f32_16x16x32_bf16 v[148:151], v[200:203], v[236:239], v[148:151]
v_lshl_add_u32 v250, v241, 4, v240
s_waitcnt lgkmcnt(0)
v_mfma_f32_16x16x32_bf16 v[152:155], v[196:199], v[208:211], v[152:155]
v_mfma_f32_16x16x32_bf16 v[156:159], v[200:203], v[208:211], v[156:159]
v_mfma_f32_16x16x32_bf16 v[180:183], v[204:207], v[208:211], v[180:183]
s_lshl_b32 s99, s22, 7
v_mfma_f32_16x16x32_bf16 v[160:163], v[212:215], v[196:199], v[160:163]
v_mfma_f32_16x16x32_bf16 v[164:167], v[212:215], v[200:203], v[164:167]
s_barrier
s_mov_b32 s84, 0xffff
s_mov_b32 s85, 0
s_mov_b32 s86, 0xffff0000
s_mov_b32 s87, 0
v_lshlrev_b32 v40, 3, v0
s_lshl_b32 s7, s3, 9
v_add_u32 v41, s7, v40
s_mul_i32 s7, s3, 5120
v_add_u32 v42, s7, v40
v_cvt_pk_bf16_f32 v168, v168, v169
buffer_load_dwordx4 a[0:3], v250, s[56:59], s99 offen
s_add_u32 s99, s99, 73728
v_cvt_pk_bf16_f32 v169, v170, v171
v_cvt_pk_bf16_f32 v172, v172, v173
v_cvt_pk_bf16_f32 v173, v174, v175
v_cvt_pk_bf16_f32 v176, v176, v177
v_cvt_pk_bf16_f32 v177, v178, v179
v_cvt_pk_bf16_f32 v180, v180, v181
v_cvt_pk_bf16_f32 v181, v182, v183
v_mov_b32 v178, v176
v_mov_b32 v179, v177
s_nop 0
v_permlane32_swap_b32 v176, v178
v_permlane32_swap_b32 v177, v179
ds_write_b64 v41, v[168:169]
buffer_load_dwordx4 a[4:7], v250, s[56:59], s99 offen
s_add_u32 s99, s99, 73728
ds_write_b64 v41, v[172:173] offset:2560
ds_write_b64 v40, v[178:179] offset:2048
ds_write_b64 v40, v[180:181] offset:4608
v_cvt_pk_bf16_f32 v116, v116, v117
v_cvt_pk_bf16_f32 v117, v118, v119
v_mov_b32 v118, v116
v_mov_b32 v119, v117
s_nop 0
v_permlane32_swap_b32 v116, v118
v_permlane32_swap_b32 v117, v119
v_cvt_pk_bf16_f32 v84, v84, v85
v_cvt_pk_bf16_f32 v85, v86, v87
v_mov_b32 v86, v118
buffer_load_dwordx4 a[8:11], v250, s[56:59], s99 offen
s_add_u32 s99, s99, 73728
v_mov_b32 v87, v119
ds_write_b64 v42, v[84:85] offset:5120
v_cvt_pk_bf16_f32 v92, v92, v93
v_cvt_pk_bf16_f32 v93, v94, v95
v_mov_b32 v94, v118
v_mov_b32 v95, v119
ds_write_b64 v42, v[92:93] offset:5632
v_cvt_pk_bf16_f32 v100, v100, v101
v_cvt_pk_bf16_f32 v101, v102, v103
v_mov_b32 v102, v118
v_mov_b32 v103, v119
ds_write_b64 v42, v[100:101] offset:6144
buffer_load_dwordx4 a[12:15], v250, s[56:59], s99 offen
s_add_u32 s99, s99, 73728
v_cvt_pk_bf16_f32 v108, v108, v109
v_cvt_pk_bf16_f32 v109, v110, v111
v_mov_b32 v110, v118
v_mov_b32 v111, v119
ds_write_b64 v42, v[108:109] offset:6656
ds_write_b64 v42, v[118:119] offset:7168
v_cvt_pk_bf16_f32 v112, v112, v113
v_cvt_pk_bf16_f32 v113, v114, v115
v_mov_b32 v114, v112
v_mov_b32 v115, v113
s_nop 0
v_permlane32_swap_b32 v112, v114
v_permlane32_swap_b32 v113, v115
buffer_load_dwordx4 a[16:19], v250, s[56:59], s99 offen
s_add_u32 s99, s99, 73728
v_cvt_pk_bf16_f32 v80, v80, v81
v_cvt_pk_bf16_f32 v81, v82, v83
v_mov_b32 v82, v114
v_mov_b32 v83, v115
v_cvt_pk_bf16_f32 v88, v88, v89
v_cvt_pk_bf16_f32 v89, v90, v91
v_mov_b32 v90, v114
v_mov_b32 v91, v115
v_cvt_pk_bf16_f32 v96, v96, v97
v_cvt_pk_bf16_f32 v97, v98, v99
v_mov_b32 v98, v114
v_mov_b32 v99, v115
buffer_load_dwordx4 a[20:23], v250, s[56:59], s99 offen
s_add_u32 s99, s99, 73728
v_cvt_pk_bf16_f32 v104, v104, v105
v_cvt_pk_bf16_f32 v105, v106, v107
v_mov_b32 v106, v114
v_mov_b32 v107, v115
v_cvt_pk_bf16_f32 v124, v124, v125
v_cvt_pk_bf16_f32 v125, v126, v127
ds_write_b64 v42, v[124:125] offset:7680
v_cvt_pk_bf16_f32 v123, v122, v123
v_cvt_pk_bf16_f32 v122, v120, v121
v_cvt_pk_bf16_f32 v132, v132, v133
v_cvt_pk_bf16_f32 v133, v134, v135
ds_write_b64 v42, v[132:133] offset:8192
buffer_load_dwordx4 a[24:27], v250, s[56:59], s99 offen
s_add_u32 s99, s99, 73728
v_cvt_pk_bf16_f32 v131, v130, v131
v_cvt_pk_bf16_f32 v130, v128, v129
v_cvt_pk_bf16_f32 v140, v140, v141
v_cvt_pk_bf16_f32 v141, v142, v143
ds_write_b64 v42, v[140:141] offset:8704
v_cvt_pk_bf16_f32 v139, v138, v139
v_cvt_pk_bf16_f32 v138, v136, v137
v_cvt_pk_bf16_f32 v148, v148, v149
v_cvt_pk_bf16_f32 v149, v150, v151
ds_write_b64 v42, v[148:149] offset:9216
v_cvt_pk_bf16_f32 v147, v146, v147
v_cvt_pk_bf16_f32 v146, v144, v145
buffer_load_dwordx4 a[28:31], v250, s[56:59], s99 offen
s_add_u32 s99, s99, 73728
v_cvt_pk_bf16_f32 v156, v156, v157
v_cvt_pk_bf16_f32 v157, v158, v159
ds_write_b64 v42, v[156:157] offset:9728
v_cvt_pk_bf16_f32 v155, v154, v155
v_cvt_pk_bf16_f32 v154, v152, v153
s_waitcnt lgkmcnt(0)
s_barrier
ds_read_b64 v[16:17], v42 offset:0
ds_read_b64 v[18:19], v42 offset:2048
ds_read_b64 v[20:21], v42 offset:512
ds_read_b64 v[22:23], v42 offset:2048
ds_read_b64 v[24:25], v42 offset:1024
ds_read_b64 v[26:27], v42 offset:2048
buffer_load_dwordx4 a[32:35], v250, s[56:59], s99 offen
s_add_u32 s99, s99, 73728
ds_read_b64 v[28:29], v42 offset:1536
ds_read_b64 v[30:31], v42 offset:2048
ds_read_b64 v[120:121], v42 offset:2560
ds_read_b64 v[128:129], v42 offset:3072
ds_read_b64 v[136:137], v42 offset:3584
ds_read_b64 v[144:145], v42 offset:4096
ds_read_b64 v[152:153], v42 offset:4608
v_cvt_pk_bf16_f32 v48, v48, v49
v_cvt_pk_bf16_f32 v49, v50, v51
v_cndmask_b32 v50, 0, v112, s[84:85]
v_mov_b32 v51, 0
v_cvt_pk_bf16_f32 v56, v56, v57
buffer_load_dwordx4 a[36:39], v250, s[56:59], s99 offen
s_add_u32 s99, s99, 73728
v_cvt_pk_bf16_f32 v57, v58, v59
v_mov_b32 v58, 0
v_cndmask_b32 v59, 0, v113, s[84:85]
v_cvt_pk_bf16_f32 v64, v64, v65
v_cvt_pk_bf16_f32 v65, v66, v67
v_cndmask_b32 v66, 0, v112, s[86:87]
v_mov_b32 v67, 0
v_cvt_pk_bf16_f32 v72, v72, v73
v_cvt_pk_bf16_f32 v73, v74, v75
v_mov_b32 v74, 0
v_cndmask_b32 v75, 0, v113, s[86:87]
v_cvt_pk_bf16_f32 v52, v52, v53
buffer_load_dwordx4 a[40:43], v250, s[56:59], s99 offen
s_add_u32 s99, s99, 73728
v_cvt_pk_bf16_f32 v53, v54, v55
v_cndmask_b32 v54, 0, v116, s[84:85]
v_mov_b32 v55, 0
v_cvt_pk_bf16_f32 v60, v60, v61
v_cvt_pk_bf16_f32 v61, v62, v63
v_mov_b32 v62, 0
v_cndmask_b32 v63, 0, v117, s[84:85]
v_cvt_pk_bf16_f32 v68, v68, v69
v_cvt_pk_bf16_f32 v69, v70, v71
v_cndmask_b32 v70, 0, v116, s[86:87]
v_mov_b32 v71, 0
v_cvt_pk_bf16_f32 v76, v76, v77
buffer_load_dwordx4 a[44:47], v250, s[56:59], s99 offen
s_add_u32 s99, s99, 73728
v_cvt_pk_bf16_f32 v77, v78, v79
v_mov_b32 v78, 0
v_cndmask_b32 v79, 0, v117, s[86:87]
v_cvt_pk_bf16_f32 v160, v160, v160
v_and_b32 v160, 0xffff0000, v160
v_mul_f32 v160, 0xbfb8aa3b, v160
v_exp_f32 v160, v160
s_nop 0
v_add_f32 v160, 1.0, v160
v_rcp_f32 v160, v160
s_nop 0
v_cvt_pk_bf16_f32 v160, v160, v160
v_and_b32 v160, 0xffff0000, v160
v_sub_f32 v161, 1.0, v160
buffer_load_dwordx4 a[48:51], v250, s[56:59], s99 offen
s_add_u32 s99, s99, 73728
v_cvt_pk_bf16_f32 v161, v161, v161
v_and_b32 v161, 0xffff0000, v161
v_cvt_pk_bf16_f32 v164, v164, v164
v_and_b32 v164, 0xffff0000, v164
v_mul_f32 v164, 0xbfb8aa3b, v164
v_exp_f32 v164, v164
s_nop 0
v_add_f32 v164, 1.0, v164
v_rcp_f32 v164, v164
s_nop 0
v_cvt_pk_bf16_f32 v164, v164, v164
v_and_b32 v164, 0xffff0000, v164
v_sub_f32 v165, 1.0, v164
v_cvt_pk_bf16_f32 v165, v165, v165
buffer_load_dwordx4 a[52:55], v250, s[56:59], s99 offen
s_add_u32 s99, s99, 73728
v_and_b32 v165, 0xffff0000, v165
v_and_b32 v240, 15, v0
v_lshrrev_b32 v241, 4, v0
v_and_b32 v242, 1, v0
v_lshl_add_u32 v243, v241, 2, v242
v_add_u32 v244, 2, v243
v_cmp_eq_u32 s[88:89], 1, v242
v_cmp_le_u32 s[90:91], v243, v240
v_cmp_le_u32 s[92:93], v244, v240
v_mov_b32 v245, 0x0c0c0100
v_mov_b32 v246, 0x01000c0c
v_cndmask_b32 v245, v245, v246, s[88:89]
buffer_load_dwordx4 a[56:59], v250, s[56:59], s99 offen
s_add_u32 s99, s99, 73728
v_mov_b32 v246, 0x0c0c0302
v_mov_b32 v247, 0x03020c0c
v_cndmask_b32 v246, v246, v247, s[88:89]
v_mov_b32 v247, 0x0c0c0c0c
v_cndmask_b32 v32, v245, v247, s[90:91]
v_cndmask_b32 v33, v246, v247, s[92:93]
v_cndmask_b32 v34, v247, v245, s[90:91]
v_cndmask_b32 v35, v247, v246, s[92:93]
s_cmp_eq_u32 s16, 0
s_cselect_b32 s7, 0xff800000, 0
v_mov_b32 v245, s7
v_cndmask_b32 v36, v245, 0, s[90:91]
buffer_load_dwordx4 a[60:63], v250, s[56:59], s99 offen
s_add_u32 s99, s99, 73728
v_cndmask_b32 v37, v245, 0, s[92:93]
v_lshrrev_b32 v242, 1, v241
v_and_b32 v243, 1, v241
v_lshlrev_b32 v244, 4, v240
v_lshl_add_u32 v244, v243, 3, v244
v_lshl_add_u32 v43, v242, 9, v244
v_lshlrev_b32 v242, 3, v240
v_mov_b32 v243, 1073741824
v_cndmask_b32 v44, v243, v242, s[84:85]
v_cndmask_b32 v45, v243, v242, s[86:87]
s_lshl_b32 s7, s13, 3
s_add_u32 s7, s7, s3
buffer_load_dwordx4 a[64:67], v250, s[56:59], s99 offen
s_add_u32 s99, s99, 73728
s_mul_i32 s20, s7, 2304
s_add_u32 s20, s20, 458752
s_add_u32 s21, s20, 9216
v_mov_b32 v248, 0x3eae1a93
s_waitcnt lgkmcnt(11)
v_mfma_f32_16x16x32_bf16 v[184:187], v[16:19], v[48:51], 0
v_mfma_f32_16x16x32_bf16 v[188:191], v[80:83], v[48:51], 0
s_waitcnt lgkmcnt(9)
v_mfma_f32_16x16x32_bf16 v[192:195], v[20:23], v[56:59], 0
v_mfma_f32_16x16x32_bf16 v[196:199], v[88:91], v[56:59], 0
s_waitcnt lgkmcnt(7)
v_mfma_f32_16x16x32_bf16 v[200:203], v[24:27], v[64:67], 0
v_mfma_f32_16x16x32_bf16 v[204:207], v[96:99], v[64:67], 0
s_waitcnt lgkmcnt(5)
v_mfma_f32_16x16x32_bf16 v[208:211], v[28:31], v[72:75], 0
v_mfma_f32_16x16x32_bf16 v[212:215], v[104:107], v[72:75], 0
buffer_load_dwordx4 a[68:71], v250, s[56:59], s99 offen
s_add_u32 s99, s99, 73728
v_cndmask_b32 v232, v184, v185, s[88:89]
v_cndmask_b32 v236, v192, v193, s[88:89]
v_cndmask_b32 v240, v200, v201, s[88:89]
s_nop 1
v_cndmask_b32 v244, v208, v209, s[88:89]
v_cndmask_b32 v234, v188, v189, s[88:89]
v_cndmask_b32 v238, v196, v197, s[88:89]
v_cndmask_b32 v242, v204, v205, s[88:89]
v_cndmask_b32 v246, v212, v213, s[88:89]
v_cndmask_b32 v233, v186, v187, s[88:89]
v_cndmask_b32 v237, v194, v195, s[88:89]
v_cndmask_b32 v241, v202, v203, s[88:89]
v_cndmask_b32 v245, v210, v211, s[88:89]
v_cndmask_b32 v235, v190, v191, s[88:89]
v_cndmask_b32 v239, v198, v199, s[88:89]
v_cndmask_b32 v243, v206, v207, s[88:89]
v_cndmask_b32 v247, v214, v215, s[88:89]
v_cndmask_b32 v232, v232, v234, s[90:91]
v_cndmask_b32 v236, v236, v238, s[90:91]
v_cndmask_b32 v240, v240, v242, s[90:91]
v_cndmask_b32 v244, v244, v246, s[90:91]
v_cndmask_b32 v233, v233, v235, s[92:93]
v_cndmask_b32 v237, v237, v239, s[92:93]
v_cndmask_b32 v241, v241, v243, s[92:93]
v_cndmask_b32 v245, v245, v247, s[92:93]
v_fma_f32 v232, v232, v248, v36
v_fma_f32 v236, v236, v248, v36
v_fma_f32 v240, v240, v248, v36
v_fma_f32 v244, v244, v248, v36
v_fma_f32 v233, v233, v248, v37
v_fma_f32 v237, v237, v248, v37
v_fma_f32 v241, v241, v248, v37
v_fma_f32 v245, v245, v248, v37
v_max_f32 v234, v232, v233
v_max_f32 v238, v236, v237
v_max_f32 v242, v240, v241
v_max_f32 v246, v244, v245
v_mov_b32 v235, v234
v_mov_b32 v239, v238
v_mov_b32 v243, v242
v_mov_b32 v247, v246
v_permlane32_swap_b32 v234, v235
v_permlane32_swap_b32 v238, v239
v_permlane32_swap_b32 v242, v243
v_permlane32_swap_b32 v246, v247
v_max_f32 v234, v234, v235
v_max_f32 v238, v238, v239
v_max_f32 v242, v242, v243
v_max_f32 v246, v246, v247
v_mov_b32 v235, v234
v_mov_b32 v239, v238
v_mov_b32 v243, v242
v_mov_b32 v247, v246
v_permlane16_swap_b32 v234, v235
v_permlane16_swap_b32 v238, v239
v_permlane16_swap_b32 v242, v243
v_permlane16_swap_b32 v246, v247
v_max_f32 v234, v234, v235
v_max_f32 v238, v238, v239
v_max_f32 v242, v242, v243
v_max_f32 v246, v246, v247
v_sub_f32 v232, v232, v234
v_sub_f32 v236, v236, v238
v_sub_f32 v240, v240, v242
v_sub_f32 v244, v244, v246
v_sub_f32 v233, v233, v234
v_sub_f32 v237, v237, v238
v_sub_f32 v241, v241, v242
v_sub_f32 v245, v245, v246
v_exp_f32 v232, v232
v_exp_f32 v236, v236
v_exp_f32 v240, v240
v_exp_f32 v244, v244
v_exp_f32 v233, v233
v_exp_f32 v237, v237
v_exp_f32 v241, v241
v_exp_f32 v245, v245
v_add_f32 v234, v232, v233
v_add_f32 v238, v236, v237
v_add_f32 v242, v240, v241
v_add_f32 v246, v244, v245
v_mov_b32 v235, v234
v_mov_b32 v239, v238
v_mov_b32 v243, v242
v_mov_b32 v247, v246
v_permlane32_swap_b32 v234, v235
v_permlane32_swap_b32 v238, v239
v_permlane32_swap_b32 v242, v243
v_permlane32_swap_b32 v246, v247
v_add_f32 v234, v234, v235
v_add_f32 v238, v238, v239
v_add_f32 v242, v242, v243
v_add_f32 v246, v246, v247
v_mov_b32 v235, v234
v_mov_b32 v239, v238
v_mov_b32 v243, v242
v_mov_b32 v247, v246
v_permlane16_swap_b32 v234, v235
v_permlane16_swap_b32 v238, v239
v_permlane16_swap_b32 v242, v243
v_permlane16_swap_b32 v246, v247
v_add_f32 v234, v234, v235
v_add_f32 v238, v238, v239
v_add_f32 v242, v242, v243
v_add_f32 v246, v246, v247
v_rcp_f32 v234, v234
v_rcp_f32 v238, v238
v_rcp_f32 v242, v242
v_rcp_f32 v246, v246
v_mul_f32 v232, v232, v234
v_mul_f32 v236, v236, v238
v_mul_f32 v240, v240, v242
v_mul_f32 v244, v244, v246
v_mul_f32 v233, v233, v234
v_mul_f32 v237, v237, v238
v_mul_f32 v241, v241, v242
v_mul_f32 v245, v245, v246
v_cvt_pk_bf16_f32 v234, v232, v233
v_cvt_pk_bf16_f32 v238, v236, v237
v_cvt_pk_bf16_f32 v242, v240, v241
v_cvt_pk_bf16_f32 v246, v244, v245
v_perm_b32 v216, v234, v234, v32
v_perm_b32 v220, v238, v238, v32
v_perm_b32 v224, v242, v242, v32
v_perm_b32 v228, v246, v246, v32
v_perm_b32 v217, v234, v234, v33
v_perm_b32 v221, v238, v238, v33
v_perm_b32 v225, v242, v242, v33
v_perm_b32 v229, v246, v246, v33
v_perm_b32 v218, v234, v234, v34
v_perm_b32 v222, v238, v238, v34
v_perm_b32 v226, v242, v242, v34
v_perm_b32 v230, v246, v246, v34
v_perm_b32 v219, v234, v234, v35
v_perm_b32 v223, v238, v238, v35
v_perm_b32 v227, v242, v242, v35
v_perm_b32 v231, v246, v246, v35
s_waitcnt lgkmcnt(4)
v_mfma_f32_16x16x32_bf16 v[184:187], v[120:123], v[216:219], 0
s_waitcnt lgkmcnt(0)
v_mfma_f32_16x16x32_bf16 v[188:191], v[152:155], v[216:219], 0
v_mfma_f32_16x16x32_bf16 v[192:195], v[128:131], v[220:223], 0
v_mfma_f32_16x16x32_bf16 v[196:199], v[152:155], v[220:223], 0
v_mfma_f32_16x16x32_bf16 v[200:203], v[136:139], v[224:227], 0
v_mfma_f32_16x16x32_bf16 v[204:207], v[152:155], v[224:227], 0
v_mfma_f32_16x16x32_bf16 v[208:211], v[144:147], v[228:231], 0
v_mfma_f32_16x16x32_bf16 v[212:215], v[152:155], v[228:231], 0
v_mul_f32 v184, v184, v160
v_mul_f32 v185, v185, v160
v_mul_f32 v186, v186, v160
v_mul_f32 v187, v187, v160
v_mul_f32 v188, v188, v160
v_mul_f32 v189, v189, v160
v_cvt_pk_bf16_f32 v232, v184, v185
v_cvt_pk_bf16_f32 v233, v186, v187
v_cvt_pk_bf16_f32 v234, v188, v189
buffer_store_dwordx2 v[232:233], v43, s[72:75], s20 offen offset:0 sc1
v_mul_f32 v192, v192, v160
v_mul_f32 v193, v193, v160
v_mul_f32 v194, v194, v160
v_mul_f32 v195, v195, v160
v_mul_f32 v198, v198, v160
v_mul_f32 v199, v199, v160
v_cvt_pk_bf16_f32 v236, v192, v193
v_cvt_pk_bf16_f32 v237, v194, v195
v_cvt_pk_bf16_f32 v235, v198, v199
buffer_store_dwordx2 v[236:237], v43, s[72:75], s20 offen offset:1024 sc1
buffer_store_dwordx2 v[234:235], v44, s[72:75], s20 offen offset:2048 sc1
v_mul_f32 v200, v200, v160
v_mul_f32 v201, v201, v160
v_mul_f32 v202, v202, v160
v_mul_f32 v203, v203, v160
v_mul_f32 v204, v204, v160
v_mul_f32 v205, v205, v160
v_cvt_pk_bf16_f32 v240, v200, v201
v_cvt_pk_bf16_f32 v241, v202, v203
v_cvt_pk_bf16_f32 v242, v204, v205
buffer_store_dwordx2 v[240:241], v43, s[72:75], s21 offen offset:0 sc1
v_mul_f32 v208, v208, v160
v_mul_f32 v209, v209, v160
v_mul_f32 v210, v210, v160
v_mul_f32 v211, v211, v160
v_mul_f32 v214, v214, v160
v_mul_f32 v215, v215, v160
v_cvt_pk_bf16_f32 v244, v208, v209
v_cvt_pk_bf16_f32 v245, v210, v211
v_cvt_pk_bf16_f32 v243, v214, v215
buffer_store_dwordx2 v[244:245], v43, s[72:75], s21 offen offset:1024 sc1
buffer_store_dwordx2 v[242:243], v45, s[72:75], s21 offen offset:2048 sc1
s_lshl_b32 s7, s3, 8
s_add_u32 s7, s7, 8192
s_cmp_eq_u32 s13, 0
s_cselect_b32 s7, s7, 1073741824
buffer_store_dwordx2 v[160:161], v44, s[72:75], s7 offen sc1
v_mfma_f32_16x16x32_bf16 v[184:187], v[80:83], v[52:55], 0
v_mfma_f32_16x16x32_bf16 v[188:191], v[84:87], v[52:55], 0
v_mfma_f32_16x16x32_bf16 v[192:195], v[88:91], v[60:63], 0
v_mfma_f32_16x16x32_bf16 v[196:199], v[92:95], v[60:63], 0
v_mfma_f32_16x16x32_bf16 v[200:203], v[96:99], v[68:71], 0
v_mfma_f32_16x16x32_bf16 v[204:207], v[100:103], v[68:71], 0
v_mfma_f32_16x16x32_bf16 v[208:211], v[104:107], v[76:79], 0
v_mfma_f32_16x16x32_bf16 v[212:215], v[108:111], v[76:79], 0
v_mov_b32 v244, 4
buffer_load_dword v254, v244, s[80:83], 0 offen sc1
v_and_b32 v240, 15, v0
v_lshrrev_b32 v241, 1, v240
v_and_b32 v242, 1, v0
v_lshlrev_b32 v242, 4, v242
v_mov_b32 v243, 0x3f80
v_lshlrev_b32 v242, v242, v243
v_cmp_eq_u32 vcc, 0, v241
s_nop 1
v_cndmask_b32 v20, 0, v242, vcc
v_cmp_eq_u32 vcc, 1, v241
s_nop 1
v_cndmask_b32 v21, 0, v242, vcc
v_cmp_eq_u32 vcc, 2, v241
s_nop 1
v_cndmask_b32 v22, 0, v242, vcc
v_cmp_eq_u32 vcc, 3, v241
s_nop 1
v_cndmask_b32 v23, 0, v242, vcc
v_cndmask_b32 v232, v184, v185, s[88:89]
v_cndmask_b32 v236, v192, v193, s[88:89]
v_cndmask_b32 v240, v200, v201, s[88:89]
v_cndmask_b32 v244, v208, v209, s[88:89]
v_cndmask_b32 v234, v188, v189, s[88:89]
v_cndmask_b32 v238, v196, v197, s[88:89]
v_cndmask_b32 v242, v204, v205, s[88:89]
v_cndmask_b32 v246, v212, v213, s[88:89]
v_cndmask_b32 v233, v186, v187, s[88:89]
v_cndmask_b32 v237, v194, v195, s[88:89]
v_cndmask_b32 v241, v202, v203, s[88:89]
v_cndmask_b32 v245, v210, v211, s[88:89]
v_cndmask_b32 v235, v190, v191, s[88:89]
v_cndmask_b32 v239, v198, v199, s[88:89]
v_cndmask_b32 v243, v206, v207, s[88:89]
v_cndmask_b32 v247, v214, v215, s[88:89]
v_cndmask_b32 v232, v232, v234, s[90:91]
v_cndmask_b32 v236, v236, v238, s[90:91]
v_cndmask_b32 v240, v240, v242, s[90:91]
v_cndmask_b32 v244, v244, v246, s[90:91]
s_waitcnt vmcnt(25)
v_mfma_f32_16x16x32_bf16 v[24:27], v[20:23], a[0:3], 0
v_cndmask_b32 v233, v233, v235, s[92:93]
v_cndmask_b32 v237, v237, v239, s[92:93]
v_cndmask_b32 v241, v241, v243, s[92:93]
v_cndmask_b32 v245, v245, v247, s[92:93]
s_waitcnt vmcnt(24)
v_mfma_f32_16x16x32_bf16 v[24:27], v[20:23], a[4:7], v[24:27]
v_fma_f32 v232, v232, v248, 0
v_fma_f32 v236, v236, v248, 0
v_fma_f32 v240, v240, v248, 0
v_fma_f32 v244, v244, v248, 0
s_waitcnt vmcnt(23)
v_mfma_f32_16x16x32_bf16 v[24:27], v[20:23], a[8:11], v[24:27]
v_fma_f32 v233, v233, v248, 0
v_fma_f32 v237, v237, v248, 0
v_fma_f32 v241, v241, v248, 0
v_fma_f32 v245, v245, v248, 0
s_waitcnt vmcnt(22)
v_mfma_f32_16x16x32_bf16 v[24:27], v[20:23], a[12:15], v[24:27]
v_max_f32 v234, v232, v233
v_max_f32 v238, v236, v237
v_max_f32 v242, v240, v241
v_max_f32 v246, v244, v245
s_waitcnt vmcnt(21)
v_mfma_f32_16x16x32_bf16 v[24:27], v[20:23], a[16:19], v[24:27]
v_mov_b32 v235, v234
v_mov_b32 v239, v238
v_mov_b32 v243, v242
v_mov_b32 v247, v246
s_waitcnt vmcnt(20)
v_mfma_f32_16x16x32_bf16 v[24:27], v[20:23], a[20:23], v[24:27]
v_permlane32_swap_b32 v234, v235
v_permlane32_swap_b32 v238, v239
v_permlane32_swap_b32 v242, v243
v_permlane32_swap_b32 v246, v247
s_waitcnt vmcnt(19)
v_mfma_f32_16x16x32_bf16 v[24:27], v[20:23], a[24:27], v[24:27]
v_max_f32 v234, v234, v235
v_max_f32 v238, v238, v239
v_max_f32 v242, v242, v243
v_max_f32 v246, v246, v247
s_waitcnt vmcnt(18)
v_mfma_f32_16x16x32_bf16 v[24:27], v[20:23], a[28:31], v[24:27]
v_mov_b32 v235, v234
v_mov_b32 v239, v238
v_mov_b32 v243, v242
v_mov_b32 v247, v246
s_waitcnt vmcnt(17)
v_mfma_f32_16x16x32_bf16 v[24:27], v[20:23], a[32:35], v[24:27]
v_permlane16_swap_b32 v234, v235
v_permlane16_swap_b32 v238, v239
v_permlane16_swap_b32 v242, v243
v_permlane16_swap_b32 v246, v247
s_waitcnt vmcnt(16)
v_mfma_f32_16x16x32_bf16 v[24:27], v[20:23], a[36:39], v[24:27]
v_max_f32 v234, v234, v235
v_max_f32 v238, v238, v239
v_max_f32 v242, v242, v243
v_max_f32 v246, v246, v247
s_waitcnt vmcnt(15)
v_mfma_f32_16x16x32_bf16 v[24:27], v[20:23], a[40:43], v[24:27]
v_sub_f32 v232, v232, v234
v_sub_f32 v236, v236, v238
v_sub_f32 v240, v240, v242
v_sub_f32 v244, v244, v246
s_waitcnt vmcnt(14)
v_mfma_f32_16x16x32_bf16 v[24:27], v[20:23], a[44:47], v[24:27]
v_sub_f32 v233, v233, v234
v_sub_f32 v237, v237, v238
v_sub_f32 v241, v241, v242
v_sub_f32 v245, v245, v246
s_waitcnt vmcnt(13)
v_mfma_f32_16x16x32_bf16 v[24:27], v[20:23], a[48:51], v[24:27]
v_exp_f32 v232, v232
v_exp_f32 v236, v236
v_exp_f32 v240, v240
v_exp_f32 v244, v244
s_waitcnt vmcnt(12)
v_mfma_f32_16x16x32_bf16 v[24:27], v[20:23], a[52:55], v[24:27]
v_exp_f32 v233, v233
v_exp_f32 v237, v237
v_exp_f32 v241, v241
v_exp_f32 v245, v245
s_waitcnt vmcnt(11)
v_mfma_f32_16x16x32_bf16 v[24:27], v[20:23], a[56:59], v[24:27]
v_add_f32 v234, v232, v233
v_add_f32 v238, v236, v237
v_add_f32 v242, v240, v241
v_add_f32 v246, v244, v245
s_waitcnt vmcnt(10)
v_mfma_f32_16x16x32_bf16 v[24:27], v[20:23], a[60:63], v[24:27]
v_mov_b32 v235, v234
v_mov_b32 v239, v238
v_mov_b32 v243, v242
v_mov_b32 v247, v246
s_waitcnt vmcnt(9)
v_mfma_f32_16x16x32_bf16 v[24:27], v[20:23], a[64:67], v[24:27]
v_permlane32_swap_b32 v234, v235
v_permlane32_swap_b32 v238, v239
v_permlane32_swap_b32 v242, v243
v_permlane32_swap_b32 v246, v247
s_waitcnt vmcnt(8)
v_mfma_f32_16x16x32_bf16 v[24:27], v[20:23], a[68:71], v[24:27]
v_add_f32 v234, v234, v235
v_add_f32 v238, v238, v239
v_add_f32 v242, v242, v243
v_add_f32 v246, v246, v247
v_mov_b32 v235, v234
v_mov_b32 v239, v238
v_mov_b32 v243, v242
v_mov_b32 v247, v246
v_permlane16_swap_b32 v234, v235
v_permlane16_swap_b32 v238, v239
v_permlane16_swap_b32 v242, v243
v_permlane16_swap_b32 v246, v247
v_add_f32 v234, v234, v235
v_add_f32 v238, v238, v239
v_add_f32 v242, v242, v243
v_add_f32 v246, v246, v247
v_rcp_f32 v234, v234
v_rcp_f32 v238, v238
v_rcp_f32 v242, v242
v_rcp_f32 v246, v246
v_mul_f32 v232, v232, v234
v_mul_f32 v236, v236, v238
v_mul_f32 v240, v240, v242
v_mul_f32 v244, v244, v246
v_mul_f32 v233, v233, v234
v_mul_f32 v237, v237, v238
v_mul_f32 v241, v241, v242
v_mul_f32 v245, v245, v246
v_cvt_pk_bf16_f32 v234, v232, v233
v_cvt_pk_bf16_f32 v238, v236, v237
v_cvt_pk_bf16_f32 v242, v240, v241
v_cvt_pk_bf16_f32 v246, v244, v245
v_perm_b32 v216, v234, v234, v32
v_perm_b32 v220, v238, v238, v32
v_perm_b32 v224, v242, v242, v32
v_perm_b32 v228, v246, v246, v32
v_perm_b32 v217, v234, v234, v33
v_perm_b32 v221, v238, v238, v33
v_perm_b32 v225, v242, v242, v33
v_perm_b32 v229, v246, v246, v33
v_perm_b32 v218, v234, v234, v34
v_perm_b32 v222, v238, v238, v34
v_perm_b32 v226, v242, v242, v34
v_perm_b32 v230, v246, v246, v34
v_perm_b32 v219, v234, v234, v35
v_perm_b32 v223, v238, v238, v35
v_perm_b32 v227, v242, v242, v35
v_perm_b32 v231, v246, v246, v35
v_mfma_f32_16x16x32_bf16 v[184:187], v[122:125], v[216:219], 0
v_mfma_f32_16x16x32_bf16 v[188:191], v[154:157], v[216:219], 0
v_mfma_f32_16x16x32_bf16 v[192:195], v[130:133], v[220:223], 0
v_mfma_f32_16x16x32_bf16 v[196:199], v[154:157], v[220:223], 0
v_mfma_f32_16x16x32_bf16 v[200:203], v[138:141], v[224:227], 0
v_mfma_f32_16x16x32_bf16 v[204:207], v[154:157], v[224:227], 0
v_mfma_f32_16x16x32_bf16 v[208:211], v[146:149], v[228:231], 0
v_mfma_f32_16x16x32_bf16 v[212:215], v[154:157], v[228:231], 0
s_nop 0
v_mul_f32 v184, v184, v164
v_mul_f32 v185, v185, v164
v_mul_f32 v186, v186, v164
v_mul_f32 v187, v187, v164
v_mul_f32 v188, v188, v164
v_mul_f32 v189, v189, v164
v_cvt_pk_bf16_f32 v232, v184, v185
v_cvt_pk_bf16_f32 v233, v186, v187
v_cvt_pk_bf16_f32 v234, v188, v189
buffer_store_dwordx2 v[232:233], v43, s[72:75], s20 offen offset:256 sc1
v_mul_f32 v192, v192, v164
v_mul_f32 v193, v193, v164
v_mul_f32 v194, v194, v164
v_mul_f32 v195, v195, v164
v_mul_f32 v198, v198, v164
v_mul_f32 v199, v199, v164
v_cvt_pk_bf16_f32 v236, v192, v193
v_cvt_pk_bf16_f32 v237, v194, v195
v_cvt_pk_bf16_f32 v235, v198, v199
buffer_store_dwordx2 v[236:237], v43, s[72:75], s20 offen offset:1280 sc1
buffer_store_dwordx2 v[234:235], v44, s[72:75], s20 offen offset:2176 sc1
v_mul_f32 v200, v200, v164
v_mul_f32 v201, v201, v164
v_mul_f32 v202, v202, v164
v_mul_f32 v203, v203, v164
v_mul_f32 v204, v204, v164
v_mul_f32 v205, v205, v164
v_cvt_pk_bf16_f32 v240, v200, v201
v_cvt_pk_bf16_f32 v241, v202, v203
v_cvt_pk_bf16_f32 v242, v204, v205
buffer_store_dwordx2 v[240:241], v43, s[72:75], s21 offen offset:256 sc1
v_mul_f32 v208, v208, v164
v_mul_f32 v209, v209, v164
v_mul_f32 v210, v210, v164
v_mul_f32 v211, v211, v164
v_mul_f32 v214, v214, v164
v_mul_f32 v215, v215, v164
v_cvt_pk_bf16_f32 v244, v208, v209
v_cvt_pk_bf16_f32 v245, v210, v211
v_cvt_pk_bf16_f32 v243, v214, v215
buffer_store_dwordx2 v[244:245], v43, s[72:75], s21 offen offset:1280 sc1
buffer_store_dwordx2 v[242:243], v45, s[72:75], s21 offen offset:2176 sc1
s_lshl_b32 s7, s3, 8
s_add_u32 s7, s7, 8320
s_cmp_eq_u32 s13, 0
s_cselect_b32 s7, s7, 1073741824
buffer_store_dwordx2 v[164:165], v44, s[72:75], s7 offen sc1
v_add_f32_dpp v24, v24, v24 row_ror:8 row_mask:0xf bank_mask:0xf
v_add_f32_dpp v25, v25, v25 row_ror:8 row_mask:0xf bank_mask:0xf
v_add_f32_dpp v26, v26, v26 row_ror:8 row_mask:0xf bank_mask:0xf
v_add_f32_dpp v27, v27, v27 row_ror:8 row_mask:0xf bank_mask:0xf
v_lshlrev_b32 v240, 4, v0
s_lshl_b32 s7, s3, 10
v_add_u32 v241, s7, v240
ds_write_b128 v241, v[24:27] offset:32768
s_waitcnt lgkmcnt(0)
s_barrier
ds_read_b128 v[184:187], v240 offset:32768
ds_read_b128 v[188:191], v240 offset:33792
ds_read_b128 v[192:195], v240 offset:34816
ds_read_b128 v[196:199], v240 offset:35840
s_waitcnt lgkmcnt(2)
v_add_f32 v184, v184, v188
s_waitcnt lgkmcnt(0)
v_add_f32 v192, v192, v196
v_add_f32 v185, v185, v189
v_add_f32 v193, v193, v197
v_add_f32 v186, v186, v190
v_add_f32 v194, v194, v198
v_add_f32 v187, v187, v191
v_add_f32 v195, v195, v199
v_add_f32 v184, v184, v192
v_add_f32 v185, v185, v193
v_add_f32 v186, v186, v194
v_add_f32 v187, v187, v195
v_cvt_pk_bf16_f32 v188, v184, v184
v_and_b32 v188, 0xffff0000, v188
v_cvt_pk_bf16_f32 v189, v185, v185
v_and_b32 v189, 0xffff0000, v189
v_cvt_pk_bf16_f32 v190, v186, v186
v_and_b32 v190, 0xffff0000, v190
v_cvt_pk_bf16_f32 v191, v187, v187
v_and_b32 v191, 0xffff0000, v191
v_sub_f32 v188, v184, v188
v_sub_f32 v189, v185, v189
v_sub_f32 v190, v186, v190
v_sub_f32 v191, v187, v191
v_cvt_pk_bf16_f32 v192, v184, v188
v_cvt_pk_bf16_f32 v193, v185, v189
v_cvt_pk_bf16_f32 v194, v186, v190
v_cvt_pk_bf16_f32 v195, v187, v191
v_and_b32 v240, 7, v0
v_lshlrev_b32 v240, 5, v240
v_and_b32 v241, 16, v0
v_add_u32 v240, v240, v241
v_and_b32 v241, 40, v0
v_cmp_eq_u32 vcc, 0, v241
v_mov_b32 v241, 1073741824
s_nop 0
v_cndmask_b32 v240, v241, v240, vcc
s_lshl_b32 s7, s22, 8
s_add_u32 s7, s7, 4063232
s_cmp_eq_u32 s3, 0
s_cselect_b32 s7, s7, 1073741824
buffer_store_dwordx4 v[192:195], v240, s[76:79], s7 offen sc1
s_lshl_b32 s101, s22, 7
s_add_u32 s101, s101, 3997696
s_waitcnt vmcnt(8)
v_cmp_eq_u32 vcc, 0, v254
s_cbranch_vccz L_tagok_2
s_mov_b32 s7, 0
L_tagspin_3:
buffer_load_dword v254, v244, s[80:83], 0 offen sc1
s_waitcnt vmcnt(0)
v_cmp_eq_u32 vcc, 0, v254
s_cbranch_vccz L_tagok_2
s_add_u32 s7, s7, 1
s_cmp_lt_u32 s7, 262144
s_sleep 1
s_cbranch_scc1 L_tagspin_3
v_mov_b32 v244, 109
buffer_store_dword v244, v253, s[80:83], 0 offen
s_waitcnt vmcnt(0)
L_tagok_2:
s_branch L_join
L_roleB:
s_lshl_b32 s16, s4, 1
s_add_u32 s16, s16, s14
s_lshl_b32 s17, s16, 2
s_add_u32 s17, s17, s3
s_and_b32 s19, s17, 7
s_mul_i32 s19, s19, 18432
s_add_u32 s19, s19, 65536
s_lshl_b32 s17, s17, 4
s_lshr_b32 s7, s15, 1
s_add_u32 s7, s7, 1
s_sub_u32 s8, 0, s7
s_bitcmp1_b32 s15, 0
s_cselect_b32 s7, s7, s8
s_add_u32 s7, s7, s17
v_bfe_u32 v20, v0, 2, 3
v_lshrrev_b32 v21, 5, v0
v_lshlrev_b32 v21, 6, v21
v_and_b32 v22, 3, v0
s_movk_i32 s12, 1152
v_lshrrev_b32 v23, 2, v20
v_sub_u32 v23, 0, v23
v_and_b32 v23, 3, v23
v_xor_b32 v23, v22, v23
v_lshl_add_u32 v23, v23, 4, v21
v_add_u32 v24, s7, v20
v_mul_lo_u32 v24, v24, s12
v_add_u32 v1, v24, v23
v_lshrrev_b32 v23, 2, v20
v_sub_u32 v23, 2, v23
v_and_b32 v23, 3, v23
v_xor_b32 v23, v22, v23
v_lshl_add_u32 v23, v23, 4, v21
v_add_u32 v24, s7, v20
v_add_u32 v24, 8, v24
v_mul_lo_u32 v24, v24, s12
v_add_u32 v2, v24, v23
s_mul_i32 s10, s3, 18432
s_add_u32 s10, s10, 73728
s_waitcnt lgkmcnt(0)
s_lshl_b32 s8, s4, 22
s_add_u32 s72, s72, s8
s_addc_u32 s73, s73, 0
s_load_dword s6, s[72:73], 0
s_add_u32 m0, s10, 0
v_add_u32 v20, 0, v0
buffer_load_dwordx4 v1, s[40:43], 0 offen offset:0 lds
s_add_u32 m0, s10, 1024
v_mul_u32_u24 v21, 3641, v20
v_lshrrev_b32 v21, 16, v21
v_mul_u32_u24 v22, 18, v21
buffer_load_dwordx4 v2, s[40:43], 0 offen offset:0 lds
s_add_u32 m0, s10, 1920
v_sub_u32 v20, v20, v22
v_bfe_u32 v22, v21, 2, 2
v_lshlrev_b32 v22, 3, v22
buffer_load_dwordx4 v1, s[40:43], 0 offen offset:128 lds
s_add_u32 m0, s10, 2944
v_lshrrev_b32 v23, 4, v21
v_lshl_add_u32 v22, v23, 2, v22
v_and_b32 v21, 3, v21
v_add_u32 v21, v21, v22
buffer_load_dwordx4 v2, s[40:43], 0 offen offset:128 lds
s_add_u32 m0, s10, 3840
v_mul_u32_u24 v21, 1152, v21
v_lshl_add_u32 v21, v20, 4, v21
v_subrev_u32 v3, 0, v21
buffer_load_dwordx4 v1, s[40:43], 0 offen offset:256 lds
s_add_u32 m0, s10, 4864
v_add_u32 v20, 64, v0
v_mul_u32_u24 v21, 3641, v20
v_lshrrev_b32 v21, 16, v21
buffer_load_dwordx4 v2, s[40:43], 0 offen offset:256 lds
s_add_u32 m0, s10, 5760
v_mul_u32_u24 v22, 18, v21
v_sub_u32 v20, v20, v22
v_bfe_u32 v22, v21, 2, 2
v_lshlrev_b32 v22, 3, v22
buffer_load_dwordx4 v1, s[40:43], 0 offen offset:384 lds
s_add_u32 m0, s10, 6784
v_lshrrev_b32 v23, 4, v21
v_lshl_add_u32 v22, v23, 2, v22
v_and_b32 v21, 3, v21
buffer_load_dwordx4 v2, s[40:43], 0 offen offset:384 lds
s_add_u32 m0, s10, 7680
v_add_u32 v21, v21, v22
v_mul_u32_u24 v21, 1152, v21
v_lshl_add_u32 v21, v20, 4, v21
buffer_load_dwordx4 v1, s[40:43], 0 offen offset:512 lds
s_add_u32 m0, s10, 8704
v_subrev_u32 v4, 1024, v21
v_add_u32 v20, 128, v0
v_mul_u32_u24 v21, 3641, v20
v_lshrrev_b32 v21, 16, v21
buffer_load_dwordx4 v2, s[40:43], 0 offen offset:512 lds
s_add_u32 m0, s10, 9600
v_mul_u32_u24 v22, 18, v21
v_sub_u32 v20, v20, v22
v_bfe_u32 v22, v21, 2, 2
buffer_load_dwordx4 v1, s[40:43], 0 offen offset:640 lds
s_add_u32 m0, s10, 10624
v_lshlrev_b32 v22, 3, v22
v_lshrrev_b32 v23, 4, v21
v_lshl_add_u32 v22, v23, 2, v22
buffer_load_dwordx4 v2, s[40:43], 0 offen offset:640 lds
s_add_u32 m0, s10, 11520
v_and_b32 v21, 3, v21
v_add_u32 v21, v21, v22
v_mul_u32_u24 v21, 1152, v21
v_lshl_add_u32 v21, v20, 4, v21
buffer_load_dwordx4 v1, s[40:43], 0 offen offset:768 lds
s_add_u32 m0, s10, 12544
v_subrev_u32 v5, 2048, v21
v_add_u32 v20, 192, v0
v_mul_u32_u24 v21, 3641, v20
buffer_load_dwordx4 v2, s[40:43], 0 offen offset:768 lds
s_add_u32 m0, s10, 13440
v_lshrrev_b32 v21, 16, v21
v_mul_u32_u24 v22, 18, v21
v_sub_u32 v20, v20, v22
buffer_load_dwordx4 v1, s[40:43], 0 offen offset:896 lds
s_add_u32 m0, s10, 14464
v_bfe_u32 v22, v21, 2, 2
v_lshlrev_b32 v22, 3, v22
v_lshrrev_b32 v23, 4, v21
v_lshl_add_u32 v22, v23, 2, v22
buffer_load_dwordx4 v2, s[40:43], 0 offen offset:896 lds
s_add_u32 m0, s10, 15360
v_and_b32 v21, 3, v21
v_add_u32 v21, v21, v22
v_mul_u32_u24 v21, 1152, v21
buffer_load_dwordx4 v1, s[40:43], 0 offen offset:1024 lds
s_add_u32 m0, s10, 16384
v_lshl_add_u32 v21, v20, 4, v21
v_subrev_u32 v6, 3072, v21
v_add_u32 v20, 256, v0
buffer_load_dwordx4 v2, s[40:43], 0 offen offset:1024 lds
v_mul_u32_u24 v21, 3641, v20
v_lshrrev_b32 v21, 16, v21
v_mul_u32_u24 v22, 18, v21
v_sub_u32 v20, v20, v22
v_bfe_u32 v22, v21, 2, 2
v_lshlrev_b32 v22, 3, v22
v_lshrrev_b32 v23, 4, v21
v_lshl_add_u32 v22, v23, 2, v22
v_and_b32 v21, 3, v21
v_add_u32 v21, v21, v22
v_mul_u32_u24 v21, 1152, v21
v_lshl_add_u32 v21, v20, 4, v21
v_subrev_u32 v7, 0, v21
v_add_u32 v20, 320, v0
v_mul_u32_u24 v21, 3641, v20
v_lshrrev_b32 v21, 16, v21
v_mul_u32_u24 v22, 18, v21
v_sub_u32 v20, v20, v22
v_bfe_u32 v22, v21, 2, 2
v_lshlrev_b32 v22, 3, v22
v_lshrrev_b32 v23, 4, v21
v_lshl_add_u32 v22, v23, 2, v22
v_and_b32 v21, 3, v21
v_add_u32 v21, v21, v22
v_mul_u32_u24 v21, 1152, v21
v_lshl_add_u32 v21, v20, 4, v21
v_subrev_u32 v8, 1024, v21
v_add_u32 v20, 384, v0
v_mul_u32_u24 v21, 3641, v20
v_lshrrev_b32 v21, 16, v21
v_mul_u32_u24 v22, 18, v21
v_sub_u32 v20, v20, v22
v_bfe_u32 v22, v21, 2, 2
v_lshlrev_b32 v22, 3, v22
v_lshrrev_b32 v23, 4, v21
v_lshl_add_u32 v22, v23, 2, v22
v_and_b32 v21, 3, v21
v_add_u32 v21, v21, v22
v_mul_u32_u24 v21, 1152, v21
v_lshl_add_u32 v21, v20, 4, v21
v_subrev_u32 v9, 2048, v21
v_add_u32 v20, 448, v0
v_mul_u32_u24 v21, 3641, v20
v_lshrrev_b32 v21, 16, v21
v_mul_u32_u24 v22, 18, v21
v_sub_u32 v20, v20, v22
v_bfe_u32 v22, v21, 2, 2
v_lshlrev_b32 v22, 3, v22
v_lshrrev_b32 v23, 4, v21
v_lshl_add_u32 v22, v23, 2, v22
v_and_b32 v21, 3, v21
v_add_u32 v21, v21, v22
v_mul_u32_u24 v21, 1152, v21
v_lshl_add_u32 v21, v20, 4, v21
v_subrev_u32 v10, 3072, v21
v_add_u32 v20, 512, v0
v_mul_u32_u24 v21, 3641, v20
v_lshrrev_b32 v21, 16, v21
v_mul_u32_u24 v22, 18, v21
v_sub_u32 v20, v20, v22
v_bfe_u32 v22, v21, 2, 2
v_lshlrev_b32 v22, 3, v22
v_lshrrev_b32 v23, 4, v21
v_lshl_add_u32 v22, v23, 2, v22
v_and_b32 v21, 3, v21
v_add_u32 v21, v21, v22
v_mul_u32_u24 v21, 1152, v21
v_lshl_add_u32 v21, v20, 4, v21
v_subrev_u32 v11, 0, v21
s_mul_i32 s18, s3, 36864
s_mul_i32 s7, s15, 288
s_add_u32 s18, s18, s7
s_mul_i32 s98, s3, 9216
s_cmp_ge_u32 s3, 2
s_cselect_b32 s20, s52, s48
s_cselect_b32 s21, s53, s49
s_cselect_b32 s24, 4294303744, 0
s_add_u32 s24, s24, 589824
s_mov_b32 s22, 663552
s_mov_b32 s23, 0x20000
s_add_u32 s24, s24, s18
s_add_u32 s99, s18, 0
s_add_u32 m0, s98, 0
s_nop 0
buffer_load_dwordx4 v3, s[48:51], s99 offen offset:0 lds
buffer_load_dwordx4 v4, s[48:51], s99 offen offset:1024 lds
buffer_load_dwordx4 v5, s[48:51], s99 offen offset:2048 lds
buffer_load_dwordx4 v6, s[48:51], s99 offen offset:3072 lds
s_add_u32 m0, s98, 4096
s_nop 0
buffer_load_dwordx4 v7, s[48:51], s99 offen offset:0 lds
buffer_load_dwordx4 v8, s[48:51], s99 offen offset:1024 lds
buffer_load_dwordx4 v9, s[48:51], s99 offen offset:2048 lds
buffer_load_dwordx4 v10, s[48:51], s99 offen offset:3072 lds
s_add_u32 m0, s98, 8192
s_nop 0
buffer_load_dwordx4 v11, s[48:51], s99 offen offset:0 lds
s_lshl_b32 s8, s4, 22
s_sub_u32 s76, s72, s8
s_subb_u32 s77, s73, 0
s_mov_b32 s78, 4194304
s_mov_b32 s79, 0x20000
s_waitcnt lgkmcnt(0)
s_mul_i32 s6, s6, 0x9E3779B1
s_add_u32 s6, s6, 0x7F4A7C15
v_and_b32 v20, 15, v0
v_lshrrev_b32 v21, 4, v0
v_lshrrev_b32 v23, 2, v20
v_sub_u32 v23, 0, v23
v_and_b32 v23, 3, v23
v_xor_b32 v23, v21, v23
v_lshlrev_b32 v22, 4, v23
v_and_b32 v23, 7, v20
v_lshl_add_u32 v22, v23, 6, v22
v_lshrrev_b32 v23, 3, v20
v_lshl_add_u32 v31, v23, 10, v22
v_add_u32 v31, s10, v31
v_lshrrev_b32 v22, 2, v20
v_lshl_add_u32 v22, v21, 2, v22
v_mul_u32_u24 v22, 288, v22
v_and_b32 v23, 3, v0
v_lshl_add_u32 v12, v23, 3, v22
v_add_u32 v13, 64512, v12
v_add_u32 v14, 129024, v12
v_add_u32 v22, s17, v20
v_mul_u32_u24 v22, 1152, v22
v_lshl_add_u32 v22, v21, 3, v22
s_mul_i32 s7, s15, 288
v_add_u32 v15, s7, v22
v_lshrrev_b32 v22, 1, v21
v_and_b32 v23, 1, v21
v_lshlrev_b32 v24, 4, v20
v_lshl_add_u32 v24, v23, 3, v24
v_lshl_add_u32 v16, v22, 8, v24
s_and_b32 s7, s3, 1
s_lshl_b32 s7, s7, 8
v_lshl_add_u32 v17, v22, 9, v24
v_add_u32 v17, s7, v17
v_cmp_eq_u32 vcc, 0, v21
v_lshlrev_b32 v22, 3, v20
v_mov_b32 v23, 1073741824
v_cndmask_b32 v18, v23, v22, vcc
v_lshlrev_b32 v19, 4, v0
v_mov_b32 v206, 0xbeeff558
s_lshl_b32 s100, s16, 2
s_add_u32 s100, s100, s15
s_lshl_b32 s100, s100, 2
s_add_u32 s100, s100, s3
s_mul_i32 s7, s100, 11
s_add_u32 s7, s7, 0
v_add_u32 v20, s7, v0
v_lshlrev_b32 v20, 7, v20
v_mov_b32 v21, 1073741824
v_cmp_gt_u32 vcc, 11, v0
s_nop 1
v_cndmask_b32 v20, v21, v20, vcc
buffer_load_dword v252, v20, s[48:51], 0 offen
v_mov_b32 v20, 0
v_mov_b32 v21, 0
v_mov_b32 v22, 0
v_mov_b32 v23, 0
s_mov_b32 s96, 0x3f803f80
s_waitcnt vmcnt(22)
ds_read_b128 v[32:35], v31 offset:0
ds_read_b128 v[36:39], v31 offset:512
ds_read_b128 v[40:43], v31 offset:2048
ds_read_b128 v[44:47], v31 offset:2560
ds_read_b128 v[48:51], v31 offset:4096
ds_read_b128 v[52:55], v31 offset:4608
s_waitcnt vmcnt(16)
ds_read_b128 v[56:59], v31 offset:6144
ds_read_b128 v[60:63], v31 offset:6656
ds_read_b128 v[64:67], v31 offset:8192
ds_read_b128 v[68:71], v31 offset:8704
ds_read_b128 v[72:75], v31 offset:10240
ds_read_b128 v[76:79], v31 offset:10752
s_waitcnt lgkmcnt(11)
v_dot2c_f32_bf16 v20, s96, v32
s_add_u32 s99, s18, 147456
s_add_u32 m0, s98, 36864
v_dot2c_f32_bf16 v22, v32, v32
v_dot2c_f32_bf16 v21, s96, v33
v_dot2c_f32_bf16 v23, v33, v33
v_dot2c_f32_bf16 v20, s96, v34
v_dot2c_f32_bf16 v22, v34, v34
v_dot2c_f32_bf16 v21, s96, v35
v_dot2c_f32_bf16 v23, v35, v35
s_waitcnt lgkmcnt(10)
v_dot2c_f32_bf16 v20, s96, v36
buffer_load_dwordx4 v3, s[48:51], s99 offen offset:0 lds
v_dot2c_f32_bf16 v22, v36, v36
v_dot2c_f32_bf16 v21, s96, v37
v_dot2c_f32_bf16 v23, v37, v37
v_dot2c_f32_bf16 v20, s96, v38
v_dot2c_f32_bf16 v22, v38, v38
v_dot2c_f32_bf16 v21, s96, v39
v_dot2c_f32_bf16 v23, v39, v39
s_waitcnt lgkmcnt(9)
v_dot2c_f32_bf16 v20, s96, v40
buffer_load_dwordx4 v4, s[48:51], s99 offen offset:1024 lds
v_dot2c_f32_bf16 v22, v40, v40
v_dot2c_f32_bf16 v21, s96, v41
v_dot2c_f32_bf16 v23, v41, v41
v_dot2c_f32_bf16 v20, s96, v42
v_dot2c_f32_bf16 v22, v42, v42
v_dot2c_f32_bf16 v21, s96, v43
v_dot2c_f32_bf16 v23, v43, v43
s_waitcnt lgkmcnt(8)
v_dot2c_f32_bf16 v20, s96, v44
buffer_load_dwordx4 v5, s[48:51], s99 offen offset:2048 lds
v_dot2c_f32_bf16 v22, v44, v44
v_dot2c_f32_bf16 v21, s96, v45
v_dot2c_f32_bf16 v23, v45, v45
v_dot2c_f32_bf16 v20, s96, v46
v_dot2c_f32_bf16 v22, v46, v46
v_dot2c_f32_bf16 v21, s96, v47
v_dot2c_f32_bf16 v23, v47, v47
s_waitcnt lgkmcnt(7)
v_dot2c_f32_bf16 v20, s96, v48
buffer_load_dwordx4 v6, s[48:51], s99 offen offset:3072 lds
v_dot2c_f32_bf16 v22, v48, v48
v_dot2c_f32_bf16 v21, s96, v49
v_dot2c_f32_bf16 v23, v49, v49
v_dot2c_f32_bf16 v20, s96, v50
v_dot2c_f32_bf16 v22, v50, v50
v_dot2c_f32_bf16 v21, s96, v51
v_dot2c_f32_bf16 v23, v51, v51
s_waitcnt lgkmcnt(6)
v_dot2c_f32_bf16 v20, s96, v52
s_add_u32 m0, s98, 40960
v_dot2c_f32_bf16 v22, v52, v52
v_dot2c_f32_bf16 v21, s96, v53
v_dot2c_f32_bf16 v23, v53, v53
v_dot2c_f32_bf16 v20, s96, v54
v_dot2c_f32_bf16 v22, v54, v54
v_dot2c_f32_bf16 v21, s96, v55
v_dot2c_f32_bf16 v23, v55, v55
s_waitcnt vmcnt(14)
ds_read_b128 v[80:83], v31 offset:12288
ds_read_b128 v[84:87], v31 offset:12800
ds_read_b128 v[88:91], v31 offset:14336
ds_read_b128 v[92:95], v31 offset:14848
ds_read_b128 v[96:99], v31 offset:16384
ds_read_b128 v[100:103], v31 offset:16896
s_waitcnt lgkmcnt(11)
v_dot2c_f32_bf16 v20, s96, v56
buffer_load_dwordx4 v7, s[48:51], s99 offen offset:0 lds
v_dot2c_f32_bf16 v22, v56, v56
v_dot2c_f32_bf16 v21, s96, v57
v_dot2c_f32_bf16 v23, v57, v57
v_dot2c_f32_bf16 v20, s96, v58
v_dot2c_f32_bf16 v22, v58, v58
v_dot2c_f32_bf16 v21, s96, v59
v_dot2c_f32_bf16 v23, v59, v59
s_waitcnt lgkmcnt(10)
v_dot2c_f32_bf16 v20, s96, v60
buffer_load_dwordx4 v8, s[48:51], s99 offen offset:1024 lds
v_dot2c_f32_bf16 v22, v60, v60
v_dot2c_f32_bf16 v21, s96, v61
v_dot2c_f32_bf16 v23, v61, v61
v_dot2c_f32_bf16 v20, s96, v62
v_dot2c_f32_bf16 v22, v62, v62
v_dot2c_f32_bf16 v21, s96, v63
v_dot2c_f32_bf16 v23, v63, v63
s_waitcnt lgkmcnt(9)
v_dot2c_f32_bf16 v20, s96, v64
buffer_load_dwordx4 v9, s[48:51], s99 offen offset:2048 lds
v_dot2c_f32_bf16 v22, v64, v64
v_dot2c_f32_bf16 v21, s96, v65
v_dot2c_f32_bf16 v23, v65, v65
v_dot2c_f32_bf16 v20, s96, v66
v_dot2c_f32_bf16 v22, v66, v66
v_dot2c_f32_bf16 v21, s96, v67
v_dot2c_f32_bf16 v23, v67, v67
s_waitcnt lgkmcnt(8)
v_dot2c_f32_bf16 v20, s96, v68
buffer_load_dwordx4 v10, s[48:51], s99 offen offset:3072 lds
v_dot2c_f32_bf16 v22, v68, v68
v_dot2c_f32_bf16 v21, s96, v69
v_dot2c_f32_bf16 v23, v69, v69
v_dot2c_f32_bf16 v20, s96, v70
v_dot2c_f32_bf16 v22, v70, v70
v_dot2c_f32_bf16 v21, s96, v71
v_dot2c_f32_bf16 v23, v71, v71
s_waitcnt lgkmcnt(7)
v_dot2c_f32_bf16 v20, s96, v72
s_add_u32 m0, s98, 45056
v_dot2c_f32_bf16 v22, v72, v72
v_dot2c_f32_bf16 v21, s96, v73
v_dot2c_f32_bf16 v23, v73, v73
v_dot2c_f32_bf16 v20, s96, v74
v_dot2c_f32_bf16 v22, v74, v74
v_dot2c_f32_bf16 v21, s96, v75
v_dot2c_f32_bf16 v23, v75, v75
s_waitcnt lgkmcnt(6)
v_dot2c_f32_bf16 v20, s96, v76
buffer_load_dwordx4 v11, s[48:51], s99 offen offset:0 lds
v_dot2c_f32_bf16 v22, v76, v76
v_dot2c_f32_bf16 v21, s96, v77
v_dot2c_f32_bf16 v23, v77, v77
v_dot2c_f32_bf16 v20, s96, v78
v_dot2c_f32_bf16 v22, v78, v78
v_dot2c_f32_bf16 v21, s96, v79
v_dot2c_f32_bf16 v23, v79, v79
s_waitcnt lgkmcnt(0)
s_barrier
v_dot2c_f32_bf16 v20, s96, v80
s_add_u32 s99, s18, 294912
s_add_u32 m0, s98, 73728
v_dot2c_f32_bf16 v22, v80, v80
v_dot2c_f32_bf16 v21, s96, v81
v_dot2c_f32_bf16 v23, v81, v81
v_dot2c_f32_bf16 v20, s96, v82
v_dot2c_f32_bf16 v22, v82, v82
v_dot2c_f32_bf16 v21, s96, v83
v_dot2c_f32_bf16 v23, v83, v83
v_dot2c_f32_bf16 v20, s96, v84
v_dot2c_f32_bf16 v22, v84, v84
v_dot2c_f32_bf16 v21, s96, v85
v_dot2c_f32_bf16 v23, v85, v85
v_dot2c_f32_bf16 v20, s96, v86
buffer_load_dwordx4 v3, s[48:51], s99 offen offset:0 lds
v_dot2c_f32_bf16 v22, v86, v86
v_dot2c_f32_bf16 v21, s96, v87
v_dot2c_f32_bf16 v23, v87, v87
v_dot2c_f32_bf16 v20, s96, v88
v_dot2c_f32_bf16 v22, v88, v88
v_dot2c_f32_bf16 v21, s96, v89
v_dot2c_f32_bf16 v23, v89, v89
v_dot2c_f32_bf16 v20, s96, v90
v_dot2c_f32_bf16 v22, v90, v90
v_dot2c_f32_bf16 v21, s96, v91
v_dot2c_f32_bf16 v23, v91, v91
v_dot2c_f32_bf16 v20, s96, v92
buffer_load_dwordx4 v4, s[48:51], s99 offen offset:1024 lds
v_dot2c_f32_bf16 v22, v92, v92
v_dot2c_f32_bf16 v21, s96, v93
v_dot2c_f32_bf16 v23, v93, v93
v_dot2c_f32_bf16 v20, s96, v94
v_dot2c_f32_bf16 v22, v94, v94
v_dot2c_f32_bf16 v21, s96, v95
v_dot2c_f32_bf16 v23, v95, v95
v_dot2c_f32_bf16 v20, s96, v96
v_dot2c_f32_bf16 v22, v96, v96
v_dot2c_f32_bf16 v21, s96, v97
v_dot2c_f32_bf16 v23, v97, v97
v_dot2c_f32_bf16 v20, s96, v98
buffer_load_dwordx4 v5, s[48:51], s99 offen offset:2048 lds
v_dot2c_f32_bf16 v22, v98, v98
v_dot2c_f32_bf16 v21, s96, v99
v_dot2c_f32_bf16 v23, v99, v99
v_dot2c_f32_bf16 v20, s96, v100
v_dot2c_f32_bf16 v22, v100, v100
v_dot2c_f32_bf16 v21, s96, v101
v_dot2c_f32_bf16 v23, v101, v101
v_dot2c_f32_bf16 v20, s96, v102
v_dot2c_f32_bf16 v22, v102, v102
v_dot2c_f32_bf16 v21, s96, v103
v_dot2c_f32_bf16 v23, v103, v103
s_nop 1
v_add_f32 v20, v20, v21
v_add_f32 v22, v22, v23
v_mov_b32 v24, v20
s_nop 1
v_permlane32_swap_b32 v20, v24
v_add_f32 v20, v20, v24
v_mov_b32 v24, v20
s_nop 1
v_permlane16_swap_b32 v20, v24
v_add_f32 v20, v20, v24
v_mov_b32 v24, v22
s_nop 1
v_permlane32_swap_b32 v22, v24
v_add_f32 v22, v22, v24
v_mov_b32 v24, v22
s_nop 1
v_permlane16_swap_b32 v22, v24
v_add_f32 v22, v22, v24
v_mul_f32 v20, 0x3ae38e39, v20
v_mul_f32 v22, 0x3ae38e39, v22
v_fma_f32 v22, -v20, v20, v22
v_max_f32 v22, 0, v22
v_cvt_pk_bf16_f32 v24, v20, v20
v_and_b32 v24, 0xffff0000, v24
v_cvt_pk_bf16_f32 v25, v22, v22
v_and_b32 v25, 0xffff0000, v25
v_add_f32 v25, 0x3727c5ac, v25
v_cvt_pk_bf16_f32 v25, v25, v25
v_and_b32 v25, 0xffff0000, v25
v_sqrt_f32 v25, v25
s_nop 0
v_cvt_pk_bf16_f32 v25, v25, v25
v_and_b32 v25, 0xffff0000, v25
v_rcp_f32 v20, v25
s_nop 0
v_mul_f32 v20, 0xbeeff558, v20
v_mul_f32 v22, v24, v20
v_sub_f32 v22, 0, v22
s_mul_i32 s7, s100, 11
s_add_u32 s7, s7, 0
v_add_u32 v26, s7, v0
v_lshlrev_b32 v26, 7, v26
v_mov_b32 v27, 1073741824
v_cmp_gt_u32 vcc, 11, v0
s_nop 1
v_cndmask_b32 v26, v27, v26, vcc
buffer_load_dword v252, v26, s[52:55], 0 offen
v_lshlrev_b32 v26, 16, v32
buffer_load_dwordx4 v6, s[48:51], s99 offen offset:3072 lds
v_lshlrev_b32 v28, 16, v33
v_and_b32 v27, 0xffff0000, v32
v_and_b32 v29, 0xffff0000, v33
v_fma_f32 v26, v26, v20, v22
v_fma_f32 v28, v28, v20, v22
v_fma_f32 v27, v27, v20, v22
v_fma_f32 v29, v29, v20, v22
s_add_u32 m0, s98, 77824
v_cvt_pk_bf16_f32 v32, v26, v27
v_cvt_pk_bf16_f32 v33, v28, v29
v_lshlrev_b32 v26, 16, v34
v_lshlrev_b32 v28, 16, v35
v_and_b32 v27, 0xffff0000, v34
v_and_b32 v29, 0xffff0000, v35
v_fma_f32 v26, v26, v20, v22
v_fma_f32 v28, v28, v20, v22
buffer_load_dwordx4 v7, s[48:51], s99 offen offset:0 lds
v_fma_f32 v27, v27, v20, v22
v_fma_f32 v29, v29, v20, v22
v_cvt_pk_bf16_f32 v34, v26, v27
v_cvt_pk_bf16_f32 v35, v28, v29
v_lshlrev_b32 v26, 16, v36
v_lshlrev_b32 v28, 16, v37
v_and_b32 v27, 0xffff0000, v36
buffer_load_dwordx4 v8, s[48:51], s99 offen offset:1024 lds
v_and_b32 v29, 0xffff0000, v37
v_fma_f32 v26, v26, v20, v22
v_fma_f32 v28, v28, v20, v22
v_fma_f32 v27, v27, v20, v22
v_fma_f32 v29, v29, v20, v22
v_cvt_pk_bf16_f32 v36, v26, v27
v_cvt_pk_bf16_f32 v37, v28, v29
v_lshlrev_b32 v26, 16, v38
buffer_load_dwordx4 v9, s[48:51], s99 offen offset:2048 lds
v_lshlrev_b32 v28, 16, v39
v_and_b32 v27, 0xffff0000, v38
v_and_b32 v29, 0xffff0000, v39
v_fma_f32 v26, v26, v20, v22
v_fma_f32 v28, v28, v20, v22
v_fma_f32 v27, v27, v20, v22
v_fma_f32 v29, v29, v20, v22
buffer_load_dwordx4 v10, s[48:51], s99 offen offset:3072 lds
v_cvt_pk_bf16_f32 v38, v26, v27
v_cvt_pk_bf16_f32 v39, v28, v29
v_lshlrev_b32 v26, 16, v40
v_lshlrev_b32 v28, 16, v41
v_and_b32 v27, 0xffff0000, v40
v_and_b32 v29, 0xffff0000, v41
v_fma_f32 v26, v26, v20, v22
v_fma_f32 v28, v28, v20, v22
s_add_u32 m0, s98, 81920
v_fma_f32 v27, v27, v20, v22
v_fma_f32 v29, v29, v20, v22
v_cvt_pk_bf16_f32 v40, v26, v27
v_cvt_pk_bf16_f32 v41, v28, v29
v_lshlrev_b32 v26, 16, v42
v_lshlrev_b32 v28, 16, v43
v_and_b32 v27, 0xffff0000, v42
buffer_load_dwordx4 v11, s[48:51], s99 offen offset:0 lds
v_and_b32 v29, 0xffff0000, v43
v_fma_f32 v26, v26, v20, v22
v_fma_f32 v28, v28, v20, v22
v_fma_f32 v27, v27, v20, v22
v_fma_f32 v29, v29, v20, v22
v_cvt_pk_bf16_f32 v42, v26, v27
v_cvt_pk_bf16_f32 v43, v28, v29
s_waitcnt vmcnt(20)
s_barrier
ds_read_b64_tr_b16 v[140:141], v12 offset:0
ds_read_b64_tr_b16 v[142:143], v12 offset:4608
ds_read_b64_tr_b16 v[144:145], v12 offset:32
ds_read_b64_tr_b16 v[146:147], v12 offset:4640
ds_read_b64_tr_b16 v[148:149], v12 offset:64
ds_read_b64_tr_b16 v[150:151], v12 offset:4672
ds_read_b64_tr_b16 v[152:153], v12 offset:96
ds_read_b64_tr_b16 v[154:155], v12 offset:4704
ds_read_b64_tr_b16 v[156:157], v12 offset:128
ds_read_b64_tr_b16 v[158:159], v12 offset:4736
ds_read_b64_tr_b16 v[160:161], v12 offset:160
ds_read_b64_tr_b16 v[162:163], v12 offset:4768
ds_read_b64_tr_b16 v[164:165], v12 offset:192
ds_read_b64_tr_b16 v[166:167], v12 offset:4800
s_waitcnt lgkmcnt(8)
v_mfma_f32_16x16x32_bf16 v[104:107], v[140:143], v[32:35], 0
ds_read_b64_tr_b16 v[168:169], v12 offset:224
ds_read_b64_tr_b16 v[170:171], v12 offset:4832
v_lshlrev_b32 v26, 16, v44
v_lshlrev_b32 v28, 16, v45
v_mfma_f32_16x16x32_bf16 v[108:111], v[144:147], v[32:35], 0
ds_read_b64_tr_b16 v[140:141], v12 offset:256
ds_read_b64_tr_b16 v[142:143], v12 offset:4864
v_and_b32 v27, 0xffff0000, v44
v_and_b32 v29, 0xffff0000, v45
v_mfma_f32_16x16x32_bf16 v[112:115], v[148:151], v[32:35], 0
ds_read_b64_tr_b16 v[144:145], v12 offset:9216
ds_read_b64_tr_b16 v[146:147], v12 offset:13824
v_fma_f32 v26, v26, v20, v22
v_fma_f32 v28, v28, v20, v22
s_waitcnt lgkmcnt(8)
v_mfma_f32_16x16x32_bf16 v[116:119], v[152:155], v[32:35], 0
ds_read_b64_tr_b16 v[148:149], v12 offset:9248
ds_read_b64_tr_b16 v[150:151], v12 offset:13856
v_fma_f32 v27, v27, v20, v22
v_fma_f32 v29, v29, v20, v22
v_mfma_f32_16x16x32_bf16 v[120:123], v[156:159], v[32:35], 0
ds_read_b64_tr_b16 v[152:153], v12 offset:9280
ds_read_b64_tr_b16 v[154:155], v12 offset:13888
v_cvt_pk_bf16_f32 v44, v26, v27
v_cvt_pk_bf16_f32 v45, v28, v29
v_mfma_f32_16x16x32_bf16 v[124:127], v[160:163], v[32:35], 0
ds_read_b64_tr_b16 v[156:157], v12 offset:9312
ds_read_b64_tr_b16 v[158:159], v12 offset:13920
v_lshlrev_b32 v26, 16, v46
v_lshlrev_b32 v28, 16, v47
s_waitcnt lgkmcnt(8)
v_mfma_f32_16x16x32_bf16 v[128:131], v[164:167], v[32:35], 0
ds_read_b64_tr_b16 v[160:161], v12 offset:9344
ds_read_b64_tr_b16 v[162:163], v12 offset:13952
v_and_b32 v27, 0xffff0000, v46
v_and_b32 v29, 0xffff0000, v47
v_mfma_f32_16x16x32_bf16 v[132:135], v[168:171], v[32:35], 0
ds_read_b64_tr_b16 v[164:165], v12 offset:9376
ds_read_b64_tr_b16 v[166:167], v12 offset:13984
v_fma_f32 v26, v26, v20, v22
v_fma_f32 v28, v28, v20, v22
v_mfma_f32_16x16x32_bf16 v[136:139], v[140:143], v[32:35], 0
ds_read_b64_tr_b16 v[168:169], v12 offset:9408
ds_read_b64_tr_b16 v[170:171], v12 offset:14016
v_fma_f32 v27, v27, v20, v22
v_fma_f32 v29, v29, v20, v22
s_waitcnt lgkmcnt(8)
v_mfma_f32_16x16x32_bf16 v[104:107], v[144:147], v[36:39], v[104:107]
ds_read_b64_tr_b16 v[140:141], v12 offset:9440
ds_read_b64_tr_b16 v[142:143], v12 offset:14048
v_cvt_pk_bf16_f32 v46, v26, v27
v_cvt_pk_bf16_f32 v47, v28, v29
v_mfma_f32_16x16x32_bf16 v[108:111], v[148:151], v[36:39], v[108:111]
ds_read_b64_tr_b16 v[144:145], v12 offset:9472
ds_read_b64_tr_b16 v[146:147], v12 offset:14080
v_lshlrev_b32 v26, 16, v48
v_lshlrev_b32 v28, 16, v49
v_mfma_f32_16x16x32_bf16 v[112:115], v[152:155], v[36:39], v[112:115]
ds_read_b64_tr_b16 v[148:149], v12 offset:18432
ds_read_b64_tr_b16 v[150:151], v12 offset:23040
v_and_b32 v27, 0xffff0000, v48
v_and_b32 v29, 0xffff0000, v49
s_waitcnt lgkmcnt(8)
v_mfma_f32_16x16x32_bf16 v[116:119], v[156:159], v[36:39], v[116:119]
ds_read_b64_tr_b16 v[152:153], v12 offset:18464
ds_read_b64_tr_b16 v[154:155], v12 offset:23072
v_fma_f32 v26, v26, v20, v22
v_fma_f32 v28, v28, v20, v22
v_mfma_f32_16x16x32_bf16 v[120:123], v[160:163], v[36:39], v[120:123]
ds_read_b64_tr_b16 v[156:157], v12 offset:18496
ds_read_b64_tr_b16 v[158:159], v12 offset:23104
v_fma_f32 v27, v27, v20, v22
v_fma_f32 v29, v29, v20, v22
v_mfma_f32_16x16x32_bf16 v[124:127], v[164:167], v[36:39], v[124:127]
ds_read_b64_tr_b16 v[160:161], v12 offset:18528
ds_read_b64_tr_b16 v[162:163], v12 offset:23136
v_cvt_pk_bf16_f32 v48, v26, v27
v_cvt_pk_bf16_f32 v49, v28, v29
s_waitcnt lgkmcnt(8)
v_mfma_f32_16x16x32_bf16 v[128:131], v[168:171], v[36:39], v[128:131]
ds_read_b64_tr_b16 v[164:165], v12 offset:18560
ds_read_b64_tr_b16 v[166:167], v12 offset:23168
v_lshlrev_b32 v26, 16, v50
v_lshlrev_b32 v28, 16, v51
v_mfma_f32_16x16x32_bf16 v[132:135], v[140:143], v[36:39], v[132:135]
ds_read_b64_tr_b16 v[168:169], v12 offset:18592
ds_read_b64_tr_b16 v[170:171], v12 offset:23200
v_and_b32 v27, 0xffff0000, v50
v_and_b32 v29, 0xffff0000, v51
v_mfma_f32_16x16x32_bf16 v[136:139], v[144:147], v[36:39], v[136:139]
ds_read_b64_tr_b16 v[140:141], v12 offset:18624
ds_read_b64_tr_b16 v[142:143], v12 offset:23232
v_fma_f32 v26, v26, v20, v22
v_fma_f32 v28, v28, v20, v22
s_waitcnt lgkmcnt(8)
v_mfma_f32_16x16x32_bf16 v[104:107], v[148:151], v[40:43], v[104:107]
ds_read_b64_tr_b16 v[144:145], v12 offset:18656
ds_read_b64_tr_b16 v[146:147], v12 offset:23264
v_fma_f32 v27, v27, v20, v22
v_fma_f32 v29, v29, v20, v22
v_mfma_f32_16x16x32_bf16 v[108:111], v[152:155], v[40:43], v[108:111]
ds_read_b64_tr_b16 v[148:149], v12 offset:18688
ds_read_b64_tr_b16 v[150:151], v12 offset:23296
v_cvt_pk_bf16_f32 v50, v26, v27
v_cvt_pk_bf16_f32 v51, v28, v29
v_mfma_f32_16x16x32_bf16 v[112:115], v[156:159], v[40:43], v[112:115]
ds_read_b64_tr_b16 v[152:153], v12 offset:27648
ds_read_b64_tr_b16 v[154:155], v12 offset:32256
s_add_u32 s99, s18, 442368
s_add_u32 m0, s98, 110592
v_lshlrev_b32 v26, 16, v52
s_waitcnt lgkmcnt(8)
v_mfma_f32_16x16x32_bf16 v[116:119], v[160:163], v[40:43], v[116:119]
ds_read_b64_tr_b16 v[156:157], v12 offset:27680
ds_read_b64_tr_b16 v[158:159], v12 offset:32288
buffer_load_dwordx4 v3, s[48:51], s99 offen offset:0 lds
v_lshlrev_b32 v28, 16, v53
v_and_b32 v27, 0xffff0000, v52
v_mfma_f32_16x16x32_bf16 v[120:123], v[164:167], v[40:43], v[120:123]
ds_read_b64_tr_b16 v[160:161], v12 offset:27712
ds_read_b64_tr_b16 v[162:163], v12 offset:32320
buffer_load_dwordx4 v4, s[48:51], s99 offen offset:1024 lds
v_and_b32 v29, 0xffff0000, v53
v_fma_f32 v26, v26, v20, v22
v_fma_f32 v28, v28, v20, v22
v_mfma_f32_16x16x32_bf16 v[124:127], v[168:171], v[40:43], v[124:127]
ds_read_b64_tr_b16 v[164:165], v12 offset:27744
ds_read_b64_tr_b16 v[166:167], v12 offset:32352
buffer_load_dwordx4 v5, s[48:51], s99 offen offset:2048 lds
v_fma_f32 v27, v27, v20, v22
v_fma_f32 v29, v29, v20, v22
s_waitcnt lgkmcnt(8)
v_mfma_f32_16x16x32_bf16 v[128:131], v[140:143], v[40:43], v[128:131]
ds_read_b64_tr_b16 v[168:169], v12 offset:27776
ds_read_b64_tr_b16 v[170:171], v12 offset:32384
buffer_load_dwordx4 v6, s[48:51], s99 offen offset:3072 lds
s_add_u32 m0, s98, 114688
v_cvt_pk_bf16_f32 v52, v26, v27
v_mfma_f32_16x16x32_bf16 v[132:135], v[144:147], v[40:43], v[132:135]
ds_read_b64_tr_b16 v[140:141], v12 offset:27808
ds_read_b64_tr_b16 v[142:143], v12 offset:32416
buffer_load_dwordx4 v7, s[48:51], s99 offen offset:0 lds
v_cvt_pk_bf16_f32 v53, v28, v29
v_lshlrev_b32 v26, 16, v54
v_lshlrev_b32 v28, 16, v55
v_mfma_f32_16x16x32_bf16 v[136:139], v[148:151], v[40:43], v[136:139]
ds_read_b64_tr_b16 v[144:145], v12 offset:27840
ds_read_b64_tr_b16 v[146:147], v12 offset:32448
buffer_load_dwordx4 v8, s[48:51], s99 offen offset:1024 lds
v_and_b32 v27, 0xffff0000, v54
v_and_b32 v29, 0xffff0000, v55
s_waitcnt lgkmcnt(8)
v_mfma_f32_16x16x32_bf16 v[104:107], v[152:155], v[44:47], v[104:107]
ds_read_b64_tr_b16 v[148:149], v12 offset:27872
ds_read_b64_tr_b16 v[150:151], v12 offset:32480
buffer_load_dwordx4 v9, s[48:51], s99 offen offset:2048 lds
v_fma_f32 v26, v26, v20, v22
v_fma_f32 v28, v28, v20, v22
v_mfma_f32_16x16x32_bf16 v[108:111], v[156:159], v[44:47], v[108:111]
ds_read_b64_tr_b16 v[152:153], v12 offset:27904
ds_read_b64_tr_b16 v[154:155], v12 offset:32512
buffer_load_dwordx4 v10, s[48:51], s99 offen offset:3072 lds
s_add_u32 m0, s98, 118784
s_nop 0
buffer_load_dwordx4 v11, s[48:51], s99 offen offset:0 lds
v_fma_f32 v27, v27, v20, v22
v_mfma_f32_16x16x32_bf16 v[112:115], v[160:163], v[44:47], v[112:115]
s_waitcnt vmcnt(19)
s_barrier
ds_read_b64_tr_b16 v[156:157], v12 offset:36864
ds_read_b64_tr_b16 v[158:159], v12 offset:41472
v_fma_f32 v29, v29, v20, v22
v_cvt_pk_bf16_f32 v54, v26, v27
v_cvt_pk_bf16_f32 v55, v28, v29
s_waitcnt lgkmcnt(8)
v_mfma_f32_16x16x32_bf16 v[116:119], v[164:167], v[44:47], v[116:119]
ds_read_b64_tr_b16 v[160:161], v12 offset:36896
ds_read_b64_tr_b16 v[162:163], v12 offset:41504
v_lshlrev_b32 v26, 16, v56
v_lshlrev_b32 v28, 16, v57
v_mfma_f32_16x16x32_bf16 v[120:123], v[168:171], v[44:47], v[120:123]
ds_read_b64_tr_b16 v[164:165], v12 offset:36928
ds_read_b64_tr_b16 v[166:167], v12 offset:41536
v_and_b32 v27, 0xffff0000, v56
v_and_b32 v29, 0xffff0000, v57
v_mfma_f32_16x16x32_bf16 v[124:127], v[140:143], v[44:47], v[124:127]
ds_read_b64_tr_b16 v[168:169], v12 offset:36960
ds_read_b64_tr_b16 v[170:171], v12 offset:41568
v_fma_f32 v26, v26, v20, v22
v_fma_f32 v28, v28, v20, v22
s_waitcnt lgkmcnt(8)
v_mfma_f32_16x16x32_bf16 v[128:131], v[144:147], v[44:47], v[128:131]
ds_read_b64_tr_b16 v[140:141], v12 offset:36992
ds_read_b64_tr_b16 v[142:143], v12 offset:41600
v_fma_f32 v27, v27, v20, v22
v_fma_f32 v29, v29, v20, v22
v_mfma_f32_16x16x32_bf16 v[132:135], v[148:151], v[44:47], v[132:135]
ds_read_b64_tr_b16 v[144:145], v12 offset:37024
ds_read_b64_tr_b16 v[146:147], v12 offset:41632
v_cvt_pk_bf16_f32 v56, v26, v27
v_cvt_pk_bf16_f32 v57, v28, v29
v_mfma_f32_16x16x32_bf16 v[136:139], v[152:155], v[44:47], v[136:139]
ds_read_b64_tr_b16 v[148:149], v12 offset:37056
ds_read_b64_tr_b16 v[150:151], v12 offset:41664
v_lshlrev_b32 v26, 16, v58
v_lshlrev_b32 v28, 16, v59
s_waitcnt lgkmcnt(8)
v_mfma_f32_16x16x32_bf16 v[104:107], v[156:159], v[48:51], v[104:107]
ds_read_b64_tr_b16 v[152:153], v12 offset:37088
ds_read_b64_tr_b16 v[154:155], v12 offset:41696
v_and_b32 v27, 0xffff0000, v58
v_and_b32 v29, 0xffff0000, v59
v_mfma_f32_16x16x32_bf16 v[108:111], v[160:163], v[48:51], v[108:111]
ds_read_b64_tr_b16 v[156:157], v12 offset:37120
ds_read_b64_tr_b16 v[158:159], v12 offset:41728
v_fma_f32 v26, v26, v20, v22
v_fma_f32 v28, v28, v20, v22
v_mfma_f32_16x16x32_bf16 v[112:115], v[164:167], v[48:51], v[112:115]
ds_read_b64_tr_b16 v[160:161], v12 offset:46080
ds_read_b64_tr_b16 v[162:163], v12 offset:50688
v_fma_f32 v27, v27, v20, v22
v_fma_f32 v29, v29, v20, v22
s_waitcnt lgkmcnt(8)
v_mfma_f32_16x16x32_bf16 v[116:119], v[168:171], v[48:51], v[116:119]
ds_read_b64_tr_b16 v[164:165], v12 offset:46112
ds_read_b64_tr_b16 v[166:167], v12 offset:50720
v_cvt_pk_bf16_f32 v58, v26, v27
v_cvt_pk_bf16_f32 v59, v28, v29
v_mfma_f32_16x16x32_bf16 v[120:123], v[140:143], v[48:51], v[120:123]
ds_read_b64_tr_b16 v[168:169], v12 offset:46144
ds_read_b64_tr_b16 v[170:171], v12 offset:50752
v_lshlrev_b32 v26, 16, v60
v_lshlrev_b32 v28, 16, v61
v_mfma_f32_16x16x32_bf16 v[124:127], v[144:147], v[48:51], v[124:127]
ds_read_b64_tr_b16 v[140:141], v12 offset:46176
ds_read_b64_tr_b16 v[142:143], v12 offset:50784
v_and_b32 v27, 0xffff0000, v60
v_and_b32 v29, 0xffff0000, v61
s_waitcnt lgkmcnt(8)
v_mfma_f32_16x16x32_bf16 v[128:131], v[148:151], v[48:51], v[128:131]
ds_read_b64_tr_b16 v[144:145], v12 offset:46208
ds_read_b64_tr_b16 v[146:147], v12 offset:50816
v_fma_f32 v26, v26, v20, v22
v_fma_f32 v28, v28, v20, v22
v_mfma_f32_16x16x32_bf16 v[132:135], v[152:155], v[48:51], v[132:135]
ds_read_b64_tr_b16 v[148:149], v12 offset:46240
ds_read_b64_tr_b16 v[150:151], v12 offset:50848
v_fma_f32 v27, v27, v20, v22
v_fma_f32 v29, v29, v20, v22
v_mfma_f32_16x16x32_bf16 v[136:139], v[156:159], v[48:51], v[136:139]
ds_read_b64_tr_b16 v[152:153], v12 offset:46272
ds_read_b64_tr_b16 v[154:155], v12 offset:50880
v_cvt_pk_bf16_f32 v60, v26, v27
v_cvt_pk_bf16_f32 v61, v28, v29
s_waitcnt lgkmcnt(8)
v_mfma_f32_16x16x32_bf16 v[104:107], v[160:163], v[52:55], v[104:107]
ds_read_b64_tr_b16 v[156:157], v12 offset:46304
ds_read_b64_tr_b16 v[158:159], v12 offset:50912
v_lshlrev_b32 v26, 16, v62
v_lshlrev_b32 v28, 16, v63
v_mfma_f32_16x16x32_bf16 v[108:111], v[164:167], v[52:55], v[108:111]
ds_read_b64_tr_b16 v[160:161], v12 offset:46336
ds_read_b64_tr_b16 v[162:163], v12 offset:50944
v_and_b32 v27, 0xffff0000, v62
v_and_b32 v29, 0xffff0000, v63
v_mfma_f32_16x16x32_bf16 v[112:115], v[168:171], v[52:55], v[112:115]
ds_read_b64_tr_b16 v[164:165], v12 offset:55296
ds_read_b64_tr_b16 v[166:167], v12 offset:59904
v_fma_f32 v26, v26, v20, v22
v_fma_f32 v28, v28, v20, v22
s_waitcnt lgkmcnt(8)
v_mfma_f32_16x16x32_bf16 v[116:119], v[140:143], v[52:55], v[116:119]
ds_read_b64_tr_b16 v[168:169], v12 offset:55328
ds_read_b64_tr_b16 v[170:171], v12 offset:59936
v_fma_f32 v27, v27, v20, v22
v_fma_f32 v29, v29, v20, v22
v_mfma_f32_16x16x32_bf16 v[120:123], v[144:147], v[52:55], v[120:123]
ds_read_b64_tr_b16 v[140:141], v12 offset:55360
ds_read_b64_tr_b16 v[142:143], v12 offset:59968
v_cvt_pk_bf16_f32 v62, v26, v27
v_cvt_pk_bf16_f32 v63, v28, v29
v_mfma_f32_16x16x32_bf16 v[124:127], v[148:151], v[52:55], v[124:127]
ds_read_b64_tr_b16 v[144:145], v12 offset:55392
ds_read_b64_tr_b16 v[146:147], v12 offset:60000
v_lshlrev_b32 v26, 16, v64
v_lshlrev_b32 v28, 16, v65
s_waitcnt lgkmcnt(8)
v_mfma_f32_16x16x32_bf16 v[128:131], v[152:155], v[52:55], v[128:131]
ds_read_b64_tr_b16 v[148:149], v12 offset:55424
ds_read_b64_tr_b16 v[150:151], v12 offset:60032
v_and_b32 v27, 0xffff0000, v64
v_and_b32 v29, 0xffff0000, v65
v_mfma_f32_16x16x32_bf16 v[132:135], v[156:159], v[52:55], v[132:135]
ds_read_b64_tr_b16 v[152:153], v12 offset:55456
ds_read_b64_tr_b16 v[154:155], v12 offset:60064
v_fma_f32 v26, v26, v20, v22
v_fma_f32 v28, v28, v20, v22
v_mfma_f32_16x16x32_bf16 v[136:139], v[160:163], v[52:55], v[136:139]
ds_read_b64_tr_b16 v[156:157], v12 offset:55488
ds_read_b64_tr_b16 v[158:159], v12 offset:60096
v_fma_f32 v27, v27, v20, v22
v_fma_f32 v29, v29, v20, v22
s_waitcnt lgkmcnt(8)
v_mfma_f32_16x16x32_bf16 v[104:107], v[164:167], v[56:59], v[104:107]
ds_read_b64_tr_b16 v[160:161], v12 offset:55520
ds_read_b64_tr_b16 v[162:163], v12 offset:60128
v_cvt_pk_bf16_f32 v64, v26, v27
v_cvt_pk_bf16_f32 v65, v28, v29
v_mfma_f32_16x16x32_bf16 v[108:111], v[168:171], v[56:59], v[108:111]
ds_read_b64_tr_b16 v[164:165], v12 offset:55552
ds_read_b64_tr_b16 v[166:167], v12 offset:60160
v_lshlrev_b32 v26, 16, v66
v_lshlrev_b32 v28, 16, v67
v_mfma_f32_16x16x32_bf16 v[112:115], v[140:143], v[56:59], v[112:115]
ds_read_b64_tr_b16 v[168:169], v13 offset:0
ds_read_b64_tr_b16 v[170:171], v13 offset:4608
v_and_b32 v27, 0xffff0000, v66
v_and_b32 v29, 0xffff0000, v67
s_waitcnt lgkmcnt(8)
v_mfma_f32_16x16x32_bf16 v[116:119], v[144:147], v[56:59], v[116:119]
ds_read_b64_tr_b16 v[140:141], v13 offset:32
ds_read_b64_tr_b16 v[142:143], v13 offset:4640
v_fma_f32 v26, v26, v20, v22
v_fma_f32 v28, v28, v20, v22
v_mfma_f32_16x16x32_bf16 v[120:123], v[148:151], v[56:59], v[120:123]
ds_read_b64_tr_b16 v[144:145], v13 offset:64
ds_read_b64_tr_b16 v[146:147], v13 offset:4672
v_fma_f32 v27, v27, v20, v22
v_fma_f32 v29, v29, v20, v22
v_mfma_f32_16x16x32_bf16 v[124:127], v[152:155], v[56:59], v[124:127]
ds_read_b64_tr_b16 v[148:149], v13 offset:96
ds_read_b64_tr_b16 v[150:151], v13 offset:4704
v_cvt_pk_bf16_f32 v66, v26, v27
v_cvt_pk_bf16_f32 v67, v28, v29
s_waitcnt lgkmcnt(8)
v_mfma_f32_16x16x32_bf16 v[128:131], v[156:159], v[56:59], v[128:131]
ds_read_b64_tr_b16 v[152:153], v13 offset:128
ds_read_b64_tr_b16 v[154:155], v13 offset:4736
v_lshlrev_b32 v26, 16, v68
v_lshlrev_b32 v28, 16, v69
v_mfma_f32_16x16x32_bf16 v[132:135], v[160:163], v[56:59], v[132:135]
ds_read_b64_tr_b16 v[156:157], v13 offset:160
ds_read_b64_tr_b16 v[158:159], v13 offset:4768
v_and_b32 v27, 0xffff0000, v68
v_and_b32 v29, 0xffff0000, v69
v_mfma_f32_16x16x32_bf16 v[136:139], v[164:167], v[56:59], v[136:139]
ds_read_b64_tr_b16 v[160:161], v13 offset:192
ds_read_b64_tr_b16 v[162:163], v13 offset:4800
v_fma_f32 v26, v26, v20, v22
v_fma_f32 v28, v28, v20, v22
s_waitcnt lgkmcnt(8)
v_mfma_f32_16x16x32_bf16 v[104:107], v[168:171], v[60:63], v[104:107]
ds_read_b64_tr_b16 v[164:165], v13 offset:224
ds_read_b64_tr_b16 v[166:167], v13 offset:4832
v_fma_f32 v27, v27, v20, v22
v_fma_f32 v29, v29, v20, v22
v_mfma_f32_16x16x32_bf16 v[108:111], v[140:143], v[60:63], v[108:111]
ds_read_b64_tr_b16 v[168:169], v13 offset:256
ds_read_b64_tr_b16 v[170:171], v13 offset:4864
v_cvt_pk_bf16_f32 v68, v26, v27
v_cvt_pk_bf16_f32 v69, v28, v29
v_mfma_f32_16x16x32_bf16 v[112:115], v[144:147], v[60:63], v[112:115]
s_waitcnt vmcnt(9)
s_barrier
ds_read_b64_tr_b16 v[140:141], v13 offset:9216
ds_read_b64_tr_b16 v[142:143], v13 offset:13824
v_lshlrev_b32 v26, 16, v70
v_lshlrev_b32 v28, 16, v71
s_waitcnt lgkmcnt(8)
v_mfma_f32_16x16x32_bf16 v[116:119], v[148:151], v[60:63], v[116:119]
ds_read_b64_tr_b16 v[144:145], v13 offset:9248
ds_read_b64_tr_b16 v[146:147], v13 offset:13856
v_and_b32 v27, 0xffff0000, v70
v_and_b32 v29, 0xffff0000, v71
v_mfma_f32_16x16x32_bf16 v[120:123], v[152:155], v[60:63], v[120:123]
ds_read_b64_tr_b16 v[148:149], v13 offset:9280
ds_read_b64_tr_b16 v[150:151], v13 offset:13888
v_fma_f32 v26, v26, v20, v22
v_fma_f32 v28, v28, v20, v22
v_mfma_f32_16x16x32_bf16 v[124:127], v[156:159], v[60:63], v[124:127]
ds_read_b64_tr_b16 v[152:153], v13 offset:9312
ds_read_b64_tr_b16 v[154:155], v13 offset:13920
v_fma_f32 v27, v27, v20, v22
v_fma_f32 v29, v29, v20, v22
s_waitcnt lgkmcnt(8)
v_mfma_f32_16x16x32_bf16 v[128:131], v[160:163], v[60:63], v[128:131]
ds_read_b64_tr_b16 v[156:157], v13 offset:9344
ds_read_b64_tr_b16 v[158:159], v13 offset:13952
v_cvt_pk_bf16_f32 v70, v26, v27
v_cvt_pk_bf16_f32 v71, v28, v29
v_mfma_f32_16x16x32_bf16 v[132:135], v[164:167], v[60:63], v[132:135]
ds_read_b64_tr_b16 v[160:161], v13 offset:9376
ds_read_b64_tr_b16 v[162:163], v13 offset:13984
v_lshlrev_b32 v26, 16, v72
v_lshlrev_b32 v28, 16, v73
v_mfma_f32_16x16x32_bf16 v[136:139], v[168:171], v[60:63], v[136:139]
ds_read_b64_tr_b16 v[164:165], v13 offset:9408
ds_read_b64_tr_b16 v[166:167], v13 offset:14016
v_and_b32 v27, 0xffff0000, v72
v_and_b32 v29, 0xffff0000, v73
s_waitcnt lgkmcnt(8)
v_mfma_f32_16x16x32_bf16 v[104:107], v[140:143], v[64:67], v[104:107]
ds_read_b64_tr_b16 v[168:169], v13 offset:9440
ds_read_b64_tr_b16 v[170:171], v13 offset:14048
v_fma_f32 v26, v26, v20, v22
v_fma_f32 v28, v28, v20, v22
v_mfma_f32_16x16x32_bf16 v[108:111], v[144:147], v[64:67], v[108:111]
ds_read_b64_tr_b16 v[140:141], v13 offset:9472
ds_read_b64_tr_b16 v[142:143], v13 offset:14080
v_fma_f32 v27, v27, v20, v22
v_fma_f32 v29, v29, v20, v22
v_mfma_f32_16x16x32_bf16 v[112:115], v[148:151], v[64:67], v[112:115]
ds_read_b64_tr_b16 v[144:145], v13 offset:18432
ds_read_b64_tr_b16 v[146:147], v13 offset:23040
v_cvt_pk_bf16_f32 v72, v26, v27
v_cvt_pk_bf16_f32 v73, v28, v29
s_waitcnt lgkmcnt(8)
v_mfma_f32_16x16x32_bf16 v[116:119], v[152:155], v[64:67], v[116:119]
ds_read_b64_tr_b16 v[148:149], v13 offset:18464
ds_read_b64_tr_b16 v[150:151], v13 offset:23072
v_lshlrev_b32 v26, 16, v74
v_lshlrev_b32 v28, 16, v75
v_mfma_f32_16x16x32_bf16 v[120:123], v[156:159], v[64:67], v[120:123]
ds_read_b64_tr_b16 v[152:153], v13 offset:18496
ds_read_b64_tr_b16 v[154:155], v13 offset:23104
v_and_b32 v27, 0xffff0000, v74
v_and_b32 v29, 0xffff0000, v75
v_mfma_f32_16x16x32_bf16 v[124:127], v[160:163], v[64:67], v[124:127]
ds_read_b64_tr_b16 v[156:157], v13 offset:18528
ds_read_b64_tr_b16 v[158:159], v13 offset:23136
v_fma_f32 v26, v26, v20, v22
v_fma_f32 v28, v28, v20, v22
s_waitcnt lgkmcnt(8)
v_mfma_f32_16x16x32_bf16 v[128:131], v[164:167], v[64:67], v[128:131]
ds_read_b64_tr_b16 v[160:161], v13 offset:18560
ds_read_b64_tr_b16 v[162:163], v13 offset:23168
v_fma_f32 v27, v27, v20, v22
v_fma_f32 v29, v29, v20, v22
v_mfma_f32_16x16x32_bf16 v[132:135], v[168:171], v[64:67], v[132:135]
ds_read_b64_tr_b16 v[164:165], v13 offset:18592
ds_read_b64_tr_b16 v[166:167], v13 offset:23200
v_cvt_pk_bf16_f32 v74, v26, v27
v_cvt_pk_bf16_f32 v75, v28, v29
v_mfma_f32_16x16x32_bf16 v[136:139], v[140:143], v[64:67], v[136:139]
ds_read_b64_tr_b16 v[168:169], v13 offset:18624
ds_read_b64_tr_b16 v[170:171], v13 offset:23232
v_lshlrev_b32 v26, 16, v76
v_lshlrev_b32 v28, 16, v77
s_waitcnt lgkmcnt(8)
v_mfma_f32_16x16x32_bf16 v[104:107], v[144:147], v[68:71], v[104:107]
ds_read_b64_tr_b16 v[140:141], v13 offset:18656
ds_read_b64_tr_b16 v[142:143], v13 offset:23264
v_and_b32 v27, 0xffff0000, v76
v_and_b32 v29, 0xffff0000, v77
v_mfma_f32_16x16x32_bf16 v[108:111], v[148:151], v[68:71], v[108:111]
ds_read_b64_tr_b16 v[144:145], v13 offset:18688
ds_read_b64_tr_b16 v[146:147], v13 offset:23296
v_fma_f32 v26, v26, v20, v22
v_fma_f32 v28, v28, v20, v22
v_mfma_f32_16x16x32_bf16 v[112:115], v[152:155], v[68:71], v[112:115]
ds_read_b64_tr_b16 v[148:149], v13 offset:27648
ds_read_b64_tr_b16 v[150:151], v13 offset:32256
v_fma_f32 v27, v27, v20, v22
v_fma_f32 v29, v29, v20, v22
s_waitcnt lgkmcnt(8)
v_mfma_f32_16x16x32_bf16 v[116:119], v[156:159], v[68:71], v[116:119]
ds_read_b64_tr_b16 v[152:153], v13 offset:27680
ds_read_b64_tr_b16 v[154:155], v13 offset:32288
v_cvt_pk_bf16_f32 v76, v26, v27
v_cvt_pk_bf16_f32 v77, v28, v29
v_mfma_f32_16x16x32_bf16 v[120:123], v[160:163], v[68:71], v[120:123]
ds_read_b64_tr_b16 v[156:157], v13 offset:27712
ds_read_b64_tr_b16 v[158:159], v13 offset:32320
v_lshlrev_b32 v26, 16, v78
v_lshlrev_b32 v28, 16, v79
v_mfma_f32_16x16x32_bf16 v[124:127], v[164:167], v[68:71], v[124:127]
ds_read_b64_tr_b16 v[160:161], v13 offset:27744
ds_read_b64_tr_b16 v[162:163], v13 offset:32352
v_and_b32 v27, 0xffff0000, v78
v_and_b32 v29, 0xffff0000, v79
s_waitcnt lgkmcnt(8)
v_mfma_f32_16x16x32_bf16 v[128:131], v[168:171], v[68:71], v[128:131]
ds_read_b64_tr_b16 v[164:165], v13 offset:27776
ds_read_b64_tr_b16 v[166:167], v13 offset:32384
v_fma_f32 v26, v26, v20, v22
v_fma_f32 v28, v28, v20, v22
v_mfma_f32_16x16x32_bf16 v[132:135], v[140:143], v[68:71], v[132:135]
ds_read_b64_tr_b16 v[168:169], v13 offset:27808
ds_read_b64_tr_b16 v[170:171], v13 offset:32416
v_fma_f32 v27, v27, v20, v22
v_fma_f32 v29, v29, v20, v22
v_mfma_f32_16x16x32_bf16 v[136:139], v[144:147], v[68:71], v[136:139]
ds_read_b64_tr_b16 v[140:141], v13 offset:27840
ds_read_b64_tr_b16 v[142:143], v13 offset:32448
v_cvt_pk_bf16_f32 v78, v26, v27
v_cvt_pk_bf16_f32 v79, v28, v29
s_waitcnt lgkmcnt(8)
v_mfma_f32_16x16x32_bf16 v[104:107], v[148:151], v[72:75], v[104:107]
ds_read_b64_tr_b16 v[144:145], v13 offset:27872
ds_read_b64_tr_b16 v[146:147], v13 offset:32480
s_mov_b32 s99, s24
s_add_u32 m0, s98, 0
v_lshlrev_b32 v26, 16, v80
v_lshlrev_b32 v28, 16, v81
v_mfma_f32_16x16x32_bf16 v[108:111], v[152:155], v[72:75], v[108:111]
ds_read_b64_tr_b16 v[148:149], v13 offset:27904
ds_read_b64_tr_b16 v[150:151], v13 offset:32512
buffer_load_dwordx4 v3, s[20:23], s99 offen offset:0 lds
v_and_b32 v27, 0xffff0000, v80
v_and_b32 v29, 0xffff0000, v81
v_mfma_f32_16x16x32_bf16 v[112:115], v[156:159], v[72:75], v[112:115]
ds_read_b64_tr_b16 v[152:153], v13 offset:36864
ds_read_b64_tr_b16 v[154:155], v13 offset:41472
buffer_load_dwordx4 v4, s[20:23], s99 offen offset:1024 lds
v_fma_f32 v26, v26, v20, v22
v_fma_f32 v28, v28, v20, v22
s_waitcnt lgkmcnt(8)
v_mfma_f32_16x16x32_bf16 v[116:119], v[160:163], v[72:75], v[116:119]
ds_read_b64_tr_b16 v[156:157], v13 offset:36896
ds_read_b64_tr_b16 v[158:159], v13 offset:41504
buffer_load_dwordx4 v5, s[20:23], s99 offen offset:2048 lds
v_fma_f32 v27, v27, v20, v22
v_fma_f32 v29, v29, v20, v22
v_mfma_f32_16x16x32_bf16 v[120:123], v[164:167], v[72:75], v[120:123]
ds_read_b64_tr_b16 v[160:161], v13 offset:36928
ds_read_b64_tr_b16 v[162:163], v13 offset:41536
buffer_load_dwordx4 v6, s[20:23], s99 offen offset:3072 lds
s_add_u32 m0, s98, 4096
v_cvt_pk_bf16_f32 v80, v26, v27
v_cvt_pk_bf16_f32 v81, v28, v29
v_mfma_f32_16x16x32_bf16 v[124:127], v[168:171], v[72:75], v[124:127]
ds_read_b64_tr_b16 v[164:165], v13 offset:36960
ds_read_b64_tr_b16 v[166:167], v13 offset:41568
buffer_load_dwordx4 v7, s[20:23], s99 offen offset:0 lds
buffer_load_dwordx4 v8, s[20:23], s99 offen offset:1024 lds
buffer_load_dwordx4 v9, s[20:23], s99 offen offset:2048 lds
buffer_load_dwordx4 v10, s[20:23], s99 offen offset:3072 lds
s_add_u32 m0, s98, 8192
s_nop 0
buffer_load_dwordx4 v11, s[20:23], s99 offen offset:0 lds
s_waitcnt lgkmcnt(8)
v_mfma_f32_16x16x32_bf16 v[128:131], v[140:143], v[72:75], v[128:131]
ds_read_b64_tr_b16 v[168:169], v13 offset:36992
ds_read_b64_tr_b16 v[170:171], v13 offset:41600
v_lshlrev_b32 v26, 16, v82
v_lshlrev_b32 v28, 16, v83
v_and_b32 v27, 0xffff0000, v82
v_mfma_f32_16x16x32_bf16 v[132:135], v[144:147], v[72:75], v[132:135]
ds_read_b64_tr_b16 v[140:141], v13 offset:37024
ds_read_b64_tr_b16 v[142:143], v13 offset:41632
v_and_b32 v29, 0xffff0000, v83
v_fma_f32 v26, v26, v20, v22
v_mfma_f32_16x16x32_bf16 v[136:139], v[148:151], v[72:75], v[136:139]
ds_read_b64_tr_b16 v[144:145], v13 offset:37056
ds_read_b64_tr_b16 v[146:147], v13 offset:41664
v_fma_f32 v28, v28, v20, v22
v_fma_f32 v27, v27, v20, v22
v_fma_f32 v29, v29, v20, v22
s_waitcnt lgkmcnt(8)
v_mfma_f32_16x16x32_bf16 v[104:107], v[152:155], v[76:79], v[104:107]
ds_read_b64_tr_b16 v[148:149], v13 offset:37088
ds_read_b64_tr_b16 v[150:151], v13 offset:41696
v_cvt_pk_bf16_f32 v82, v26, v27
v_cvt_pk_bf16_f32 v83, v28, v29
v_mfma_f32_16x16x32_bf16 v[108:111], v[156:159], v[76:79], v[108:111]
ds_read_b64_tr_b16 v[152:153], v13 offset:37120
ds_read_b64_tr_b16 v[154:155], v13 offset:41728
v_lshlrev_b32 v26, 16, v84
v_lshlrev_b32 v28, 16, v85
v_mfma_f32_16x16x32_bf16 v[112:115], v[160:163], v[76:79], v[112:115]
s_waitcnt vmcnt(9)
s_barrier
ds_read_b64_tr_b16 v[156:157], v13 offset:46080
ds_read_b64_tr_b16 v[158:159], v13 offset:50688
v_and_b32 v27, 0xffff0000, v84
v_and_b32 v29, 0xffff0000, v85
s_waitcnt lgkmcnt(8)
v_mfma_f32_16x16x32_bf16 v[116:119], v[164:167], v[76:79], v[116:119]
ds_read_b64_tr_b16 v[160:161], v13 offset:46112
ds_read_b64_tr_b16 v[162:163], v13 offset:50720
v_fma_f32 v26, v26, v20, v22
v_fma_f32 v28, v28, v20, v22
v_mfma_f32_16x16x32_bf16 v[120:123], v[168:171], v[76:79], v[120:123]
ds_read_b64_tr_b16 v[164:165], v13 offset:46144
ds_read_b64_tr_b16 v[166:167], v13 offset:50752
v_fma_f32 v27, v27, v20, v22
v_fma_f32 v29, v29, v20, v22
v_mfma_f32_16x16x32_bf16 v[124:127], v[140:143], v[76:79], v[124:127]
ds_read_b64_tr_b16 v[168:169], v13 offset:46176
ds_read_b64_tr_b16 v[170:171], v13 offset:50784
v_cvt_pk_bf16_f32 v84, v26, v27
v_cvt_pk_bf16_f32 v85, v28, v29
s_waitcnt lgkmcnt(8)
v_mfma_f32_16x16x32_bf16 v[128:131], v[144:147], v[76:79], v[128:131]
ds_read_b64_tr_b16 v[140:141], v13 offset:46208
ds_read_b64_tr_b16 v[142:143], v13 offset:50816
v_lshlrev_b32 v26, 16, v86
v_lshlrev_b32 v28, 16, v87
v_mfma_f32_16x16x32_bf16 v[132:135], v[148:151], v[76:79], v[132:135]
ds_read_b64_tr_b16 v[144:145], v13 offset:46240
ds_read_b64_tr_b16 v[146:147], v13 offset:50848
v_and_b32 v27, 0xffff0000, v86
v_and_b32 v29, 0xffff0000, v87
v_mfma_f32_16x16x32_bf16 v[136:139], v[152:155], v[76:79], v[136:139]
ds_read_b64_tr_b16 v[148:149], v13 offset:46272
ds_read_b64_tr_b16 v[150:151], v13 offset:50880
v_fma_f32 v26, v26, v20, v22
v_fma_f32 v28, v28, v20, v22
s_waitcnt lgkmcnt(8)
v_mfma_f32_16x16x32_bf16 v[104:107], v[156:159], v[80:83], v[104:107]
ds_read_b64_tr_b16 v[152:153], v13 offset:46304
ds_read_b64_tr_b16 v[154:155], v13 offset:50912
v_fma_f32 v27, v27, v20, v22
v_fma_f32 v29, v29, v20, v22
v_mfma_f32_16x16x32_bf16 v[108:111], v[160:163], v[80:83], v[108:111]
ds_read_b64_tr_b16 v[156:157], v13 offset:46336
ds_read_b64_tr_b16 v[158:159], v13 offset:50944
v_cvt_pk_bf16_f32 v86, v26, v27
v_cvt_pk_bf16_f32 v87, v28, v29
v_mfma_f32_16x16x32_bf16 v[112:115], v[164:167], v[80:83], v[112:115]
ds_read_b64_tr_b16 v[160:161], v13 offset:55296
ds_read_b64_tr_b16 v[162:163], v13 offset:59904
v_lshlrev_b32 v26, 16, v88
v_lshlrev_b32 v28, 16, v89
s_waitcnt lgkmcnt(8)
v_mfma_f32_16x16x32_bf16 v[116:119], v[168:171], v[80:83], v[116:119]
ds_read_b64_tr_b16 v[164:165], v13 offset:55328
ds_read_b64_tr_b16 v[166:167], v13 offset:59936
v_and_b32 v27, 0xffff0000, v88
v_and_b32 v29, 0xffff0000, v89
v_mfma_f32_16x16x32_bf16 v[120:123], v[140:143], v[80:83], v[120:123]
ds_read_b64_tr_b16 v[168:169], v13 offset:55360
ds_read_b64_tr_b16 v[170:171], v13 offset:59968
v_fma_f32 v26, v26, v20, v22
v_fma_f32 v28, v28, v20, v22
v_mfma_f32_16x16x32_bf16 v[124:127], v[144:147], v[80:83], v[124:127]
ds_read_b64_tr_b16 v[140:141], v13 offset:55392
ds_read_b64_tr_b16 v[142:143], v13 offset:60000
v_fma_f32 v27, v27, v20, v22
v_fma_f32 v29, v29, v20, v22
s_waitcnt lgkmcnt(8)
v_mfma_f32_16x16x32_bf16 v[128:131], v[148:151], v[80:83], v[128:131]
ds_read_b64_tr_b16 v[144:145], v13 offset:55424
ds_read_b64_tr_b16 v[146:147], v13 offset:60032
v_cvt_pk_bf16_f32 v88, v26, v27
v_cvt_pk_bf16_f32 v89, v28, v29
v_mfma_f32_16x16x32_bf16 v[132:135], v[152:155], v[80:83], v[132:135]
ds_read_b64_tr_b16 v[148:149], v13 offset:55456
ds_read_b64_tr_b16 v[150:151], v13 offset:60064
v_lshlrev_b32 v26, 16, v90
v_lshlrev_b32 v28, 16, v91
v_mfma_f32_16x16x32_bf16 v[136:139], v[156:159], v[80:83], v[136:139]
ds_read_b64_tr_b16 v[152:153], v13 offset:55488
ds_read_b64_tr_b16 v[154:155], v13 offset:60096
v_and_b32 v27, 0xffff0000, v90
v_and_b32 v29, 0xffff0000, v91
s_waitcnt lgkmcnt(8)
v_mfma_f32_16x16x32_bf16 v[104:107], v[160:163], v[84:87], v[104:107]
ds_read_b64_tr_b16 v[156:157], v13 offset:55520
ds_read_b64_tr_b16 v[158:159], v13 offset:60128
v_fma_f32 v26, v26, v20, v22
v_fma_f32 v28, v28, v20, v22
v_mfma_f32_16x16x32_bf16 v[108:111], v[164:167], v[84:87], v[108:111]
ds_read_b64_tr_b16 v[160:161], v13 offset:55552
ds_read_b64_tr_b16 v[162:163], v13 offset:60160
v_fma_f32 v27, v27, v20, v22
v_fma_f32 v29, v29, v20, v22
v_mfma_f32_16x16x32_bf16 v[112:115], v[168:171], v[84:87], v[112:115]
ds_read_b64_tr_b16 v[164:165], v14 offset:0
ds_read_b64_tr_b16 v[166:167], v14 offset:4608
v_cvt_pk_bf16_f32 v90, v26, v27
v_cvt_pk_bf16_f32 v91, v28, v29
s_waitcnt lgkmcnt(8)
v_mfma_f32_16x16x32_bf16 v[116:119], v[140:143], v[84:87], v[116:119]
ds_read_b64_tr_b16 v[168:169], v14 offset:32
ds_read_b64_tr_b16 v[170:171], v14 offset:4640
v_lshlrev_b32 v26, 16, v92
v_lshlrev_b32 v28, 16, v93
v_mfma_f32_16x16x32_bf16 v[120:123], v[144:147], v[84:87], v[120:123]
ds_read_b64_tr_b16 v[140:141], v14 offset:64
ds_read_b64_tr_b16 v[142:143], v14 offset:4672
v_and_b32 v27, 0xffff0000, v92
v_and_b32 v29, 0xffff0000, v93
v_mfma_f32_16x16x32_bf16 v[124:127], v[148:151], v[84:87], v[124:127]
ds_read_b64_tr_b16 v[144:145], v14 offset:96
ds_read_b64_tr_b16 v[146:147], v14 offset:4704
v_fma_f32 v26, v26, v20, v22
v_fma_f32 v28, v28, v20, v22
s_waitcnt lgkmcnt(8)
v_mfma_f32_16x16x32_bf16 v[128:131], v[152:155], v[84:87], v[128:131]
ds_read_b64_tr_b16 v[148:149], v14 offset:128
ds_read_b64_tr_b16 v[150:151], v14 offset:4736
v_fma_f32 v27, v27, v20, v22
v_fma_f32 v29, v29, v20, v22
s_add_u32 s99, s18, 73728
s_add_u32 m0, s98, 36864
v_mfma_f32_16x16x32_bf16 v[132:135], v[156:159], v[84:87], v[132:135]
ds_read_b64_tr_b16 v[152:153], v14 offset:160
ds_read_b64_tr_b16 v[154:155], v14 offset:4768
buffer_load_dwordx4 v3, s[52:55], s99 offen offset:0 lds
v_cvt_pk_bf16_f32 v92, v26, v27
v_mfma_f32_16x16x32_bf16 v[136:139], v[160:163], v[84:87], v[136:139]
ds_read_b64_tr_b16 v[156:157], v14 offset:192
ds_read_b64_tr_b16 v[158:159], v14 offset:4800
buffer_load_dwordx4 v4, s[52:55], s99 offen offset:1024 lds
v_cvt_pk_bf16_f32 v93, v28, v29
v_lshlrev_b32 v26, 16, v94
s_waitcnt lgkmcnt(8)
v_mfma_f32_16x16x32_bf16 v[104:107], v[164:167], v[88:91], v[104:107]
ds_read_b64_tr_b16 v[160:161], v14 offset:224
ds_read_b64_tr_b16 v[162:163], v14 offset:4832
buffer_load_dwordx4 v5, s[52:55], s99 offen offset:2048 lds
v_lshlrev_b32 v28, 16, v95
v_and_b32 v27, 0xffff0000, v94
v_mfma_f32_16x16x32_bf16 v[108:111], v[168:171], v[88:91], v[108:111]
ds_read_b64_tr_b16 v[164:165], v14 offset:256
ds_read_b64_tr_b16 v[166:167], v14 offset:4864
buffer_load_dwordx4 v6, s[52:55], s99 offen offset:3072 lds
v_and_b32 v29, 0xffff0000, v95
v_fma_f32 v26, v26, v20, v22
v_mfma_f32_16x16x32_bf16 v[112:115], v[140:143], v[88:91], v[112:115]
ds_read_b64_tr_b16 v[168:169], v14 offset:9216
ds_read_b64_tr_b16 v[170:171], v14 offset:13824
v_fma_f32 v28, v28, v20, v22
v_fma_f32 v27, v27, v20, v22
v_fma_f32 v29, v29, v20, v22
s_waitcnt lgkmcnt(8)
v_mfma_f32_16x16x32_bf16 v[116:119], v[144:147], v[88:91], v[116:119]
ds_read_b64_tr_b16 v[140:141], v14 offset:9248
ds_read_b64_tr_b16 v[142:143], v14 offset:13856
v_cvt_pk_bf16_f32 v94, v26, v27
v_cvt_pk_bf16_f32 v95, v28, v29
s_add_u32 m0, s98, 40960
v_mfma_f32_16x16x32_bf16 v[120:123], v[148:151], v[88:91], v[120:123]
ds_read_b64_tr_b16 v[144:145], v14 offset:9280
ds_read_b64_tr_b16 v[146:147], v14 offset:13888
buffer_load_dwordx4 v7, s[52:55], s99 offen offset:0 lds
v_lshlrev_b32 v26, 16, v96
v_lshlrev_b32 v28, 16, v97
v_mfma_f32_16x16x32_bf16 v[124:127], v[152:155], v[88:91], v[124:127]
ds_read_b64_tr_b16 v[148:149], v14 offset:9312
ds_read_b64_tr_b16 v[150:151], v14 offset:13920
buffer_load_dwordx4 v8, s[52:55], s99 offen offset:1024 lds
buffer_load_dwordx4 v9, s[52:55], s99 offen offset:2048 lds
buffer_load_dwordx4 v10, s[52:55], s99 offen offset:3072 lds
s_add_u32 m0, s98, 45056
s_nop 0
buffer_load_dwordx4 v11, s[52:55], s99 offen offset:0 lds
s_waitcnt lgkmcnt(8)
v_mfma_f32_16x16x32_bf16 v[128:131], v[156:159], v[88:91], v[128:131]
ds_read_b64_tr_b16 v[152:153], v14 offset:9344
ds_read_b64_tr_b16 v[154:155], v14 offset:13952
v_and_b32 v27, 0xffff0000, v96
v_and_b32 v29, 0xffff0000, v97
v_fma_f32 v26, v26, v20, v22
v_mfma_f32_16x16x32_bf16 v[132:135], v[160:163], v[88:91], v[132:135]
ds_read_b64_tr_b16 v[156:157], v14 offset:9376
ds_read_b64_tr_b16 v[158:159], v14 offset:13984
v_fma_f32 v28, v28, v20, v22
v_fma_f32 v27, v27, v20, v22
v_mfma_f32_16x16x32_bf16 v[136:139], v[164:167], v[88:91], v[136:139]
ds_read_b64_tr_b16 v[160:161], v14 offset:9408
ds_read_b64_tr_b16 v[162:163], v14 offset:14016
v_fma_f32 v29, v29, v20, v22
v_cvt_pk_bf16_f32 v96, v26, v27
s_waitcnt lgkmcnt(8)
v_mfma_f32_16x16x32_bf16 v[104:107], v[168:171], v[92:95], v[104:107]
ds_read_b64_tr_b16 v[164:165], v14 offset:9440
ds_read_b64_tr_b16 v[166:167], v14 offset:14048
v_cvt_pk_bf16_f32 v97, v28, v29
v_lshlrev_b32 v26, 16, v98
v_mfma_f32_16x16x32_bf16 v[108:111], v[140:143], v[92:95], v[108:111]
ds_read_b64_tr_b16 v[168:169], v14 offset:9472
ds_read_b64_tr_b16 v[170:171], v14 offset:14080
v_lshlrev_b32 v28, 16, v99
v_and_b32 v27, 0xffff0000, v98
v_mfma_f32_16x16x32_bf16 v[112:115], v[144:147], v[92:95], v[112:115]
s_waitcnt vmcnt(9)
s_barrier
ds_read_b64_tr_b16 v[140:141], v12 offset:0
ds_read_b64_tr_b16 v[142:143], v12 offset:4608
v_and_b32 v29, 0xffff0000, v99
v_fma_f32 v26, v26, v20, v22
v_fma_f32 v28, v28, v20, v22
s_waitcnt lgkmcnt(8)
v_mfma_f32_16x16x32_bf16 v[116:119], v[148:151], v[92:95], v[116:119]
ds_read_b64_tr_b16 v[144:145], v12 offset:32
ds_read_b64_tr_b16 v[146:147], v12 offset:4640
v_fma_f32 v27, v27, v20, v22
v_fma_f32 v29, v29, v20, v22
v_mfma_f32_16x16x32_bf16 v[120:123], v[152:155], v[92:95], v[120:123]
ds_read_b64_tr_b16 v[148:149], v12 offset:64
ds_read_b64_tr_b16 v[150:151], v12 offset:4672
v_cvt_pk_bf16_f32 v98, v26, v27
v_cvt_pk_bf16_f32 v99, v28, v29
v_mfma_f32_16x16x32_bf16 v[124:127], v[156:159], v[92:95], v[124:127]
ds_read_b64_tr_b16 v[152:153], v12 offset:96
ds_read_b64_tr_b16 v[154:155], v12 offset:4704
v_lshlrev_b32 v26, 16, v100
v_lshlrev_b32 v28, 16, v101
s_waitcnt lgkmcnt(8)
v_mfma_f32_16x16x32_bf16 v[128:131], v[160:163], v[92:95], v[128:131]
ds_read_b64_tr_b16 v[156:157], v12 offset:128
ds_read_b64_tr_b16 v[158:159], v12 offset:4736
v_and_b32 v27, 0xffff0000, v100
v_and_b32 v29, 0xffff0000, v101
v_mfma_f32_16x16x32_bf16 v[132:135], v[164:167], v[92:95], v[132:135]
ds_read_b64_tr_b16 v[160:161], v12 offset:160
ds_read_b64_tr_b16 v[162:163], v12 offset:4768
v_fma_f32 v26, v26, v20, v22
v_fma_f32 v28, v28, v20, v22
v_mfma_f32_16x16x32_bf16 v[136:139], v[168:171], v[92:95], v[136:139]
ds_read_b64_tr_b16 v[164:165], v12 offset:192
ds_read_b64_tr_b16 v[166:167], v12 offset:4800
v_fma_f32 v27, v27, v20, v22
v_fma_f32 v29, v29, v20, v22
s_waitcnt lgkmcnt(8)
v_mfma_f32_16x16x32_bf16 v[104:107], v[140:143], v[96:99], v[104:107]
ds_read_b64_tr_b16 v[168:169], v12 offset:224
ds_read_b64_tr_b16 v[170:171], v12 offset:4832
v_cvt_pk_bf16_f32 v100, v26, v27
v_cvt_pk_bf16_f32 v101, v28, v29
v_mfma_f32_16x16x32_bf16 v[108:111], v[144:147], v[96:99], v[108:111]
ds_read_b64_tr_b16 v[140:141], v12 offset:256
ds_read_b64_tr_b16 v[142:143], v12 offset:4864
v_lshlrev_b32 v26, 16, v102
s_add_u32 s99, s18, 221184
s_add_u32 m0, s98, 73728
v_mfma_f32_16x16x32_bf16 v[112:115], v[148:151], v[96:99], v[112:115]
ds_read_b64_tr_b16 v[144:145], v12 offset:9216
ds_read_b64_tr_b16 v[146:147], v12 offset:13824
buffer_load_dwordx4 v3, s[52:55], s99 offen offset:0 lds
v_lshlrev_b32 v28, 16, v103
v_and_b32 v27, 0xffff0000, v102
s_waitcnt lgkmcnt(8)
v_mfma_f32_16x16x32_bf16 v[116:119], v[152:155], v[96:99], v[116:119]
ds_read_b64_tr_b16 v[148:149], v12 offset:9248
ds_read_b64_tr_b16 v[150:151], v12 offset:13856
buffer_load_dwordx4 v4, s[52:55], s99 offen offset:1024 lds
v_and_b32 v29, 0xffff0000, v103
v_mfma_f32_16x16x32_bf16 v[120:123], v[156:159], v[96:99], v[120:123]
ds_read_b64_tr_b16 v[152:153], v12 offset:9280
ds_read_b64_tr_b16 v[154:155], v12 offset:13888
buffer_load_dwordx4 v5, s[52:55], s99 offen offset:2048 lds
v_fma_f32 v26, v26, v20, v22
v_mfma_f32_16x16x32_bf16 v[124:127], v[160:163], v[96:99], v[124:127]
ds_read_b64_tr_b16 v[156:157], v12 offset:9312
ds_read_b64_tr_b16 v[158:159], v12 offset:13920
buffer_load_dwordx4 v6, s[52:55], s99 offen offset:3072 lds
v_fma_f32 v28, v28, v20, v22
v_fma_f32 v27, v27, v20, v22
s_waitcnt lgkmcnt(8)
v_mfma_f32_16x16x32_bf16 v[128:131], v[164:167], v[96:99], v[128:131]
ds_read_b64_tr_b16 v[160:161], v12 offset:9344
ds_read_b64_tr_b16 v[162:163], v12 offset:13952
v_fma_f32 v29, v29, v20, v22
v_cvt_pk_bf16_f32 v102, v26, v27
v_cvt_pk_bf16_f32 v103, v28, v29
v_mfma_f32_16x16x32_bf16 v[132:135], v[168:171], v[96:99], v[132:135]
ds_read_b64_tr_b16 v[164:165], v12 offset:9376
ds_read_b64_tr_b16 v[166:167], v12 offset:13984
s_add_u32 m0, s98, 77824
v_mfma_f32_16x16x32_bf16 v[136:139], v[140:143], v[96:99], v[136:139]
ds_read_b64_tr_b16 v[168:169], v12 offset:9408
ds_read_b64_tr_b16 v[170:171], v12 offset:14016
buffer_load_dwordx4 v7, s[52:55], s99 offen offset:0 lds
s_waitcnt lgkmcnt(8)
v_mfma_f32_16x16x32_bf16 v[104:107], v[144:147], v[100:103], v[104:107]
ds_read_b64_tr_b16 v[140:141], v12 offset:9440
ds_read_b64_tr_b16 v[142:143], v12 offset:14048
buffer_load_dwordx4 v8, s[52:55], s99 offen offset:1024 lds
buffer_load_dwordx4 v9, s[52:55], s99 offen offset:2048 lds
buffer_load_dwordx4 v10, s[52:55], s99 offen offset:3072 lds
s_add_u32 m0, s98, 81920
s_nop 0
buffer_load_dwordx4 v11, s[52:55], s99 offen offset:0 lds
v_mfma_f32_16x16x32_bf16 v[108:111], v[148:151], v[100:103], v[108:111]
ds_read_b64_tr_b16 v[144:145], v12 offset:9472
ds_read_b64_tr_b16 v[146:147], v12 offset:14080
v_mfma_f32_16x16x32_bf16 v[112:115], v[152:155], v[100:103], v[112:115]
s_waitcnt lgkmcnt(6)
v_mfma_f32_16x16x32_bf16 v[116:119], v[156:159], v[100:103], v[116:119]
v_mfma_f32_16x16x32_bf16 v[120:123], v[160:163], v[100:103], v[120:123]
v_mfma_f32_16x16x32_bf16 v[124:127], v[164:167], v[100:103], v[124:127]
s_waitcnt lgkmcnt(0)
v_mfma_f32_16x16x32_bf16 v[128:131], v[168:171], v[100:103], v[128:131]
v_mfma_f32_16x16x32_bf16 v[132:135], v[140:143], v[100:103], v[132:135]
v_mfma_f32_16x16x32_bf16 v[136:139], v[144:147], v[100:103], v[136:139]
v_fmaak_f32 v190, v104, v104, 0x409d30fc
v_fmaak_f32 v191, v105, v105, 0x409d30fc
v_fmaak_f32 v192, v106, v106, 0x409d30fc
v_fmaak_f32 v193, v107, v107, 0x409d30fc
v_mul_f32 v190, v104, v190
v_mul_f32 v191, v105, v191
v_mul_f32 v192, v106, v192
v_mul_f32 v193, v107, v193
v_exp_f32 v190, v190
v_exp_f32 v191, v191
v_exp_f32 v192, v192
v_exp_f32 v193, v193
v_fma_f32 v190, v190, v206, v206
v_fma_f32 v191, v191, v206, v206
v_fma_f32 v192, v192, v206, v206
v_fma_f32 v193, v193, v206, v206
v_rcp_f32 v190, v190
v_rcp_f32 v191, v191
v_rcp_f32 v192, v192
v_rcp_f32 v193, v193
v_mul_f32 v190, v104, v190
v_mul_f32 v191, v105, v191
v_mul_f32 v192, v106, v192
v_mul_f32 v193, v107, v193
v_cvt_pk_bf16_f32 v194, v190, v191
v_cvt_pk_bf16_f32 v195, v192, v193
s_mul_i32 s7, s15, 4608
s_add_u32 s7, s7, s19
s_add_u32 s8, s7, 4096
buffer_store_dwordx2 v[194:195], v16, s[72:75], s7 offen offset:0 sc1
v_fmaak_f32 v198, v108, v108, 0x409d30fc
v_fmaak_f32 v199, v109, v109, 0x409d30fc
v_fmaak_f32 v200, v110, v110, 0x409d30fc
v_fmaak_f32 v201, v111, v111, 0x409d30fc
v_mul_f32 v198, v108, v198
v_mul_f32 v199, v109, v199
v_mul_f32 v200, v110, v200
v_mul_f32 v201, v111, v201
v_exp_f32 v198, v198
v_exp_f32 v199, v199
v_exp_f32 v200, v200
v_exp_f32 v201, v201
v_fma_f32 v198, v198, v206, v206
v_fma_f32 v199, v199, v206, v206
v_fma_f32 v200, v200, v206, v206
v_fma_f32 v201, v201, v206, v206
v_rcp_f32 v198, v198
v_rcp_f32 v199, v199
v_rcp_f32 v200, v200
v_rcp_f32 v201, v201
v_mul_f32 v198, v108, v198
v_mul_f32 v199, v109, v199
v_mul_f32 v200, v110, v200
v_mul_f32 v201, v111, v201
v_cvt_pk_bf16_f32 v202, v198, v199
v_cvt_pk_bf16_f32 v203, v200, v201
buffer_store_dwordx2 v[202:203], v16, s[72:75], s7 offen offset:512 sc1
v_fmaak_f32 v190, v112, v112, 0x409d30fc
v_fmaak_f32 v191, v113, v113, 0x409d30fc
v_fmaak_f32 v192, v114, v114, 0x409d30fc
v_fmaak_f32 v193, v115, v115, 0x409d30fc
v_mul_f32 v190, v112, v190
v_mul_f32 v191, v113, v191
v_mul_f32 v192, v114, v192
v_mul_f32 v193, v115, v193
v_exp_f32 v190, v190
v_exp_f32 v191, v191
v_exp_f32 v192, v192
v_exp_f32 v193, v193
v_fma_f32 v190, v190, v206, v206
v_fma_f32 v191, v191, v206, v206
v_fma_f32 v192, v192, v206, v206
v_fma_f32 v193, v193, v206, v206
v_rcp_f32 v190, v190
v_rcp_f32 v191, v191
v_rcp_f32 v192, v192
v_rcp_f32 v193, v193
v_mul_f32 v190, v112, v190
v_mul_f32 v191, v113, v191
v_mul_f32 v192, v114, v192
v_mul_f32 v193, v115, v193
v_cvt_pk_bf16_f32 v194, v190, v191
v_cvt_pk_bf16_f32 v195, v192, v193
buffer_store_dwordx2 v[194:195], v16, s[72:75], s7 offen offset:1024 sc1
v_fmaak_f32 v198, v116, v116, 0x409d30fc
v_fmaak_f32 v199, v117, v117, 0x409d30fc
v_fmaak_f32 v200, v118, v118, 0x409d30fc
v_fmaak_f32 v201, v119, v119, 0x409d30fc
v_mul_f32 v198, v116, v198
v_mul_f32 v199, v117, v199
v_mul_f32 v200, v118, v200
v_mul_f32 v201, v119, v201
v_exp_f32 v198, v198
v_exp_f32 v199, v199
v_exp_f32 v200, v200
v_exp_f32 v201, v201
v_fma_f32 v198, v198, v206, v206
v_fma_f32 v199, v199, v206, v206
v_fma_f32 v200, v200, v206, v206
v_fma_f32 v201, v201, v206, v206
v_rcp_f32 v198, v198
v_rcp_f32 v199, v199
v_rcp_f32 v200, v200
v_rcp_f32 v201, v201
v_mul_f32 v198, v116, v198
v_mul_f32 v199, v117, v199
v_mul_f32 v200, v118, v200
v_mul_f32 v201, v119, v201
v_cvt_pk_bf16_f32 v202, v198, v199
v_cvt_pk_bf16_f32 v203, v200, v201
buffer_store_dwordx2 v[202:203], v16, s[72:75], s7 offen offset:1536 sc1
v_fmaak_f32 v190, v120, v120, 0x409d30fc
v_fmaak_f32 v191, v121, v121, 0x409d30fc
v_fmaak_f32 v192, v122, v122, 0x409d30fc
v_fmaak_f32 v193, v123, v123, 0x409d30fc
v_mul_f32 v190, v120, v190
v_mul_f32 v191, v121, v191
v_mul_f32 v192, v122, v192
v_mul_f32 v193, v123, v193
v_exp_f32 v190, v190
v_exp_f32 v191, v191
v_exp_f32 v192, v192
v_exp_f32 v193, v193
v_fma_f32 v190, v190, v206, v206
v_fma_f32 v191, v191, v206, v206
v_fma_f32 v192, v192, v206, v206
v_fma_f32 v193, v193, v206, v206
v_rcp_f32 v190, v190
v_rcp_f32 v191, v191
v_rcp_f32 v192, v192
v_rcp_f32 v193, v193
v_mul_f32 v190, v120, v190
v_mul_f32 v191, v121, v191
v_mul_f32 v192, v122, v192
v_mul_f32 v193, v123, v193
v_cvt_pk_bf16_f32 v194, v190, v191
v_cvt_pk_bf16_f32 v195, v192, v193
buffer_store_dwordx2 v[194:195], v16, s[72:75], s7 offen offset:2048 sc1
v_fmaak_f32 v198, v124, v124, 0x409d30fc
v_fmaak_f32 v199, v125, v125, 0x409d30fc
v_fmaak_f32 v200, v126, v126, 0x409d30fc
v_fmaak_f32 v201, v127, v127, 0x409d30fc
v_mul_f32 v198, v124, v198
v_mul_f32 v199, v125, v199
v_mul_f32 v200, v126, v200
v_mul_f32 v201, v127, v201
v_exp_f32 v198, v198
v_exp_f32 v199, v199
v_exp_f32 v200, v200
v_exp_f32 v201, v201
v_fma_f32 v198, v198, v206, v206
v_fma_f32 v199, v199, v206, v206
v_fma_f32 v200, v200, v206, v206
v_fma_f32 v201, v201, v206, v206
v_rcp_f32 v198, v198
v_rcp_f32 v199, v199
v_rcp_f32 v200, v200
v_rcp_f32 v201, v201
v_mul_f32 v198, v124, v198
v_mul_f32 v199, v125, v199
v_mul_f32 v200, v126, v200
v_mul_f32 v201, v127, v201
v_cvt_pk_bf16_f32 v202, v198, v199
v_cvt_pk_bf16_f32 v203, v200, v201
buffer_store_dwordx2 v[202:203], v16, s[72:75], s7 offen offset:2560 sc1
v_fmaak_f32 v190, v128, v128, 0x409d30fc
v_fmaak_f32 v191, v129, v129, 0x409d30fc
v_fmaak_f32 v192, v130, v130, 0x409d30fc
v_fmaak_f32 v193, v131, v131, 0x409d30fc
v_mul_f32 v190, v128, v190
v_mul_f32 v191, v129, v191
v_mul_f32 v192, v130, v192
v_mul_f32 v193, v131, v193
v_exp_f32 v190, v190
v_exp_f32 v191, v191
v_exp_f32 v192, v192
v_exp_f32 v193, v193
v_fma_f32 v190, v190, v206, v206
v_fma_f32 v191, v191, v206, v206
v_fma_f32 v192, v192, v206, v206
v_fma_f32 v193, v193, v206, v206
v_rcp_f32 v190, v190
v_rcp_f32 v191, v191
v_rcp_f32 v192, v192
v_rcp_f32 v193, v193
v_mul_f32 v190, v128, v190
v_mul_f32 v191, v129, v191
v_mul_f32 v192, v130, v192
v_mul_f32 v193, v131, v193
v_cvt_pk_bf16_f32 v194, v190, v191
v_cvt_pk_bf16_f32 v195, v192, v193
buffer_store_dwordx2 v[194:195], v16, s[72:75], s7 offen offset:3072 sc1
v_fmaak_f32 v198, v132, v132, 0x409d30fc
v_fmaak_f32 v199, v133, v133, 0x409d30fc
v_fmaak_f32 v200, v134, v134, 0x409d30fc
v_fmaak_f32 v201, v135, v135, 0x409d30fc
v_mul_f32 v198, v132, v198
v_mul_f32 v199, v133, v199
v_mul_f32 v200, v134, v200
v_mul_f32 v201, v135, v201
v_exp_f32 v198, v198
v_exp_f32 v199, v199
v_exp_f32 v200, v200
v_exp_f32 v201, v201
v_fma_f32 v198, v198, v206, v206
v_fma_f32 v199, v199, v206, v206
v_fma_f32 v200, v200, v206, v206
v_fma_f32 v201, v201, v206, v206
v_rcp_f32 v198, v198
v_rcp_f32 v199, v199
v_rcp_f32 v200, v200
v_rcp_f32 v201, v201
v_mul_f32 v198, v132, v198
v_mul_f32 v199, v133, v199
v_mul_f32 v200, v134, v200
v_mul_f32 v201, v135, v201
v_cvt_pk_bf16_f32 v202, v198, v199
v_cvt_pk_bf16_f32 v203, v200, v201
buffer_store_dwordx2 v[202:203], v16, s[72:75], s7 offen offset:3584 sc1
v_fmaak_f32 v190, v136, v136, 0x409d30fc
v_fmaak_f32 v191, v137, v137, 0x409d30fc
v_fmaak_f32 v192, v138, v138, 0x409d30fc
v_fmaak_f32 v193, v139, v139, 0x409d30fc
v_mul_f32 v190, v136, v190
v_mul_f32 v191, v137, v191
v_mul_f32 v192, v138, v192
v_mul_f32 v193, v139, v193
v_exp_f32 v190, v190
v_exp_f32 v191, v191
v_exp_f32 v192, v192
v_exp_f32 v193, v193
v_fma_f32 v190, v190, v206, v206
v_fma_f32 v191, v191, v206, v206
v_fma_f32 v192, v192, v206, v206
v_fma_f32 v193, v193, v206, v206
v_rcp_f32 v190, v190
v_rcp_f32 v191, v191
v_rcp_f32 v192, v192
v_rcp_f32 v193, v193
v_mul_f32 v190, v136, v190
v_mul_f32 v191, v137, v191
v_mul_f32 v192, v138, v192
v_mul_f32 v193, v139, v193
v_cvt_pk_bf16_f32 v194, v190, v191
v_cvt_pk_bf16_f32 v195, v192, v193
buffer_store_dwordx2 v[194:195], v16, s[72:75], s8 offen offset:0 sc1
s_waitcnt vmcnt(0) lgkmcnt(0)
s_barrier
s_lshl_b32 s7, s14, 9
s_lshl_b32 s8, s15, 2
s_add_u32 s7, s7, s8
s_add_u32 s7, s7, 16384
v_mov_b32 v255, s6
buffer_store_dword v255, v253, s[72:75], s7 offen sc1
s_waitcnt lgkmcnt(0)
s_cmp_lg_u32 s3, 0
s_cbranch_scc1 L_skip_4
s_lshl_b32 s7, s14, 9
s_add_u32 s7, s7, 16384
v_and_b32 v20, 3, v0
v_lshlrev_b32 v20, 2, v20
s_mov_b32 s8, 0
L_poll_5:
buffer_load_dword v21, v20, s[72:75], s7 offen sc1
s_waitcnt vmcnt(0)
v_cmp_ne_u32 vcc, s6, v21
s_cbranch_vccz L_done_6
s_add_u32 s8, s8, 1
s_cmp_lt_u32 s8, 262144
s_sleep 1
s_cbranch_scc1 L_poll_5
v_mov_b32 v21, 101
buffer_store_dword v21, v253, s[80:83], 0 offen
s_waitcnt vmcnt(0)
L_done_6:
s_nop 0
L_skip_4:
s_lshl_b32 s9, s3, 12
s_add_u32 s9, s9, 147456
s_mul_i32 s11, s15, 288
v_lshrrev_b32 v22, 4, v0
v_and_b32 v23, 15, v0
v_add_u32 v24, 0, v22
v_xor_b32 v25, v23, v24
v_add_u32 v24, s17, v24
v_mul_u32_u24 v24, 1152, v24
v_lshl_add_u32 v24, v25, 4, v24
s_add_u32 m0, s9, 0
s_nop 0
buffer_load_dwordx4 v24, s[40:43], s11 offen lds
v_add_u32 v24, 4, v22
v_xor_b32 v25, v23, v24
v_add_u32 v24, s17, v24
v_mul_u32_u24 v24, 1152, v24
v_lshl_add_u32 v24, v25, 4, v24
s_add_u32 m0, s9, 1024
s_nop 0
buffer_load_dwordx4 v24, s[40:43], s11 offen lds
v_add_u32 v24, 8, v22
v_xor_b32 v25, v23, v24
v_add_u32 v24, s17, v24
v_mul_u32_u24 v24, 1152, v24
v_lshl_add_u32 v24, v25, 4, v24
s_add_u32 m0, s9, 2048
s_nop 0
buffer_load_dwordx4 v24, s[40:43], s11 offen lds
v_add_u32 v24, 12, v22
v_xor_b32 v25, v23, v24
v_add_u32 v24, s17, v24
v_mul_u32_u24 v24, 1152, v24
v_lshl_add_u32 v24, v25, 4, v24
s_add_u32 m0, s9, 3072
s_nop 0
buffer_load_dwordx4 v24, s[40:43], s11 offen lds
buffer_load_dwordx2 v[188:189], v15, s[40:43], 0 offen offset:256
v_lshrrev_b32 v24, 1, v22
v_xor_b32 v24, v24, v23
v_lshlrev_b32 v24, 4, v24
v_lshl_add_u32 v24, v23, 8, v24
v_and_b32 v25, 1, v22
v_lshl_add_u32 v24, v25, 3, v24
v_add_u32 v15, s9, v24
s_add_u32 s99, s18, 368640
s_add_u32 m0, s98, 110592
s_nop 0
buffer_load_dwordx4 v3, s[52:55], s99 offen offset:0 lds
buffer_load_dwordx4 v4, s[52:55], s99 offen offset:1024 lds
buffer_load_dwordx4 v5, s[52:55], s99 offen offset:2048 lds
buffer_load_dwordx4 v6, s[52:55], s99 offen offset:3072 lds
s_add_u32 m0, s98, 114688
s_nop 0
buffer_load_dwordx4 v7, s[52:55], s99 offen offset:0 lds
buffer_load_dwordx4 v8, s[52:55], s99 offen offset:1024 lds
buffer_load_dwordx4 v9, s[52:55], s99 offen offset:2048 lds
buffer_load_dwordx4 v10, s[52:55], s99 offen offset:3072 lds
s_add_u32 m0, s98, 118784
s_nop 0
buffer_load_dwordx4 v11, s[52:55], s99 offen offset:0 lds
s_barrier
s_add_u32 s7, s19, 0
buffer_load_dwordx4 v[32:35], v19, s[72:75], s7 offen offset:0 sc1
buffer_load_dwordx4 v[36:39], v19, s[72:75], s7 offen offset:1024 sc1
buffer_load_dwordx4 v[40:43], v19, s[72:75], s7 offen offset:2048 sc1
buffer_load_dwordx4 v[44:47], v19, s[72:75], s7 offen offset:3072 sc1
s_add_u32 s7, s19, 4096
buffer_load_dwordx4 v[48:51], v19, s[72:75], s7 offen offset:0 sc1
buffer_load_dwordx4 v[52:55], v19, s[72:75], s7 offen offset:1024 sc1
buffer_load_dwordx4 v[56:59], v19, s[72:75], s7 offen offset:2048 sc1
buffer_load_dwordx4 v[60:63], v19, s[72:75], s7 offen offset:3072 sc1
s_add_u32 s7, s19, 8192
buffer_load_dwordx4 v[64:67], v19, s[72:75], s7 offen offset:0 sc1
buffer_load_dwordx4 v[68:71], v19, s[72:75], s7 offen offset:1024 sc1
buffer_load_dwordx4 v[72:75], v19, s[72:75], s7 offen offset:2048 sc1
buffer_load_dwordx4 v[76:79], v19, s[72:75], s7 offen offset:3072 sc1
s_add_u32 s7, s19, 12288
buffer_load_dwordx4 v[80:83], v19, s[72:75], s7 offen offset:0 sc1
buffer_load_dwordx4 v[84:87], v19, s[72:75], s7 offen offset:1024 sc1
buffer_load_dwordx4 v[88:91], v19, s[72:75], s7 offen offset:2048 sc1
buffer_load_dwordx4 v[92:95], v19, s[72:75], s7 offen offset:3072 sc1
s_add_u32 s7, s19, 16384
buffer_load_dwordx4 v[96:99], v19, s[72:75], s7 offen offset:0 sc1
buffer_load_dwordx4 v[100:103], v19, s[72:75], s7 offen offset:1024 sc1
ds_read_b64_tr_b16 v[140:141], v12 offset:18432
ds_read_b64_tr_b16 v[142:143], v12 offset:23040
ds_read_b64_tr_b16 v[144:145], v12 offset:18464
ds_read_b64_tr_b16 v[146:147], v12 offset:23072
ds_read_b64_tr_b16 v[148:149], v12 offset:18496
ds_read_b64_tr_b16 v[150:151], v12 offset:23104
ds_read_b64_tr_b16 v[152:153], v12 offset:18528
ds_read_b64_tr_b16 v[154:155], v12 offset:23136
ds_read_b64_tr_b16 v[156:157], v12 offset:18560
ds_read_b64_tr_b16 v[158:159], v12 offset:23168
ds_read_b64_tr_b16 v[160:161], v12 offset:18592
ds_read_b64_tr_b16 v[162:163], v12 offset:23200
ds_read_b64_tr_b16 v[164:165], v12 offset:18624
ds_read_b64_tr_b16 v[166:167], v12 offset:23232
s_waitcnt lgkmcnt(8)
s_waitcnt vmcnt(17)
v_mfma_f32_16x16x32_bf16 v[104:107], v[140:143], v[32:35], 0
ds_read_b64_tr_b16 v[168:169], v12 offset:18656
ds_read_b64_tr_b16 v[170:171], v12 offset:23264
v_mfma_f32_16x16x32_bf16 v[108:111], v[144:147], v[32:35], 0
ds_read_b64_tr_b16 v[140:141], v12 offset:18688
ds_read_b64_tr_b16 v[142:143], v12 offset:23296
v_mfma_f32_16x16x32_bf16 v[112:115], v[148:151], v[32:35], 0
ds_read_b64_tr_b16 v[144:145], v12 offset:27648
ds_read_b64_tr_b16 v[146:147], v12 offset:32256
s_waitcnt lgkmcnt(8)
v_mfma_f32_16x16x32_bf16 v[116:119], v[152:155], v[32:35], 0
ds_read_b64_tr_b16 v[148:149], v12 offset:27680
ds_read_b64_tr_b16 v[150:151], v12 offset:32288
v_mfma_f32_16x16x32_bf16 v[120:123], v[156:159], v[32:35], 0
ds_read_b64_tr_b16 v[152:153], v12 offset:27712
ds_read_b64_tr_b16 v[154:155], v12 offset:32320
v_mfma_f32_16x16x32_bf16 v[124:127], v[160:163], v[32:35], 0
ds_read_b64_tr_b16 v[156:157], v12 offset:27744
ds_read_b64_tr_b16 v[158:159], v12 offset:32352
s_waitcnt lgkmcnt(8)
v_mfma_f32_16x16x32_bf16 v[128:131], v[164:167], v[32:35], 0
ds_read_b64_tr_b16 v[160:161], v12 offset:27776
ds_read_b64_tr_b16 v[162:163], v12 offset:32384
v_mfma_f32_16x16x32_bf16 v[132:135], v[168:171], v[32:35], 0
ds_read_b64_tr_b16 v[164:165], v12 offset:27808
ds_read_b64_tr_b16 v[166:167], v12 offset:32416
v_mfma_f32_16x16x32_bf16 v[136:139], v[140:143], v[32:35], 0
ds_read_b64_tr_b16 v[168:169], v12 offset:27840
ds_read_b64_tr_b16 v[170:171], v12 offset:32448
s_waitcnt lgkmcnt(8)
s_waitcnt vmcnt(16)
v_mfma_f32_16x16x32_bf16 v[104:107], v[144:147], v[36:39], v[104:107]
ds_read_b64_tr_b16 v[140:141], v12 offset:27872
ds_read_b64_tr_b16 v[142:143], v12 offset:32480
v_mfma_f32_16x16x32_bf16 v[108:111], v[148:151], v[36:39], v[108:111]
ds_read_b64_tr_b16 v[144:145], v12 offset:27904
ds_read_b64_tr_b16 v[146:147], v12 offset:32512
v_mfma_f32_16x16x32_bf16 v[112:115], v[152:155], v[36:39], v[112:115]
s_barrier
ds_read_b64_tr_b16 v[148:149], v12 offset:36864
ds_read_b64_tr_b16 v[150:151], v12 offset:41472
s_waitcnt lgkmcnt(8)
v_mfma_f32_16x16x32_bf16 v[116:119], v[156:159], v[36:39], v[116:119]
ds_read_b64_tr_b16 v[152:153], v12 offset:36896
ds_read_b64_tr_b16 v[154:155], v12 offset:41504
v_mfma_f32_16x16x32_bf16 v[120:123], v[160:163], v[36:39], v[120:123]
ds_read_b64_tr_b16 v[156:157], v12 offset:36928
ds_read_b64_tr_b16 v[158:159], v12 offset:41536
v_mfma_f32_16x16x32_bf16 v[124:127], v[164:167], v[36:39], v[124:127]
ds_read_b64_tr_b16 v[160:161], v12 offset:36960
ds_read_b64_tr_b16 v[162:163], v12 offset:41568
s_waitcnt lgkmcnt(8)
v_mfma_f32_16x16x32_bf16 v[128:131], v[168:171], v[36:39], v[128:131]
ds_read_b64_tr_b16 v[164:165], v12 offset:36992
ds_read_b64_tr_b16 v[166:167], v12 offset:41600
v_mfma_f32_16x16x32_bf16 v[132:135], v[140:143], v[36:39], v[132:135]
ds_read_b64_tr_b16 v[168:169], v12 offset:37024
ds_read_b64_tr_b16 v[170:171], v12 offset:41632
v_mfma_f32_16x16x32_bf16 v[136:139], v[144:147], v[36:39], v[136:139]
ds_read_b64_tr_b16 v[140:141], v12 offset:37056
ds_read_b64_tr_b16 v[142:143], v12 offset:41664
s_waitcnt lgkmcnt(8)
s_waitcnt vmcnt(15)
v_mfma_f32_16x16x32_bf16 v[104:107], v[148:151], v[40:43], v[104:107]
ds_read_b64_tr_b16 v[144:145], v12 offset:37088
ds_read_b64_tr_b16 v[146:147], v12 offset:41696
v_mfma_f32_16x16x32_bf16 v[108:111], v[152:155], v[40:43], v[108:111]
ds_read_b64_tr_b16 v[148:149], v12 offset:37120
ds_read_b64_tr_b16 v[150:151], v12 offset:41728
v_mfma_f32_16x16x32_bf16 v[112:115], v[156:159], v[40:43], v[112:115]
ds_read_b64_tr_b16 v[152:153], v12 offset:46080
ds_read_b64_tr_b16 v[154:155], v12 offset:50688
s_waitcnt lgkmcnt(8)
v_mfma_f32_16x16x32_bf16 v[116:119], v[160:163], v[40:43], v[116:119]
ds_read_b64_tr_b16 v[156:157], v12 offset:46112
ds_read_b64_tr_b16 v[158:159], v12 offset:50720
v_mfma_f32_16x16x32_bf16 v[120:123], v[164:167], v[40:43], v[120:123]
ds_read_b64_tr_b16 v[160:161], v12 offset:46144
ds_read_b64_tr_b16 v[162:163], v12 offset:50752
v_mfma_f32_16x16x32_bf16 v[124:127], v[168:171], v[40:43], v[124:127]
ds_read_b64_tr_b16 v[164:165], v12 offset:46176
ds_read_b64_tr_b16 v[166:167], v12 offset:50784
s_waitcnt lgkmcnt(8)
v_mfma_f32_16x16x32_bf16 v[128:131], v[140:143], v[40:43], v[128:131]
ds_read_b64_tr_b16 v[168:169], v12 offset:46208
ds_read_b64_tr_b16 v[170:171], v12 offset:50816
v_mfma_f32_16x16x32_bf16 v[132:135], v[144:147], v[40:43], v[132:135]
ds_read_b64_tr_b16 v[140:141], v12 offset:46240
ds_read_b64_tr_b16 v[142:143], v12 offset:50848
v_mfma_f32_16x16x32_bf16 v[136:139], v[148:151], v[40:43], v[136:139]
ds_read_b64_tr_b16 v[144:145], v12 offset:46272
ds_read_b64_tr_b16 v[146:147], v12 offset:50880
s_waitcnt lgkmcnt(8)
s_waitcnt vmcnt(14)
v_mfma_f32_16x16x32_bf16 v[104:107], v[152:155], v[44:47], v[104:107]
ds_read_b64_tr_b16 v[148:149], v12 offset:46304
ds_read_b64_tr_b16 v[150:151], v12 offset:50912
v_mfma_f32_16x16x32_bf16 v[108:111], v[156:159], v[44:47], v[108:111]
ds_read_b64_tr_b16 v[152:153], v12 offset:46336
ds_read_b64_tr_b16 v[154:155], v12 offset:50944
v_mfma_f32_16x16x32_bf16 v[112:115], v[160:163], v[44:47], v[112:115]
ds_read_b64_tr_b16 v[156:157], v12 offset:55296
ds_read_b64_tr_b16 v[158:159], v12 offset:59904
s_waitcnt lgkmcnt(8)
v_mfma_f32_16x16x32_bf16 v[116:119], v[164:167], v[44:47], v[116:119]
ds_read_b64_tr_b16 v[160:161], v12 offset:55328
ds_read_b64_tr_b16 v[162:163], v12 offset:59936
v_mfma_f32_16x16x32_bf16 v[120:123], v[168:171], v[44:47], v[120:123]
ds_read_b64_tr_b16 v[164:165], v12 offset:55360
ds_read_b64_tr_b16 v[166:167], v12 offset:59968
v_mfma_f32_16x16x32_bf16 v[124:127], v[140:143], v[44:47], v[124:127]
ds_read_b64_tr_b16 v[168:169], v12 offset:55392
ds_read_b64_tr_b16 v[170:171], v12 offset:60000
s_waitcnt lgkmcnt(8)
v_mfma_f32_16x16x32_bf16 v[128:131], v[144:147], v[44:47], v[128:131]
ds_read_b64_tr_b16 v[140:141], v12 offset:55424
ds_read_b64_tr_b16 v[142:143], v12 offset:60032
v_mfma_f32_16x16x32_bf16 v[132:135], v[148:151], v[44:47], v[132:135]
ds_read_b64_tr_b16 v[144:145], v12 offset:55456
ds_read_b64_tr_b16 v[146:147], v12 offset:60064
v_mfma_f32_16x16x32_bf16 v[136:139], v[152:155], v[44:47], v[136:139]
ds_read_b64_tr_b16 v[148:149], v12 offset:55488
ds_read_b64_tr_b16 v[150:151], v12 offset:60096
s_waitcnt lgkmcnt(8)
s_waitcnt vmcnt(13)
v_mfma_f32_16x16x32_bf16 v[104:107], v[156:159], v[48:51], v[104:107]
ds_read_b64_tr_b16 v[152:153], v12 offset:55520
ds_read_b64_tr_b16 v[154:155], v12 offset:60128
v_mfma_f32_16x16x32_bf16 v[108:111], v[160:163], v[48:51], v[108:111]
ds_read_b64_tr_b16 v[156:157], v12 offset:55552
ds_read_b64_tr_b16 v[158:159], v12 offset:60160
v_mfma_f32_16x16x32_bf16 v[112:115], v[164:167], v[48:51], v[112:115]
ds_read_b64_tr_b16 v[160:161], v13 offset:0
ds_read_b64_tr_b16 v[162:163], v13 offset:4608
s_waitcnt lgkmcnt(8)
v_mfma_f32_16x16x32_bf16 v[116:119], v[168:171], v[48:51], v[116:119]
ds_read_b64_tr_b16 v[164:165], v13 offset:32
ds_read_b64_tr_b16 v[166:167], v13 offset:4640
v_mfma_f32_16x16x32_bf16 v[120:123], v[140:143], v[48:51], v[120:123]
ds_read_b64_tr_b16 v[168:169], v13 offset:64
ds_read_b64_tr_b16 v[170:171], v13 offset:4672
v_mfma_f32_16x16x32_bf16 v[124:127], v[144:147], v[48:51], v[124:127]
ds_read_b64_tr_b16 v[140:141], v13 offset:96
ds_read_b64_tr_b16 v[142:143], v13 offset:4704
s_waitcnt lgkmcnt(8)
v_mfma_f32_16x16x32_bf16 v[128:131], v[148:151], v[48:51], v[128:131]
ds_read_b64_tr_b16 v[144:145], v13 offset:128
ds_read_b64_tr_b16 v[146:147], v13 offset:4736
v_mfma_f32_16x16x32_bf16 v[132:135], v[152:155], v[48:51], v[132:135]
ds_read_b64_tr_b16 v[148:149], v13 offset:160
ds_read_b64_tr_b16 v[150:151], v13 offset:4768
v_mfma_f32_16x16x32_bf16 v[136:139], v[156:159], v[48:51], v[136:139]
ds_read_b64_tr_b16 v[152:153], v13 offset:192
ds_read_b64_tr_b16 v[154:155], v13 offset:4800
s_waitcnt lgkmcnt(8)
s_waitcnt vmcnt(12)
v_mfma_f32_16x16x32_bf16 v[104:107], v[160:163], v[52:55], v[104:107]
ds_read_b64_tr_b16 v[156:157], v13 offset:224
ds_read_b64_tr_b16 v[158:159], v13 offset:4832
v_mfma_f32_16x16x32_bf16 v[108:111], v[164:167], v[52:55], v[108:111]
ds_read_b64_tr_b16 v[160:161], v13 offset:256
ds_read_b64_tr_b16 v[162:163], v13 offset:4864
v_mfma_f32_16x16x32_bf16 v[112:115], v[168:171], v[52:55], v[112:115]
s_barrier
ds_read_b64_tr_b16 v[164:165], v13 offset:9216
ds_read_b64_tr_b16 v[166:167], v13 offset:13824
s_waitcnt lgkmcnt(8)
v_mfma_f32_16x16x32_bf16 v[116:119], v[140:143], v[52:55], v[116:119]
ds_read_b64_tr_b16 v[168:169], v13 offset:9248
ds_read_b64_tr_b16 v[170:171], v13 offset:13856
s_add_u32 s99, s18, 516096
s_add_u32 m0, s98, 0
v_mfma_f32_16x16x32_bf16 v[120:123], v[144:147], v[52:55], v[120:123]
ds_read_b64_tr_b16 v[140:141], v13 offset:9280
ds_read_b64_tr_b16 v[142:143], v13 offset:13888
v_mfma_f32_16x16x32_bf16 v[124:127], v[148:151], v[52:55], v[124:127]
ds_read_b64_tr_b16 v[144:145], v13 offset:9312
ds_read_b64_tr_b16 v[146:147], v13 offset:13920
buffer_load_dwordx4 v3, s[52:55], s99 offen offset:0 lds
s_waitcnt lgkmcnt(8)
v_mfma_f32_16x16x32_bf16 v[128:131], v[152:155], v[52:55], v[128:131]
ds_read_b64_tr_b16 v[148:149], v13 offset:9344
ds_read_b64_tr_b16 v[150:151], v13 offset:13952
v_mfma_f32_16x16x32_bf16 v[132:135], v[156:159], v[52:55], v[132:135]
ds_read_b64_tr_b16 v[152:153], v13 offset:9376
ds_read_b64_tr_b16 v[154:155], v13 offset:13984
v_mfma_f32_16x16x32_bf16 v[136:139], v[160:163], v[52:55], v[136:139]
ds_read_b64_tr_b16 v[156:157], v13 offset:9408
ds_read_b64_tr_b16 v[158:159], v13 offset:14016
buffer_load_dwordx4 v4, s[52:55], s99 offen offset:1024 lds
s_waitcnt lgkmcnt(8)
s_waitcnt vmcnt(13)
v_mfma_f32_16x16x32_bf16 v[104:107], v[164:167], v[56:59], v[104:107]
ds_read_b64_tr_b16 v[160:161], v13 offset:9440
ds_read_b64_tr_b16 v[162:163], v13 offset:14048
v_mfma_f32_16x16x32_bf16 v[108:111], v[168:171], v[56:59], v[108:111]
ds_read_b64_tr_b16 v[164:165], v13 offset:9472
ds_read_b64_tr_b16 v[166:167], v13 offset:14080
v_mfma_f32_16x16x32_bf16 v[112:115], v[140:143], v[56:59], v[112:115]
ds_read_b64_tr_b16 v[168:169], v13 offset:18432
ds_read_b64_tr_b16 v[170:171], v13 offset:23040
buffer_load_dwordx4 v5, s[52:55], s99 offen offset:2048 lds
s_waitcnt lgkmcnt(8)
v_mfma_f32_16x16x32_bf16 v[116:119], v[144:147], v[56:59], v[116:119]
ds_read_b64_tr_b16 v[140:141], v13 offset:18464
ds_read_b64_tr_b16 v[142:143], v13 offset:23072
v_mfma_f32_16x16x32_bf16 v[120:123], v[148:151], v[56:59], v[120:123]
ds_read_b64_tr_b16 v[144:145], v13 offset:18496
ds_read_b64_tr_b16 v[146:147], v13 offset:23104
v_mfma_f32_16x16x32_bf16 v[124:127], v[152:155], v[56:59], v[124:127]
ds_read_b64_tr_b16 v[148:149], v13 offset:18528
ds_read_b64_tr_b16 v[150:151], v13 offset:23136
buffer_load_dwordx4 v6, s[52:55], s99 offen offset:3072 lds
s_waitcnt lgkmcnt(8)
v_mfma_f32_16x16x32_bf16 v[128:131], v[156:159], v[56:59], v[128:131]
ds_read_b64_tr_b16 v[152:153], v13 offset:18560
ds_read_b64_tr_b16 v[154:155], v13 offset:23168
s_add_u32 m0, s98, 4096
v_mfma_f32_16x16x32_bf16 v[132:135], v[160:163], v[56:59], v[132:135]
ds_read_b64_tr_b16 v[156:157], v13 offset:18592
ds_read_b64_tr_b16 v[158:159], v13 offset:23200
v_mfma_f32_16x16x32_bf16 v[136:139], v[164:167], v[56:59], v[136:139]
ds_read_b64_tr_b16 v[160:161], v13 offset:18624
ds_read_b64_tr_b16 v[162:163], v13 offset:23232
s_waitcnt lgkmcnt(8)
s_waitcnt vmcnt(14)
v_mfma_f32_16x16x32_bf16 v[104:107], v[168:171], v[60:63], v[104:107]
ds_read_b64_tr_b16 v[164:165], v13 offset:18656
ds_read_b64_tr_b16 v[166:167], v13 offset:23264
buffer_load_dwordx4 v7, s[52:55], s99 offen offset:0 lds
v_mfma_f32_16x16x32_bf16 v[108:111], v[140:143], v[60:63], v[108:111]
ds_read_b64_tr_b16 v[168:169], v13 offset:18688
ds_read_b64_tr_b16 v[170:171], v13 offset:23296
v_mfma_f32_16x16x32_bf16 v[112:115], v[144:147], v[60:63], v[112:115]
ds_read_b64_tr_b16 v[140:141], v13 offset:27648
ds_read_b64_tr_b16 v[142:143], v13 offset:32256
s_waitcnt lgkmcnt(8)
v_mfma_f32_16x16x32_bf16 v[116:119], v[148:151], v[60:63], v[116:119]
ds_read_b64_tr_b16 v[144:145], v13 offset:27680
ds_read_b64_tr_b16 v[146:147], v13 offset:32288
buffer_load_dwordx4 v8, s[52:55], s99 offen offset:1024 lds
v_mfma_f32_16x16x32_bf16 v[120:123], v[152:155], v[60:63], v[120:123]
ds_read_b64_tr_b16 v[148:149], v13 offset:27712
ds_read_b64_tr_b16 v[150:151], v13 offset:32320
v_mfma_f32_16x16x32_bf16 v[124:127], v[156:159], v[60:63], v[124:127]
ds_read_b64_tr_b16 v[152:153], v13 offset:27744
ds_read_b64_tr_b16 v[154:155], v13 offset:32352
s_waitcnt lgkmcnt(8)
v_mfma_f32_16x16x32_bf16 v[128:131], v[160:163], v[60:63], v[128:131]
ds_read_b64_tr_b16 v[156:157], v13 offset:27776
ds_read_b64_tr_b16 v[158:159], v13 offset:32384
buffer_load_dwordx4 v9, s[52:55], s99 offen offset:2048 lds
v_mfma_f32_16x16x32_bf16 v[132:135], v[164:167], v[60:63], v[132:135]
ds_read_b64_tr_b16 v[160:161], v13 offset:27808
ds_read_b64_tr_b16 v[162:163], v13 offset:32416
v_mfma_f32_16x16x32_bf16 v[136:139], v[168:171], v[60:63], v[136:139]
ds_read_b64_tr_b16 v[164:165], v13 offset:27840
ds_read_b64_tr_b16 v[166:167], v13 offset:32448
s_waitcnt lgkmcnt(8)
s_waitcnt vmcnt(16)
v_mfma_f32_16x16x32_bf16 v[104:107], v[140:143], v[64:67], v[104:107]
ds_read_b64_tr_b16 v[168:169], v13 offset:27872
ds_read_b64_tr_b16 v[170:171], v13 offset:32480
buffer_load_dwordx4 v10, s[52:55], s99 offen offset:3072 lds
v_mfma_f32_16x16x32_bf16 v[108:111], v[144:147], v[64:67], v[108:111]
ds_read_b64_tr_b16 v[140:141], v13 offset:27904
ds_read_b64_tr_b16 v[142:143], v13 offset:32512
s_add_u32 m0, s98, 8192
v_mfma_f32_16x16x32_bf16 v[112:115], v[148:151], v[64:67], v[112:115]
ds_read_b64_tr_b16 v[144:145], v13 offset:36864
ds_read_b64_tr_b16 v[146:147], v13 offset:41472
s_waitcnt lgkmcnt(8)
v_mfma_f32_16x16x32_bf16 v[116:119], v[152:155], v[64:67], v[116:119]
ds_read_b64_tr_b16 v[148:149], v13 offset:36896
ds_read_b64_tr_b16 v[150:151], v13 offset:41504
buffer_load_dwordx4 v11, s[52:55], s99 offen offset:0 lds
v_mfma_f32_16x16x32_bf16 v[120:123], v[156:159], v[64:67], v[120:123]
ds_read_b64_tr_b16 v[152:153], v13 offset:36928
ds_read_b64_tr_b16 v[154:155], v13 offset:41536
v_mfma_f32_16x16x32_bf16 v[124:127], v[160:163], v[64:67], v[124:127]
ds_read_b64_tr_b16 v[156:157], v13 offset:36960
ds_read_b64_tr_b16 v[158:159], v13 offset:41568
s_waitcnt lgkmcnt(8)
v_mfma_f32_16x16x32_bf16 v[128:131], v[164:167], v[64:67], v[128:131]
ds_read_b64_tr_b16 v[160:161], v13 offset:36992
ds_read_b64_tr_b16 v[162:163], v13 offset:41600
v_mfma_f32_16x16x32_bf16 v[132:135], v[168:171], v[64:67], v[132:135]
ds_read_b64_tr_b16 v[164:165], v13 offset:37024
ds_read_b64_tr_b16 v[166:167], v13 offset:41632
v_mfma_f32_16x16x32_bf16 v[136:139], v[140:143], v[64:67], v[136:139]
ds_read_b64_tr_b16 v[168:169], v13 offset:37056
ds_read_b64_tr_b16 v[170:171], v13 offset:41664
s_waitcnt lgkmcnt(8)
s_waitcnt vmcnt(17)
v_mfma_f32_16x16x32_bf16 v[104:107], v[144:147], v[68:71], v[104:107]
ds_read_b64_tr_b16 v[140:141], v13 offset:37088
ds_read_b64_tr_b16 v[142:143], v13 offset:41696
v_mfma_f32_16x16x32_bf16 v[108:111], v[148:151], v[68:71], v[108:111]
ds_read_b64_tr_b16 v[144:145], v13 offset:37120
ds_read_b64_tr_b16 v[146:147], v13 offset:41728
v_mfma_f32_16x16x32_bf16 v[112:115], v[152:155], v[68:71], v[112:115]
s_barrier
ds_read_b64_tr_b16 v[148:149], v13 offset:46080
ds_read_b64_tr_b16 v[150:151], v13 offset:50688
s_waitcnt lgkmcnt(8)
v_mfma_f32_16x16x32_bf16 v[116:119], v[156:159], v[68:71], v[116:119]
ds_read_b64_tr_b16 v[152:153], v13 offset:46112
ds_read_b64_tr_b16 v[154:155], v13 offset:50720
v_mfma_f32_16x16x32_bf16 v[120:123], v[160:163], v[68:71], v[120:123]
ds_read_b64_tr_b16 v[156:157], v13 offset:46144
ds_read_b64_tr_b16 v[158:159], v13 offset:50752
v_mfma_f32_16x16x32_bf16 v[124:127], v[164:167], v[68:71], v[124:127]
ds_read_b64_tr_b16 v[160:161], v13 offset:46176
ds_read_b64_tr_b16 v[162:163], v13 offset:50784
s_waitcnt lgkmcnt(8)
v_mfma_f32_16x16x32_bf16 v[128:131], v[168:171], v[68:71], v[128:131]
ds_read_b64_tr_b16 v[164:165], v13 offset:46208
ds_read_b64_tr_b16 v[166:167], v13 offset:50816
v_mfma_f32_16x16x32_bf16 v[132:135], v[140:143], v[68:71], v[132:135]
ds_read_b64_tr_b16 v[168:169], v13 offset:46240
ds_read_b64_tr_b16 v[170:171], v13 offset:50848
v_mfma_f32_16x16x32_bf16 v[136:139], v[144:147], v[68:71], v[136:139]
ds_read_b64_tr_b16 v[140:141], v13 offset:46272
ds_read_b64_tr_b16 v[142:143], v13 offset:50880
s_waitcnt lgkmcnt(8)
s_waitcnt vmcnt(16)
v_mfma_f32_16x16x32_bf16 v[104:107], v[148:151], v[72:75], v[104:107]
ds_read_b64_tr_b16 v[144:145], v13 offset:46304
ds_read_b64_tr_b16 v[146:147], v13 offset:50912
v_mfma_f32_16x16x32_bf16 v[108:111], v[152:155], v[72:75], v[108:111]
ds_read_b64_tr_b16 v[148:149], v13 offset:46336
ds_read_b64_tr_b16 v[150:151], v13 offset:50944
v_mfma_f32_16x16x32_bf16 v[112:115], v[156:159], v[72:75], v[112:115]
ds_read_b64_tr_b16 v[152:153], v13 offset:55296
ds_read_b64_tr_b16 v[154:155], v13 offset:59904
s_waitcnt lgkmcnt(8)
v_mfma_f32_16x16x32_bf16 v[116:119], v[160:163], v[72:75], v[116:119]
ds_read_b64_tr_b16 v[156:157], v13 offset:55328
ds_read_b64_tr_b16 v[158:159], v13 offset:59936
v_mfma_f32_16x16x32_bf16 v[120:123], v[164:167], v[72:75], v[120:123]
ds_read_b64_tr_b16 v[160:161], v13 offset:55360
ds_read_b64_tr_b16 v[162:163], v13 offset:59968
v_mfma_f32_16x16x32_bf16 v[124:127], v[168:171], v[72:75], v[124:127]
ds_read_b64_tr_b16 v[164:165], v13 offset:55392
ds_read_b64_tr_b16 v[166:167], v13 offset:60000
s_waitcnt lgkmcnt(8)
v_mfma_f32_16x16x32_bf16 v[128:131], v[140:143], v[72:75], v[128:131]
ds_read_b64_tr_b16 v[168:169], v13 offset:55424
ds_read_b64_tr_b16 v[170:171], v13 offset:60032
v_mfma_f32_16x16x32_bf16 v[132:135], v[144:147], v[72:75], v[132:135]
ds_read_b64_tr_b16 v[140:141], v13 offset:55456
ds_read_b64_tr_b16 v[142:143], v13 offset:60064
v_mfma_f32_16x16x32_bf16 v[136:139], v[148:151], v[72:75], v[136:139]
ds_read_b64_tr_b16 v[144:145], v13 offset:55488
ds_read_b64_tr_b16 v[146:147], v13 offset:60096
s_waitcnt lgkmcnt(8)
s_waitcnt vmcnt(15)
v_mfma_f32_16x16x32_bf16 v[104:107], v[152:155], v[76:79], v[104:107]
ds_read_b64_tr_b16 v[148:149], v13 offset:55520
ds_read_b64_tr_b16 v[150:151], v13 offset:60128
v_mfma_f32_16x16x32_bf16 v[108:111], v[156:159], v[76:79], v[108:111]
ds_read_b64_tr_b16 v[152:153], v13 offset:55552
ds_read_b64_tr_b16 v[154:155], v13 offset:60160
v_mfma_f32_16x16x32_bf16 v[112:115], v[160:163], v[76:79], v[112:115]
ds_read_b64_tr_b16 v[156:157], v14 offset:0
ds_read_b64_tr_b16 v[158:159], v14 offset:4608
s_waitcnt lgkmcnt(8)
v_mfma_f32_16x16x32_bf16 v[116:119], v[164:167], v[76:79], v[116:119]
ds_read_b64_tr_b16 v[160:161], v14 offset:32
ds_read_b64_tr_b16 v[162:163], v14 offset:4640
v_mfma_f32_16x16x32_bf16 v[120:123], v[168:171], v[76:79], v[120:123]
ds_read_b64_tr_b16 v[164:165], v14 offset:64
ds_read_b64_tr_b16 v[166:167], v14 offset:4672
v_mfma_f32_16x16x32_bf16 v[124:127], v[140:143], v[76:79], v[124:127]
ds_read_b64_tr_b16 v[168:169], v14 offset:96
ds_read_b64_tr_b16 v[170:171], v14 offset:4704
s_waitcnt lgkmcnt(8)
v_mfma_f32_16x16x32_bf16 v[128:131], v[144:147], v[76:79], v[128:131]
ds_read_b64_tr_b16 v[140:141], v14 offset:128
ds_read_b64_tr_b16 v[142:143], v14 offset:4736
v_mfma_f32_16x16x32_bf16 v[132:135], v[148:151], v[76:79], v[132:135]
ds_read_b64_tr_b16 v[144:145], v14 offset:160
ds_read_b64_tr_b16 v[146:147], v14 offset:4768
v_mfma_f32_16x16x32_bf16 v[136:139], v[152:155], v[76:79], v[136:139]
ds_read_b64_tr_b16 v[148:149], v14 offset:192
ds_read_b64_tr_b16 v[150:151], v14 offset:4800
s_waitcnt lgkmcnt(8)
s_waitcnt vmcnt(14)
v_mfma_f32_16x16x32_bf16 v[104:107], v[156:159], v[80:83], v[104:107]
ds_read_b64_tr_b16 v[152:153], v14 offset:224
ds_read_b64_tr_b16 v[154:155], v14 offset:4832
v_mfma_f32_16x16x32_bf16 v[108:111], v[160:163], v[80:83], v[108:111]
ds_read_b64_tr_b16 v[156:157], v14 offset:256
ds_read_b64_tr_b16 v[158:159], v14 offset:4864
v_mfma_f32_16x16x32_bf16 v[112:115], v[164:167], v[80:83], v[112:115]
ds_read_b64_tr_b16 v[160:161], v14 offset:9216
ds_read_b64_tr_b16 v[162:163], v14 offset:13824
s_waitcnt lgkmcnt(8)
v_mfma_f32_16x16x32_bf16 v[116:119], v[168:171], v[80:83], v[116:119]
ds_read_b64_tr_b16 v[164:165], v14 offset:9248
ds_read_b64_tr_b16 v[166:167], v14 offset:13856
v_mfma_f32_16x16x32_bf16 v[120:123], v[140:143], v[80:83], v[120:123]
ds_read_b64_tr_b16 v[168:169], v14 offset:9280
ds_read_b64_tr_b16 v[170:171], v14 offset:13888
v_mfma_f32_16x16x32_bf16 v[124:127], v[144:147], v[80:83], v[124:127]
ds_read_b64_tr_b16 v[140:141], v14 offset:9312
ds_read_b64_tr_b16 v[142:143], v14 offset:13920
s_waitcnt lgkmcnt(8)
v_mfma_f32_16x16x32_bf16 v[128:131], v[148:151], v[80:83], v[128:131]
ds_read_b64_tr_b16 v[144:145], v14 offset:9344
ds_read_b64_tr_b16 v[146:147], v14 offset:13952
v_mfma_f32_16x16x32_bf16 v[132:135], v[152:155], v[80:83], v[132:135]
ds_read_b64_tr_b16 v[148:149], v14 offset:9376
ds_read_b64_tr_b16 v[150:151], v14 offset:13984
v_mfma_f32_16x16x32_bf16 v[136:139], v[156:159], v[80:83], v[136:139]
ds_read_b64_tr_b16 v[152:153], v14 offset:9408
ds_read_b64_tr_b16 v[154:155], v14 offset:14016
s_waitcnt lgkmcnt(8)
s_waitcnt vmcnt(13)
v_mfma_f32_16x16x32_bf16 v[104:107], v[160:163], v[84:87], v[104:107]
ds_read_b64_tr_b16 v[156:157], v14 offset:9440
ds_read_b64_tr_b16 v[158:159], v14 offset:14048
v_mfma_f32_16x16x32_bf16 v[108:111], v[164:167], v[84:87], v[108:111]
ds_read_b64_tr_b16 v[160:161], v14 offset:9472
ds_read_b64_tr_b16 v[162:163], v14 offset:14080
v_mfma_f32_16x16x32_bf16 v[112:115], v[168:171], v[84:87], v[112:115]
s_waitcnt vmcnt(0)
s_barrier
ds_read_b64_tr_b16 v[164:165], v12 offset:0
ds_read_b64_tr_b16 v[166:167], v12 offset:4608
s_waitcnt lgkmcnt(8)
v_mfma_f32_16x16x32_bf16 v[116:119], v[140:143], v[84:87], v[116:119]
ds_read_b64_tr_b16 v[168:169], v12 offset:32
ds_read_b64_tr_b16 v[170:171], v12 offset:4640
v_mfma_f32_16x16x32_bf16 v[120:123], v[144:147], v[84:87], v[120:123]
ds_read_b64_tr_b16 v[140:141], v12 offset:64
ds_read_b64_tr_b16 v[142:143], v12 offset:4672
v_mfma_f32_16x16x32_bf16 v[124:127], v[148:151], v[84:87], v[124:127]
ds_read_b64_tr_b16 v[144:145], v12 offset:96
ds_read_b64_tr_b16 v[146:147], v12 offset:4704
s_waitcnt lgkmcnt(8)
v_mfma_f32_16x16x32_bf16 v[128:131], v[152:155], v[84:87], v[128:131]
ds_read_b64_tr_b16 v[148:149], v12 offset:128
ds_read_b64_tr_b16 v[150:151], v12 offset:4736
v_mfma_f32_16x16x32_bf16 v[132:135], v[156:159], v[84:87], v[132:135]
ds_read_b64_tr_b16 v[152:153], v12 offset:160
ds_read_b64_tr_b16 v[154:155], v12 offset:4768
v_mfma_f32_16x16x32_bf16 v[136:139], v[160:163], v[84:87], v[136:139]
ds_read_b64_tr_b16 v[156:157], v12 offset:192
ds_read_b64_tr_b16 v[158:159], v12 offset:4800
s_waitcnt lgkmcnt(8)
v_mfma_f32_16x16x32_bf16 v[104:107], v[164:167], v[88:91], v[104:107]
ds_read_b64_tr_b16 v[160:161], v12 offset:224
ds_read_b64_tr_b16 v[162:163], v12 offset:4832
v_mfma_f32_16x16x32_bf16 v[108:111], v[168:171], v[88:91], v[108:111]
ds_read_b64_tr_b16 v[164:165], v12 offset:256
ds_read_b64_tr_b16 v[166:167], v12 offset:4864
v_mfma_f32_16x16x32_bf16 v[112:115], v[140:143], v[88:91], v[112:115]
ds_read_b64_tr_b16 v[168:169], v12 offset:9216
ds_read_b64_tr_b16 v[170:171], v12 offset:13824
s_waitcnt lgkmcnt(8)
v_mfma_f32_16x16x32_bf16 v[116:119], v[144:147], v[88:91], v[116:119]
ds_read_b64_tr_b16 v[140:141], v12 offset:9248
ds_read_b64_tr_b16 v[142:143], v12 offset:13856
v_mfma_f32_16x16x32_bf16 v[120:123], v[148:151], v[88:91], v[120:123]
ds_read_b64_tr_b16 v[144:145], v12 offset:9280
ds_read_b64_tr_b16 v[146:147], v12 offset:13888
v_mfma_f32_16x16x32_bf16 v[124:127], v[152:155], v[88:91], v[124:127]
ds_read_b64_tr_b16 v[148:149], v12 offset:9312
ds_read_b64_tr_b16 v[150:151], v12 offset:13920
s_waitcnt lgkmcnt(8)
v_mfma_f32_16x16x32_bf16 v[128:131], v[156:159], v[88:91], v[128:131]
ds_read_b64_tr_b16 v[152:153], v12 offset:9344
ds_read_b64_tr_b16 v[154:155], v12 offset:13952
v_mfma_f32_16x16x32_bf16 v[132:135], v[160:163], v[88:91], v[132:135]
ds_read_b64_tr_b16 v[156:157], v12 offset:9376
ds_read_b64_tr_b16 v[158:159], v12 offset:13984
v_mfma_f32_16x16x32_bf16 v[136:139], v[164:167], v[88:91], v[136:139]
ds_read_b64_tr_b16 v[160:161], v12 offset:9408
ds_read_b64_tr_b16 v[162:163], v12 offset:14016
s_waitcnt lgkmcnt(8)
v_mfma_f32_16x16x32_bf16 v[104:107], v[168:171], v[92:95], v[104:107]
ds_read_b64_tr_b16 v[164:165], v12 offset:9440
ds_read_b64_tr_b16 v[166:167], v12 offset:14048
v_mfma_f32_16x16x32_bf16 v[108:111], v[140:143], v[92:95], v[108:111]
ds_read_b64_tr_b16 v[168:169], v12 offset:9472
ds_read_b64_tr_b16 v[170:171], v12 offset:14080
v_mfma_f32_16x16x32_bf16 v[112:115], v[144:147], v[92:95], v[112:115]
ds_read_b64_tr_b16 v[140:141], v12 offset:18432
ds_read_b64_tr_b16 v[142:143], v12 offset:23040
s_waitcnt lgkmcnt(8)
v_mfma_f32_16x16x32_bf16 v[116:119], v[148:151], v[92:95], v[116:119]
ds_read_b64_tr_b16 v[144:145], v12 offset:18464
ds_read_b64_tr_b16 v[146:147], v12 offset:23072
v_mfma_f32_16x16x32_bf16 v[120:123], v[152:155], v[92:95], v[120:123]
ds_read_b64_tr_b16 v[148:149], v12 offset:18496
ds_read_b64_tr_b16 v[150:151], v12 offset:23104
v_mfma_f32_16x16x32_bf16 v[124:127], v[156:159], v[92:95], v[124:127]
ds_read_b64_tr_b16 v[152:153], v12 offset:18528
ds_read_b64_tr_b16 v[154:155], v12 offset:23136
s_waitcnt lgkmcnt(8)
v_mfma_f32_16x16x32_bf16 v[128:131], v[160:163], v[92:95], v[128:131]
ds_read_b64_tr_b16 v[156:157], v12 offset:18560
ds_read_b64_tr_b16 v[158:159], v12 offset:23168
v_mfma_f32_16x16x32_bf16 v[132:135], v[164:167], v[92:95], v[132:135]
ds_read_b64_tr_b16 v[160:161], v12 offset:18592
ds_read_b64_tr_b16 v[162:163], v12 offset:23200
v_mfma_f32_16x16x32_bf16 v[136:139], v[168:171], v[92:95], v[136:139]
ds_read_b64_tr_b16 v[164:165], v12 offset:18624
ds_read_b64_tr_b16 v[166:167], v12 offset:23232
s_waitcnt lgkmcnt(8)
v_mfma_f32_16x16x32_bf16 v[104:107], v[140:143], v[96:99], v[104:107]
ds_read_b64_tr_b16 v[168:169], v12 offset:18656
ds_read_b64_tr_b16 v[170:171], v12 offset:23264
v_mfma_f32_16x16x32_bf16 v[108:111], v[144:147], v[96:99], v[108:111]
ds_read_b64_tr_b16 v[140:141], v12 offset:18688
ds_read_b64_tr_b16 v[142:143], v12 offset:23296
v_mfma_f32_16x16x32_bf16 v[112:115], v[148:151], v[96:99], v[112:115]
ds_read_b64_tr_b16 v[144:145], v12 offset:27648
ds_read_b64_tr_b16 v[146:147], v12 offset:32256
s_waitcnt lgkmcnt(8)
v_mfma_f32_16x16x32_bf16 v[116:119], v[152:155], v[96:99], v[116:119]
ds_read_b64_tr_b16 v[148:149], v12 offset:27680
ds_read_b64_tr_b16 v[150:151], v12 offset:32288
v_mfma_f32_16x16x32_bf16 v[120:123], v[156:159], v[96:99], v[120:123]
ds_read_b64_tr_b16 v[152:153], v12 offset:27712
ds_read_b64_tr_b16 v[154:155], v12 offset:32320
v_mfma_f32_16x16x32_bf16 v[124:127], v[160:163], v[96:99], v[124:127]
ds_read_b64_tr_b16 v[156:157], v12 offset:27744
ds_read_b64_tr_b16 v[158:159], v12 offset:32352
s_waitcnt lgkmcnt(8)
v_mfma_f32_16x16x32_bf16 v[128:131], v[164:167], v[96:99], v[128:131]
ds_read_b64_tr_b16 v[160:161], v12 offset:27776
ds_read_b64_tr_b16 v[162:163], v12 offset:32384
v_mfma_f32_16x16x32_bf16 v[132:135], v[168:171], v[96:99], v[132:135]
ds_read_b64_tr_b16 v[164:165], v12 offset:27808
ds_read_b64_tr_b16 v[166:167], v12 offset:32416
v_mfma_f32_16x16x32_bf16 v[136:139], v[140:143], v[96:99], v[136:139]
ds_read_b64_tr_b16 v[168:169], v12 offset:27840
ds_read_b64_tr_b16 v[170:171], v12 offset:32448
s_waitcnt lgkmcnt(8)
v_mfma_f32_16x16x32_bf16 v[104:107], v[144:147], v[100:103], v[104:107]
ds_read_b64_tr_b16 v[140:141], v12 offset:27872
ds_read_b64_tr_b16 v[142:143], v12 offset:32480
v_mfma_f32_16x16x32_bf16 v[108:111], v[148:151], v[100:103], v[108:111]
ds_read_b64_tr_b16 v[144:145], v12 offset:27904
ds_read_b64_tr_b16 v[146:147], v12 offset:32512
v_mfma_f32_16x16x32_bf16 v[112:115], v[152:155], v[100:103], v[112:115]
v_xor_b32 v24, 0, v15
ds_read_b64 v[172:173], v24
s_waitcnt lgkmcnt(7)
v_mfma_f32_16x16x32_bf16 v[116:119], v[156:159], v[100:103], v[116:119]
v_xor_b32 v25, 32, v15
ds_read_b64 v[174:175], v25
v_mfma_f32_16x16x32_bf16 v[120:123], v[160:163], v[100:103], v[120:123]
v_xor_b32 v24, 64, v15
ds_read_b64 v[176:177], v24
v_mfma_f32_16x16x32_bf16 v[124:127], v[164:167], v[100:103], v[124:127]
v_xor_b32 v25, 96, v15
ds_read_b64 v[178:179], v25
s_waitcnt lgkmcnt(4)
v_mfma_f32_16x16x32_bf16 v[128:131], v[168:171], v[100:103], v[128:131]
v_xor_b32 v24, 128, v15
ds_read_b64 v[180:181], v24
v_mfma_f32_16x16x32_bf16 v[132:135], v[140:143], v[100:103], v[132:135]
v_xor_b32 v25, 160, v15
ds_read_b64 v[182:183], v25
v_xor_b32 v24, 192, v15
ds_read_b64 v[184:185], v24
v_mfma_f32_16x16x32_bf16 v[136:139], v[144:147], v[100:103], v[136:139]
v_xor_b32 v25, 224, v15
ds_read_b64 v[186:187], v25
s_lshl_b32 s7, s14, 1
s_lshr_b32 s8, s3, 1
s_add_u32 s7, s7, s8
s_mul_i32 s7, s7, 36
s_mul_i32 s8, s15, 9
s_add_u32 s7, s7, s8
s_lshl_b32 s7, s7, 10
s_add_u32 s7, s7, 262144
v_mov_b32 v20, 0
v_mov_b32 v21, 0
v_mov_b32 v22, 0
v_mov_b32 v23, 0
v_cvt_pk_bf16_f32 v190, v104, v105
v_cvt_pk_bf16_f32 v191, v106, v107
v_lshlrev_b32 v104, 16, v190
v_and_b32 v105, 0xffff0000, v190
v_lshlrev_b32 v106, 16, v191
v_and_b32 v107, 0xffff0000, v191
s_waitcnt lgkmcnt(7)
v_lshlrev_b32 v190, 16, v172
v_and_b32 v191, 0xffff0000, v172
v_lshlrev_b32 v192, 16, v173
v_and_b32 v193, 0xffff0000, v173
v_add_f32 v190, v190, v104
v_add_f32 v191, v191, v105
v_add_f32 v192, v192, v106
v_add_f32 v193, v193, v107
v_cvt_pk_bf16_f32 v194, v190, v191
v_cvt_pk_bf16_f32 v195, v192, v193
buffer_store_dwordx2 v[194:195], v17, s[72:75], s7 offen offset:0 sc1
v_dot2c_f32_bf16 v20, s96, v194
v_dot2c_f32_bf16 v22, v194, v194
v_dot2c_f32_bf16 v21, s96, v195
v_dot2c_f32_bf16 v23, v195, v195
v_cvt_pk_bf16_f32 v198, v108, v109
v_cvt_pk_bf16_f32 v199, v110, v111
v_lshlrev_b32 v108, 16, v198
v_and_b32 v109, 0xffff0000, v198
v_lshlrev_b32 v110, 16, v199
v_and_b32 v111, 0xffff0000, v199
s_waitcnt lgkmcnt(6)
v_lshlrev_b32 v198, 16, v174
v_and_b32 v199, 0xffff0000, v174
v_lshlrev_b32 v200, 16, v175
v_and_b32 v201, 0xffff0000, v175
v_add_f32 v198, v198, v108
v_add_f32 v199, v199, v109
v_add_f32 v200, v200, v110
v_add_f32 v201, v201, v111
v_cvt_pk_bf16_f32 v202, v198, v199
v_cvt_pk_bf16_f32 v203, v200, v201
buffer_store_dwordx2 v[202:203], v17, s[72:75], s7 offen offset:1024 sc1
v_dot2c_f32_bf16 v20, s96, v202
v_dot2c_f32_bf16 v22, v202, v202
v_dot2c_f32_bf16 v21, s96, v203
v_dot2c_f32_bf16 v23, v203, v203
v_cvt_pk_bf16_f32 v190, v112, v113
v_cvt_pk_bf16_f32 v191, v114, v115
v_lshlrev_b32 v112, 16, v190
v_and_b32 v113, 0xffff0000, v190
v_lshlrev_b32 v114, 16, v191
v_and_b32 v115, 0xffff0000, v191
s_waitcnt lgkmcnt(5)
v_lshlrev_b32 v190, 16, v176
v_and_b32 v191, 0xffff0000, v176
v_lshlrev_b32 v192, 16, v177
v_and_b32 v193, 0xffff0000, v177
v_add_f32 v190, v190, v112
v_add_f32 v191, v191, v113
v_add_f32 v192, v192, v114
v_add_f32 v193, v193, v115
v_cvt_pk_bf16_f32 v194, v190, v191
v_cvt_pk_bf16_f32 v195, v192, v193
buffer_store_dwordx2 v[194:195], v17, s[72:75], s7 offen offset:2048 sc1
v_dot2c_f32_bf16 v20, s96, v194
v_dot2c_f32_bf16 v22, v194, v194
v_dot2c_f32_bf16 v21, s96, v195
v_dot2c_f32_bf16 v23, v195, v195
v_cvt_pk_bf16_f32 v198, v116, v117
v_cvt_pk_bf16_f32 v199, v118, v119
v_lshlrev_b32 v116, 16, v198
v_and_b32 v117, 0xffff0000, v198
v_lshlrev_b32 v118, 16, v199
v_and_b32 v119, 0xffff0000, v199
s_waitcnt lgkmcnt(4)
v_lshlrev_b32 v198, 16, v178
v_and_b32 v199, 0xffff0000, v178
v_lshlrev_b32 v200, 16, v179
v_and_b32 v201, 0xffff0000, v179
v_add_f32 v198, v198, v116
v_add_f32 v199, v199, v117
v_add_f32 v200, v200, v118
v_add_f32 v201, v201, v119
v_cvt_pk_bf16_f32 v202, v198, v199
v_cvt_pk_bf16_f32 v203, v200, v201
buffer_store_dwordx2 v[202:203], v17, s[72:75], s7 offen offset:3072 sc1
v_dot2c_f32_bf16 v20, s96, v202
v_dot2c_f32_bf16 v22, v202, v202
v_dot2c_f32_bf16 v21, s96, v203
v_dot2c_f32_bf16 v23, v203, v203
v_cvt_pk_bf16_f32 v190, v120, v121
v_cvt_pk_bf16_f32 v191, v122, v123
v_lshlrev_b32 v120, 16, v190
v_and_b32 v121, 0xffff0000, v190
v_lshlrev_b32 v122, 16, v191
v_and_b32 v123, 0xffff0000, v191
s_waitcnt lgkmcnt(3)
v_lshlrev_b32 v190, 16, v180
v_and_b32 v191, 0xffff0000, v180
v_lshlrev_b32 v192, 16, v181
v_and_b32 v193, 0xffff0000, v181
v_add_f32 v190, v190, v120
v_add_f32 v191, v191, v121
v_add_f32 v192, v192, v122
v_add_f32 v193, v193, v123
v_cvt_pk_bf16_f32 v194, v190, v191
v_cvt_pk_bf16_f32 v195, v192, v193
s_add_u32 s7, s7, 4096
buffer_store_dwordx2 v[194:195], v17, s[72:75], s7 offen offset:0 sc1
v_dot2c_f32_bf16 v20, s96, v194
v_dot2c_f32_bf16 v22, v194, v194
v_dot2c_f32_bf16 v21, s96, v195
v_dot2c_f32_bf16 v23, v195, v195
v_cvt_pk_bf16_f32 v198, v124, v125
v_cvt_pk_bf16_f32 v199, v126, v127
v_lshlrev_b32 v124, 16, v198
v_and_b32 v125, 0xffff0000, v198
v_lshlrev_b32 v126, 16, v199
v_and_b32 v127, 0xffff0000, v199
s_waitcnt lgkmcnt(2)
v_lshlrev_b32 v198, 16, v182
v_and_b32 v199, 0xffff0000, v182
v_lshlrev_b32 v200, 16, v183
v_and_b32 v201, 0xffff0000, v183
v_add_f32 v198, v198, v124
v_add_f32 v199, v199, v125
v_add_f32 v200, v200, v126
v_add_f32 v201, v201, v127
v_cvt_pk_bf16_f32 v202, v198, v199
v_cvt_pk_bf16_f32 v203, v200, v201
buffer_store_dwordx2 v[202:203], v17, s[72:75], s7 offen offset:1024 sc1
v_dot2c_f32_bf16 v20, s96, v202
v_dot2c_f32_bf16 v22, v202, v202
v_dot2c_f32_bf16 v21, s96, v203
v_dot2c_f32_bf16 v23, v203, v203
v_cvt_pk_bf16_f32 v190, v128, v129
v_cvt_pk_bf16_f32 v191, v130, v131
v_lshlrev_b32 v128, 16, v190
v_and_b32 v129, 0xffff0000, v190
v_lshlrev_b32 v130, 16, v191
v_and_b32 v131, 0xffff0000, v191
s_waitcnt lgkmcnt(1)
v_lshlrev_b32 v190, 16, v184
v_and_b32 v191, 0xffff0000, v184
v_lshlrev_b32 v192, 16, v185
v_and_b32 v193, 0xffff0000, v185
v_add_f32 v190, v190, v128
v_add_f32 v191, v191, v129
v_add_f32 v192, v192, v130
v_add_f32 v193, v193, v131
v_cvt_pk_bf16_f32 v194, v190, v191
v_cvt_pk_bf16_f32 v195, v192, v193
buffer_store_dwordx2 v[194:195], v17, s[72:75], s7 offen offset:2048 sc1
v_dot2c_f32_bf16 v20, s96, v194
v_dot2c_f32_bf16 v22, v194, v194
v_dot2c_f32_bf16 v21, s96, v195
v_dot2c_f32_bf16 v23, v195, v195
v_cvt_pk_bf16_f32 v198, v132, v133
v_cvt_pk_bf16_f32 v199, v134, v135
v_lshlrev_b32 v132, 16, v198
v_and_b32 v133, 0xffff0000, v198
v_lshlrev_b32 v134, 16, v199
v_and_b32 v135, 0xffff0000, v199
s_waitcnt lgkmcnt(0)
v_lshlrev_b32 v198, 16, v186
v_and_b32 v199, 0xffff0000, v186
v_lshlrev_b32 v200, 16, v187
v_and_b32 v201, 0xffff0000, v187
v_add_f32 v198, v198, v132
v_add_f32 v199, v199, v133
v_add_f32 v200, v200, v134
v_add_f32 v201, v201, v135
v_cvt_pk_bf16_f32 v202, v198, v199
v_cvt_pk_bf16_f32 v203, v200, v201
buffer_store_dwordx2 v[202:203], v17, s[72:75], s7 offen offset:3072 sc1
v_dot2c_f32_bf16 v20, s96, v202
v_dot2c_f32_bf16 v22, v202, v202
v_dot2c_f32_bf16 v21, s96, v203
v_dot2c_f32_bf16 v23, v203, v203
v_cvt_pk_bf16_f32 v190, v136, v137
v_cvt_pk_bf16_f32 v191, v138, v139
v_lshlrev_b32 v136, 16, v190
v_and_b32 v137, 0xffff0000, v190
v_lshlrev_b32 v138, 16, v191
v_and_b32 v139, 0xffff0000, v191
v_lshlrev_b32 v190, 16, v188
v_and_b32 v191, 0xffff0000, v188
v_lshlrev_b32 v192, 16, v189
v_and_b32 v193, 0xffff0000, v189
v_add_f32 v190, v190, v136
v_add_f32 v191, v191, v137
v_add_f32 v192, v192, v138
v_add_f32 v193, v193, v139
v_cvt_pk_bf16_f32 v194, v190, v191
v_cvt_pk_bf16_f32 v195, v192, v193
s_add_u32 s7, s7, 4096
buffer_store_dwordx2 v[194:195], v17, s[72:75], s7 offen offset:0 sc1
v_dot2c_f32_bf16 v20, s96, v194
v_dot2c_f32_bf16 v22, v194, v194
v_dot2c_f32_bf16 v21, s96, v195
v_dot2c_f32_bf16 v23, v195, v195
s_nop 1
v_add_f32 v20, v20, v21
v_add_f32 v21, v22, v23
v_mov_b32 v24, v20
s_nop 1
v_permlane32_swap_b32 v20, v24
v_add_f32 v20, v20, v24
v_mov_b32 v24, v20
s_nop 1
v_permlane16_swap_b32 v20, v24
v_add_f32 v20, v20, v24
v_mov_b32 v24, v21
s_nop 1
v_permlane32_swap_b32 v21, v24
v_add_f32 v21, v21, v24
v_mov_b32 v24, v21
s_nop 1
v_permlane16_swap_b32 v21, v24
v_add_f32 v21, v21, v24
s_and_b32 s7, s100, 31
s_lshl_b32 s7, s7, 7
s_add_u32 s7, s7, 4096
buffer_store_dwordx2 v[20:21], v18, s[72:75], s7 offen sc1
s_mov_b32 s101, 1073741824
L_join:
v_bfe_u32 v32, v0, 2, 3
v_lshrrev_b32 v33, 5, v0
v_and_b32 v34, 3, v0
v_lshlrev_b32 v33, 6, v33
v_lshl_add_u32 v33, v34, 4, v33
s_mul_i32 s7, s3, 48
v_add_u32 v35, s7, v32
v_mul_u32_u24 v13, 9216, v35
v_add_u32 v13, v13, v33
v_mul_u32_u24 v14, 1152, v35
v_add_u32 v14, v14, v33
v_add_u32 v6, 367616, v13
v_add_u32 v12, 45056, v14
v_add_u32 v5, 294912, v13
v_add_u32 v11, 36864, v14
v_add_u32 v4, 218112, v13
v_add_u32 v10, 24576, v14
v_add_u32 v3, 145408, v13
v_add_u32 v9, 16384, v14
v_add_u32 v2, 72704, v13
v_add_u32 v8, 8192, v14
v_add_u32 v1, 0, v13
v_add_u32 v7, 0, v14
v_mul_u32_u24 v35, 1152, v32
v_add_u32 v14, v35, v33
v_and_b32 v35, 3, v32
v_add_u32 v35, 16, v35
v_mul_u32_u24 v35, 1152, v35
v_add_u32 v15, v35, v33
v_lshrrev_b32 v32, 2, v0
v_lshlrev_b32 v34, 4, v34
v_mul_u32_u24 v35, 9216, v32
v_add_u32 v13, v34, v35
v_mul_u32_u24 v35, 1152, v32
v_add_u32 v36, v34, v35
v_and_b32 v32, 3, v32
v_mul_u32_u24 v32, 1152, v32
v_add_u32 v37, v34, v32
s_and_b32 s91, s5, 1
s_mul_i32 s17, s5, 576
s_lshl_b32 s8, s91, 6
s_add_u32 s16, s17, s8
s_cmp_eq_u32 s91, 0
s_cselect_b32 s8, 512, 0
s_add_u32 s17, s17, s8
s_mul_i32 s29, s3, 6144
s_mul_i32 s30, s3, 3072
s_lshl_b32 s31, s3, 10
v_bfe_u32 v32, v0, 2, 2
v_bfe_u32 v33, v0, 4, 1
v_lshrrev_b32 v34, 5, v0
v_and_b32 v35, 3, v0
v_lshlrev_b32 v32, 6, v32
v_lshl_add_u32 v32, v33, 5, v32
v_lshl_add_u32 v32, v35, 3, v32
v_lshl_add_u32 v25, v34, 9, v32
v_add_u32 v31, 49152, v25
v_add_u32 v22, 0, v32
v_lshl_add_u32 v16, v34, 10, v22
v_lshl_add_u32 v19, v34, 8, v22
v_add_u32 v23, 49152, v32
v_lshl_add_u32 v17, v34, 10, v23
v_lshl_add_u32 v20, v34, 8, v23
v_add_u32 v24, 98304, v32
v_lshl_add_u32 v18, v34, 10, v24
v_lshl_add_u32 v21, v34, 8, v24
v_lshlrev_b32 v26, 4, v0
s_waitcnt vmcnt(0) lgkmcnt(0)
s_barrier
s_lshl_b32 s7, s5, 2
s_add_u32 s7, s7, 18432
v_mov_b32 v255, s6
buffer_store_dword v255, v253, s[72:75], s7 offen sc1
buffer_store_dword v254, v253, s[76:79], s101 offen sc1
s_lshl_b32 s90, s5, 2
s_add_u32 s90, s90, s3
s_mul_i32 s33, s90, 18432
s_add_u32 s34, s33, 655360
s_add_u32 s33, s33, 1835008
s_mul_i32 s51, s90, 2304
s_add_u32 s51, s51, 458752
s_xor_b32 s90, s90, 4
s_mul_i32 s101, s90, 18432
s_add_u32 s101, s101, 655360
s_mul_i32 s88, s91, 640
s_lshl_b32 s89, s91, 6
s_add_u32 s89, s89, 512
s_xor_b32 s86, s5, 1
s_and_b32 s87, s5, 1
s_lshl_b32 s87, s87, 5
s_mul_i32 s90, s5, 288
s_add_u32 s96, s90, s87
s_mul_i32 s18, s96, 1152
s_add_u32 s18, s18, s88
s_mul_i32 s20, s3, 24
s_add_u32 s20, s20, 192
s_add_u32 s20, s20, s87
s_sub_u32 s96, s20, 288
s_cmp_ge_u32 s20, 288
s_cselect_b32 s20, s96, s20
s_add_u32 s20, s20, s90
s_mul_i32 s20, s20, 1152
s_add_u32 s20, s20, s88
s_mul_i32 s21, s3, 24
s_add_u32 s21, s21, 200
s_add_u32 s21, s21, s87
s_sub_u32 s96, s21, 288
s_cmp_ge_u32 s21, 288
s_cselect_b32 s21, s96, s21
s_add_u32 s21, s21, s90
s_mul_i32 s21, s21, 1152
s_add_u32 s21, s21, s88
s_sub_u32 s21, s21, 1024
s_mul_i32 s22, s3, 24
s_add_u32 s22, s22, 208
s_add_u32 s22, s22, s87
s_sub_u32 s96, s22, 288
s_cmp_ge_u32 s22, 288
s_cselect_b32 s22, s96, s22
s_add_u32 s22, s22, s90
s_mul_i32 s22, s22, 1152
s_add_u32 s22, s22, s88
s_sub_u32 s22, s22, 2048
s_mul_i32 s40, s3, 96
s_add_u32 s40, s40, 0
s_add_u32 s40, s40, s87
s_sub_u32 s96, s40, 288
s_cmp_ge_u32 s40, 288
s_cselect_b32 s40, s96, s40
s_add_u32 s40, s40, s90
s_mul_i32 s40, s40, 1152
s_add_u32 s40, s40, s89
s_mul_i32 s41, s3, 96
s_add_u32 s41, s41, 16
s_add_u32 s41, s41, s87
s_sub_u32 s96, s41, 288
s_cmp_ge_u32 s41, 288
s_cselect_b32 s41, s96, s41
s_add_u32 s41, s41, s90
s_mul_i32 s41, s41, 1152
s_add_u32 s41, s41, s89
s_mul_i32 s42, s3, 96
s_add_u32 s42, s42, 32
s_add_u32 s42, s42, s87
s_sub_u32 s96, s42, 288
s_cmp_ge_u32 s42, 288
s_cselect_b32 s42, s96, s42
s_add_u32 s42, s42, s90
s_mul_i32 s42, s42, 1152
s_add_u32 s42, s42, s89
s_mul_i32 s43, s3, 96
s_add_u32 s43, s43, 48
s_add_u32 s43, s43, s87
s_sub_u32 s96, s43, 288
s_cmp_ge_u32 s43, 288
s_cselect_b32 s43, s96, s43
s_add_u32 s43, s43, s90
s_mul_i32 s43, s43, 1152
s_add_u32 s43, s43, s89
s_mul_i32 s44, s3, 96
s_add_u32 s44, s44, 64
s_add_u32 s44, s44, s87
s_sub_u32 s96, s44, 288
s_cmp_ge_u32 s44, 288
s_cselect_b32 s44, s96, s44
s_add_u32 s44, s44, s90
s_mul_i32 s44, s44, 1152
s_add_u32 s44, s44, s89
s_mul_i32 s45, s3, 96
s_add_u32 s45, s45, 80
s_add_u32 s45, s45, s87
s_sub_u32 s96, s45, 288
s_cmp_ge_u32 s45, 288
s_cselect_b32 s45, s96, s45
s_add_u32 s45, s45, s90
s_mul_i32 s45, s45, 1152
s_add_u32 s45, s45, s89
s_mul_i32 s90, s5, 36
s_lshl_b32 s96, s3, 3
s_add_u32 s96, s96, s90
s_lshr_b32 s87, s3, 1
s_lshl_b32 s87, s87, 2
s_add_u32 s96, s96, s87
s_mul_i32 s26, s96, 1152
s_add_u32 s26, s26, s88
s_and_b32 s87, s86, 1
s_lshl_b32 s87, s87, 5
s_mul_i32 s90, s86, 288
s_add_u32 s96, s90, s87
s_mul_i32 s19, s96, 1152
s_add_u32 s19, s19, s88
s_mul_i32 s23, s3, 24
s_add_u32 s23, s23, 192
s_add_u32 s23, s23, s87
s_sub_u32 s96, s23, 288
s_cmp_ge_u32 s23, 288
s_cselect_b32 s23, s96, s23
s_add_u32 s23, s23, s90
s_mul_i32 s23, s23, 1152
s_add_u32 s23, s23, s88
s_mul_i32 s24, s3, 24
s_add_u32 s24, s24, 200
s_add_u32 s24, s24, s87
s_sub_u32 s96, s24, 288
s_cmp_ge_u32 s24, 288
s_cselect_b32 s24, s96, s24
s_add_u32 s24, s24, s90
s_mul_i32 s24, s24, 1152
s_add_u32 s24, s24, s88
s_sub_u32 s24, s24, 1024
s_mul_i32 s25, s3, 24
s_add_u32 s25, s25, 208
s_add_u32 s25, s25, s87
s_sub_u32 s96, s25, 288
s_cmp_ge_u32 s25, 288
s_cselect_b32 s25, s96, s25
s_add_u32 s25, s25, s90
s_mul_i32 s25, s25, 1152
s_add_u32 s25, s25, s88
s_sub_u32 s25, s25, 2048
s_mul_i32 s46, s3, 80
s_add_u32 s46, s46, 0
s_min_u32 s46, s46, 272
s_add_u32 s46, s46, s87
s_sub_u32 s96, s46, 288
s_cmp_ge_u32 s46, 288
s_cselect_b32 s46, s96, s46
s_add_u32 s46, s46, s90
s_mul_i32 s46, s46, 1152
s_add_u32 s46, s46, s89
s_mul_i32 s47, s3, 80
s_add_u32 s47, s47, 16
s_min_u32 s47, s47, 272
s_add_u32 s47, s47, s87
s_sub_u32 s96, s47, 288
s_cmp_ge_u32 s47, 288
s_cselect_b32 s47, s96, s47
s_add_u32 s47, s47, s90
s_mul_i32 s47, s47, 1152
s_add_u32 s47, s47, s89
s_mul_i32 s48, s3, 80
s_add_u32 s48, s48, 32
s_min_u32 s48, s48, 272
s_add_u32 s48, s48, s87
s_sub_u32 s96, s48, 288
s_cmp_ge_u32 s48, 288
s_cselect_b32 s48, s96, s48
s_add_u32 s48, s48, s90
s_mul_i32 s48, s48, 1152
s_add_u32 s48, s48, s89
s_mul_i32 s49, s3, 80
s_add_u32 s49, s49, 48
s_min_u32 s49, s49, 272
s_add_u32 s49, s49, s87
s_sub_u32 s96, s49, 288
s_cmp_ge_u32 s49, 288
s_cselect_b32 s49, s96, s49
s_add_u32 s49, s49, s90
s_mul_i32 s49, s49, 1152
s_add_u32 s49, s49, s89
s_mul_i32 s50, s3, 80
s_add_u32 s50, s50, 64
s_min_u32 s50, s50, 272
s_add_u32 s50, s50, s87
s_sub_u32 s96, s50, 288
s_cmp_ge_u32 s50, 288
s_cselect_b32 s50, s96, s50
s_add_u32 s50, s50, s90
s_mul_i32 s50, s50, 1152
s_add_u32 s50, s50, s89
s_mul_i32 s90, s86, 36
s_lshl_b32 s96, s3, 3
s_add_u32 s96, s96, s90
s_lshr_b32 s87, s3, 1
s_lshl_b32 s87, s87, 2
s_add_u32 s96, s96, s87
s_mul_i32 s27, s96, 1152
s_add_u32 s27, s27, s88
s_and_b32 s90, s3, 1
s_xor_b32 s90, s90, s5
s_mul_i32 s28, s90, 41472
s_add_u32 s28, s28, s88
s_cmp_ge_u32 s3, 2
s_cselect_b32 s28, 1073741824, s28
s_mul_i32 s90, s5, 41472
s_add_u32 s90, s90, s89
s_mul_i32 s96, s86, 41472
s_add_u32 s96, s96, s89
s_add_u32 s87, s90, 0
s_cmp_eq_u32 s3, 3
s_cselect_b32 s40, s87, s40
s_add_u32 s87, s90, 23040
s_cmp_eq_u32 s3, 3
s_cselect_b32 s41, s87, s41
s_add_u32 s87, s96, 0
s_cmp_eq_u32 s3, 3
s_cselect_b32 s42, s87, s42
s_add_u32 s87, s96, 23040
s_cmp_eq_u32 s3, 3
s_cselect_b32 s43, s87, s43
s_add_u32 s87, s90, 18432
s_cmp_eq_u32 s3, 3
s_cselect_b32 s44, s87, s44
s_add_u32 s87, s96, 18432
s_cmp_eq_u32 s3, 3
s_cselect_b32 s45, s87, s45
s_cselect_b32 s52, s64, s60
s_cselect_b32 s53, s65, s61
s_cselect_b32 s54, 663552, s62
s_mov_b32 s55, 0x20000
s_cselect_b64 s[92:93], -1, 0
v_cndmask_b32 v37, v36, v37, s[92:93]
s_lshl_b32 s12, s5, 2
v_accvgpr_write_b32 a255, s6
s_waitcnt lgkmcnt(0)
s_cmp_lg_u32 s3, 0
s_cbranch_scc1 L_skip_8
s_movk_i32 s7, 18432
v_and_b32 v32, 15, v0
v_lshlrev_b32 v32, 2, v32
s_mov_b32 s8, 0
L_poll_9:
buffer_load_dword v33, v32, s[72:75], s7 offen sc1
s_waitcnt vmcnt(0)
v_cmp_ne_u32 vcc, s6, v33
s_cbranch_vccz L_done_10
s_add_u32 s8, s8, 1
s_cmp_lt_u32 s8, 262144
s_sleep 1
s_cbranch_scc1 L_poll_9
v_mov_b32 v33, 102
buffer_store_dword v33, v253, s[80:83], 0 offen
s_waitcnt vmcnt(0)
L_done_10:
s_nop 0
L_skip_8:
s_add_u32 s32, s16, 0
s_add_u32 m0, s29, 0
s_nop 0
buffer_load_dwordx4 v1, s[56:59], s32 offen offset:0 lds
buffer_load_dwordx4 v2, s[56:59], s32 offen offset:1024 lds
buffer_load_dwordx4 v3, s[56:59], s32 offen offset:2048 lds
buffer_load_dwordx4 v4, s[56:59], s32 offen offset:3072 lds
s_add_u32 m0, s29, 4096
s_nop 0
buffer_load_dwordx4 v5, s[56:59], s32 offen offset:0 lds
buffer_load_dwordx4 v6, s[56:59], s32 offen offset:1024 lds
s_add_u32 s32, s16, 1769472
s_add_u32 m0, s29, 24576
s_nop 0
buffer_load_dwordx4 v1, s[56:59], s32 offen offset:0 lds
buffer_load_dwordx4 v2, s[56:59], s32 offen offset:1024 lds
buffer_load_dwordx4 v3, s[56:59], s32 offen offset:2048 lds
buffer_load_dwordx4 v4, s[56:59], s32 offen offset:3072 lds
s_add_u32 m0, s29, 28672
s_nop 0
buffer_load_dwordx4 v5, s[56:59], s32 offen offset:0 lds
buffer_load_dwordx4 v6, s[56:59], s32 offen offset:1024 lds
s_barrier
v_and_b32 v32, 31, v0
v_lshlrev_b32 v33, 3, v32
v_mov_b32 v176, v33
s_lshr_b32 s7, s3, 1
s_lshl_b32 s7, s7, 11
s_and_b32 s8, s3, 1
s_lshl_b32 s8, s8, 8
s_add_u32 s7, s7, s8
s_add_u32 s7, s7, 4096
buffer_load_dwordx2 v[48:49], v33, s[72:75], s7 offen offset:0 sc1
buffer_load_dwordx2 v[50:51], v33, s[72:75], s7 offen offset:512 sc1
buffer_load_dwordx2 v[52:53], v33, s[72:75], s7 offen offset:1024 sc1
buffer_load_dwordx2 v[54:55], v33, s[72:75], s7 offen offset:1536 sc1
s_lshl_b32 s8, s3, 8
s_add_u32 s8, s8, 8192
buffer_load_dword v29, v33, s[72:75], s8 offen offset:4 sc1
s_mul_i32 s7, s3, 36864
s_add_u32 s7, s7, 262144
buffer_load_dwordx4 a[0:3], v26, s[72:75], s7 offen offset:0 sc1
buffer_load_dwordx4 a[4:7], v26, s[72:75], s7 offen offset:1024 sc1
buffer_load_dwordx4 a[8:11], v26, s[72:75], s7 offen offset:2048 sc1
buffer_load_dwordx4 a[12:15], v26, s[72:75], s7 offen offset:3072 sc1
s_add_u32 s7, s7, 4096
buffer_load_dwordx4 a[16:19], v26, s[72:75], s7 offen offset:0 sc1
buffer_load_dwordx4 a[20:23], v26, s[72:75], s7 offen offset:1024 sc1
buffer_load_dwordx4 a[24:27], v26, s[72:75], s7 offen offset:2048 sc1
buffer_load_dwordx4 a[28:31], v26, s[72:75], s7 offen offset:3072 sc1
s_add_u32 s7, s7, 4096
buffer_load_dwordx4 a[32:35], v26, s[72:75], s7 offen offset:0 sc1
buffer_load_dwordx4 a[36:39], v26, s[72:75], s7 offen offset:1024 sc1
L_slot0:
s_waitcnt vmcnt(21)
s_barrier
ds_read_b64_tr_b16 a[144:145], v16 offset:0
ds_read_b64_tr_b16 a[146:147], v16 offset:256
ds_read_b64_tr_b16 a[148:149], v16 offset:512
ds_read_b64_tr_b16 a[150:151], v16 offset:768
ds_read_b64_tr_b16 a[152:153], v16 offset:2048
ds_read_b64_tr_b16 a[154:155], v16 offset:2304
ds_read_b64_tr_b16 a[156:157], v16 offset:2560
ds_read_b64_tr_b16 a[158:159], v16 offset:2816
ds_read_b64_tr_b16 a[160:161], v16 offset:4096
ds_read_b64_tr_b16 a[162:163], v16 offset:4352
ds_read_b64_tr_b16 a[164:165], v16 offset:4608
ds_read_b64_tr_b16 a[166:167], v16 offset:4864
ds_read_b64_tr_b16 a[168:169], v16 offset:6144
ds_read_b64_tr_b16 a[170:171], v16 offset:6400
s_waitcnt lgkmcnt(6)
s_waitcnt vmcnt(9)
v_mfma_f32_32x32x16_bf16 v[112:127], a[144:147], a[0:3], 0
ds_read_b64_tr_b16 a[172:173], v16 offset:6656
ds_read_b64_tr_b16 a[174:175], v16 offset:6912
buffer_load_dwordx4 a[40:43], v26, s[72:75], s7 offen offset:2048 sc1
v_mfma_f32_32x32x16_bf16 v[128:143], a[148:151], a[0:3], 0
ds_read_b64_tr_b16 a[144:145], v16 offset:8192
ds_read_b64_tr_b16 a[146:147], v16 offset:8448
s_waitcnt vmcnt(9)
v_mfma_f32_32x32x16_bf16 v[112:127], a[152:155], a[4:7], v[112:127]
ds_read_b64_tr_b16 a[148:149], v16 offset:8704
ds_read_b64_tr_b16 a[150:151], v16 offset:8960
buffer_load_dwordx4 a[44:47], v26, s[72:75], s7 offen offset:3072 sc1
v_mfma_f32_32x32x16_bf16 v[128:143], a[156:159], a[4:7], v[128:143]
ds_read_b64_tr_b16 a[152:153], v16 offset:10240
ds_read_b64_tr_b16 a[154:155], v16 offset:10496
s_add_u32 s7, s7, 4096
s_waitcnt lgkmcnt(6)
s_waitcnt vmcnt(9)
v_mfma_f32_32x32x16_bf16 v[112:127], a[160:163], a[8:11], v[112:127]
ds_read_b64_tr_b16 a[156:157], v16 offset:10752
ds_read_b64_tr_b16 a[158:159], v16 offset:11008
buffer_load_dwordx4 a[48:51], v26, s[72:75], s7 offen offset:0 sc1
v_mfma_f32_32x32x16_bf16 v[128:143], a[164:167], a[8:11], v[128:143]
ds_read_b64_tr_b16 a[160:161], v16 offset:12288
ds_read_b64_tr_b16 a[162:163], v16 offset:12544
s_waitcnt vmcnt(9)
v_mfma_f32_32x32x16_bf16 v[112:127], a[168:171], a[12:15], v[112:127]
ds_read_b64_tr_b16 a[164:165], v16 offset:12800
ds_read_b64_tr_b16 a[166:167], v16 offset:13056
buffer_load_dwordx4 a[52:55], v26, s[72:75], s7 offen offset:1024 sc1
v_mov_b32 v34, 1073741824
v_cmp_gt_u32 s[84:85], 32, v0
v_mfma_f32_32x32x16_bf16 v[128:143], a[172:175], a[12:15], v[128:143]
ds_read_b64_tr_b16 a[168:169], v16 offset:14336
ds_read_b64_tr_b16 a[170:171], v16 offset:14592
v_cndmask_b32 v30, v34, v33, s[84:85]
v_add_f32 v27, v48, v50
s_waitcnt lgkmcnt(6)
s_waitcnt vmcnt(9)
v_mfma_f32_32x32x16_bf16 v[112:127], a[144:147], a[16:19], v[112:127]
ds_read_b64_tr_b16 a[172:173], v16 offset:14848
ds_read_b64_tr_b16 a[174:175], v16 offset:15104
buffer_load_dwordx4 a[56:59], v26, s[72:75], s7 offen offset:2048 sc1
s_add_u32 s32, s16, 3538944
s_add_u32 m0, s29, 49152
v_mfma_f32_32x32x16_bf16 v[128:143], a[148:151], a[16:19], v[128:143]
ds_read_b64_tr_b16 a[144:145], v16 offset:16384
ds_read_b64_tr_b16 a[146:147], v16 offset:16640
v_add_f32 v28, v49, v51
v_add_f32 v52, v52, v54
v_add_f32 v53, v53, v55
s_waitcnt vmcnt(9)
v_mfma_f32_32x32x16_bf16 v[112:127], a[152:155], a[20:23], v[112:127]
ds_read_b64_tr_b16 a[148:149], v16 offset:16896
ds_read_b64_tr_b16 a[150:151], v16 offset:17152
buffer_load_dwordx4 a[60:63], v26, s[72:75], s7 offen offset:3072 sc1
v_add_f32 v27, v27, v52
v_add_f32 v28, v28, v53
v_mfma_f32_32x32x16_bf16 v[128:143], a[156:159], a[20:23], v[128:143]
ds_read_b64_tr_b16 a[152:153], v16 offset:18432
ds_read_b64_tr_b16 a[154:155], v16 offset:18688
s_add_u32 s7, s7, 4096
v_mul_f32 v27, 0x3ae38e39, v27
s_waitcnt lgkmcnt(6)
s_waitcnt vmcnt(9)
v_mfma_f32_32x32x16_bf16 v[112:127], a[160:163], a[24:27], v[112:127]
ds_read_b64_tr_b16 a[156:157], v16 offset:18944
ds_read_b64_tr_b16 a[158:159], v16 offset:19200
v_mul_f32 v28, 0x3ae38e39, v28
v_fma_f32 v28, -v27, v27, v28
v_max_f32 v28, 0, v28
v_mfma_f32_32x32x16_bf16 v[128:143], a[164:167], a[24:27], v[128:143]
ds_read_b64_tr_b16 a[160:161], v16 offset:20480
ds_read_b64_tr_b16 a[162:163], v16 offset:20736
buffer_load_dwordx4 a[64:67], v26, s[72:75], s7 offen offset:0 sc1
v_cvt_pk_bf16_f32 v32, v27, v27
v_and_b32 v32, 0xffff0000, v32
s_waitcnt vmcnt(9)
v_mfma_f32_32x32x16_bf16 v[112:127], a[168:171], a[28:31], v[112:127]
ds_read_b64_tr_b16 a[164:165], v16 offset:20992
ds_read_b64_tr_b16 a[166:167], v16 offset:21248
buffer_load_dwordx4 a[68:71], v26, s[72:75], s7 offen offset:1024 sc1
v_cvt_pk_bf16_f32 v33, v28, v28
v_and_b32 v33, 0xffff0000, v33
v_mfma_f32_32x32x16_bf16 v[128:143], a[172:175], a[28:31], v[128:143]
ds_read_b64_tr_b16 a[168:169], v16 offset:22528
ds_read_b64_tr_b16 a[170:171], v16 offset:22784
v_add_f32 v33, 0x3727c5ac, v33
v_cvt_pk_bf16_f32 v33, v33, v33
s_waitcnt lgkmcnt(6)
s_waitcnt vmcnt(9)
v_mfma_f32_32x32x16_bf16 v[112:127], a[144:147], a[32:35], v[112:127]
ds_read_b64_tr_b16 a[172:173], v16 offset:23040
ds_read_b64_tr_b16 a[174:175], v16 offset:23296
buffer_load_dwordx4 a[72:75], v26, s[72:75], s7 offen offset:2048 sc1
v_and_b32 v33, 0xffff0000, v33
v_sqrt_f32 v33, v33
v_mfma_f32_32x32x16_bf16 v[128:143], a[148:151], a[32:35], v[128:143]
L_slot1:
s_barrier
ds_read_b64_tr_b16 a[144:145], v16 offset:24576
ds_read_b64_tr_b16 a[146:147], v16 offset:24832
v_cvt_pk_bf16_f32 v33, v33, v33
v_and_b32 v33, 0xffff0000, v33
s_waitcnt vmcnt(9)
v_mfma_f32_32x32x16_bf16 v[112:127], a[152:155], a[36:39], v[112:127]
ds_read_b64_tr_b16 a[148:149], v16 offset:25088
ds_read_b64_tr_b16 a[150:151], v16 offset:25344
buffer_load_dwordx4 a[76:79], v26, s[72:75], s7 offen offset:3072 sc1
v_rcp_f32 v27, v33
s_nop 0
v_mul_f32 v27, 0xbeeff558, v27
v_mfma_f32_32x32x16_bf16 v[128:143], a[156:159], a[36:39], v[128:143]
ds_read_b64_tr_b16 a[152:153], v16 offset:26624
ds_read_b64_tr_b16 a[154:155], v16 offset:26880
buffer_load_dwordx4 v1, s[56:59], s32 offen offset:0 lds
s_add_u32 s7, s7, 4096
s_waitcnt lgkmcnt(6)
s_waitcnt vmcnt(10)
v_mfma_f32_32x32x16_bf16 v[112:127], a[160:163], a[40:43], v[112:127]
ds_read_b64_tr_b16 a[156:157], v16 offset:27136
ds_read_b64_tr_b16 a[158:159], v16 offset:27392
s_mul_i32 s11, s5, 9
s_lshr_b32 s11, s11, 1
s_lshl_b32 s11, s11, 7
s_add_u32 s11, s11, 3997696
v_mfma_f32_32x32x16_bf16 v[128:143], a[164:167], a[40:43], v[128:143]
ds_read_b64_tr_b16 a[160:161], v16 offset:28672
ds_read_b64_tr_b16 a[162:163], v16 offset:28928
buffer_load_dwordx4 a[80:83], v26, s[72:75], s7 offen offset:0 sc1
v_min_u32 v40, 4, v0
v_lshlrev_b32 v40, 7, v40
s_waitcnt vmcnt(10)
v_mfma_f32_32x32x16_bf16 v[112:127], a[168:171], a[44:47], v[112:127]
ds_read_b64_tr_b16 a[164:165], v16 offset:29184
ds_read_b64_tr_b16 a[166:167], v16 offset:29440
buffer_load_dwordx4 a[84:87], v26, s[72:75], s7 offen offset:1024 sc1
v_mov_b32 v43, 4
v_mul_f32 v28, v32, v27
v_mfma_f32_32x32x16_bf16 v[128:143], a[172:175], a[44:47], v[128:143]
ds_read_b64_tr_b16 a[168:169], v16 offset:30720
ds_read_b64_tr_b16 a[170:171], v16 offset:30976
buffer_load_dwordx4 v2, s[56:59], s32 offen offset:1024 lds
v_sub_f32 v28, 0, v28
v_rcp_f32 v29, v29
s_waitcnt lgkmcnt(6)
s_waitcnt vmcnt(11)
v_mfma_f32_32x32x16_bf16 v[112:127], a[144:147], a[48:51], v[112:127]
ds_read_b64_tr_b16 a[172:173], v16 offset:31232
ds_read_b64_tr_b16 a[174:175], v16 offset:31488
buffer_load_dwordx4 a[88:91], v26, s[72:75], s7 offen offset:2048 sc1
buffer_load_dword v42, v43, s[80:83], 0 offen sc1
buffer_load_dword v41, v40, s[76:79], s11 offen sc1
v_min_f32 v29, 0x7149f2ca, v29
v_mfma_f32_32x32x16_bf16 v[128:143], a[148:151], a[48:51], v[128:143]
ds_read_b64_tr_b16 a[144:145], v16 offset:32768
ds_read_b64_tr_b16 a[146:147], v16 offset:33024
buffer_load_dwordx4 v3, s[56:59], s32 offen offset:2048 lds
v_mul_f32 v29, 0xbeeff558, v29
v_sub_f32 v32, 0, v32
s_waitcnt vmcnt(14)
v_mfma_f32_32x32x16_bf16 v[112:127], a[152:155], a[52:55], v[112:127]
ds_read_b64_tr_b16 a[148:149], v16 offset:33280
ds_read_b64_tr_b16 a[150:151], v16 offset:33536
buffer_load_dwordx4 a[92:95], v26, s[72:75], s7 offen offset:3072 sc1
v_cvt_pk_bf16_f32 v32, v32, v32
v_cndmask_b32 v32, 0, v32, s[84:85]
v_accvgpr_write_b32 a212, v32
v_accvgpr_write_b32 a217, v32
v_mfma_f32_32x32x16_bf16 v[128:143], a[156:159], a[52:55], v[128:143]
ds_read_b64_tr_b16 a[152:153], v16 offset:34816
ds_read_b64_tr_b16 a[154:155], v16 offset:35072
buffer_load_dwordx4 v4, s[56:59], s32 offen offset:3072 lds
s_add_u32 s7, s7, 4096
s_add_u32 m0, s29, 53248
v_accvgpr_write_b32 a213, 0
s_waitcnt lgkmcnt(6)
s_waitcnt vmcnt(15)
v_mfma_f32_32x32x16_bf16 v[112:127], a[160:163], a[56:59], v[112:127]
ds_read_b64_tr_b16 a[156:157], v16 offset:35328
ds_read_b64_tr_b16 a[158:159], v16 offset:35584
buffer_load_dwordx4 v5, s[56:59], s32 offen offset:0 lds
v_accvgpr_write_b32 a214, 0
v_accvgpr_write_b32 a215, 0
v_accvgpr_write_b32 a216, 0
v_accvgpr_write_b32 a218, 0
v_accvgpr_write_b32 a219, 0
v_accvgpr_write_b32 a209, 0
v_accvgpr_write_b32 a210, 0
v_accvgpr_write_b32 a211, 0
v_mfma_f32_32x32x16_bf16 v[128:143], a[164:167], a[56:59], v[128:143]
ds_read_b64_tr_b16 a[160:161], v16 offset:36864
ds_read_b64_tr_b16 a[162:163], v16 offset:37120
buffer_load_dwordx4 a[96:99], v26, s[72:75], s7 offen offset:0 sc1
s_waitcnt vmcnt(16)
v_mfma_f32_32x32x16_bf16 v[112:127], a[168:171], a[60:63], v[112:127]
ds_read_b64_tr_b16 a[164:165], v16 offset:37376
ds_read_b64_tr_b16 a[166:167], v16 offset:37632
buffer_load_dwordx4 a[100:103], v26, s[72:75], s7 offen offset:1024 sc1
buffer_load_dwordx4 v6, s[56:59], s32 offen offset:1024 lds
v_mfma_f32_32x32x16_bf16 v[128:143], a[172:175], a[60:63], v[128:143]
ds_read_b64_tr_b16 a[168:169], v16 offset:38912
ds_read_b64_tr_b16 a[170:171], v16 offset:39168
s_waitcnt lgkmcnt(6)
s_waitcnt vmcnt(17)
v_mfma_f32_32x32x16_bf16 v[112:127], a[144:147], a[64:67], v[112:127]
ds_read_b64_tr_b16 a[172:173], v16 offset:39424
ds_read_b64_tr_b16 a[174:175], v16 offset:39680
buffer_load_dwordx4 a[104:107], v26, s[72:75], s7 offen offset:2048 sc1
v_mfma_f32_32x32x16_bf16 v[128:143], a[148:151], a[64:67], v[128:143]
ds_read_b64_tr_b16 a[144:145], v16 offset:40960
ds_read_b64_tr_b16 a[146:147], v16 offset:41216
s_waitcnt vmcnt(17)
v_mfma_f32_32x32x16_bf16 v[112:127], a[152:155], a[68:71], v[112:127]
ds_read_b64_tr_b16 a[148:149], v16 offset:41472
ds_read_b64_tr_b16 a[150:151], v16 offset:41728
buffer_load_dwordx4 a[108:111], v26, s[72:75], s7 offen offset:3072 sc1
s_add_u32 s32, s16, 128
s_add_u32 m0, s29, 73728
v_mfma_f32_32x32x16_bf16 v[128:143], a[156:159], a[68:71], v[128:143]
ds_read_b64_tr_b16 a[152:153], v16 offset:43008
ds_read_b64_tr_b16 a[154:155], v16 offset:43264
s_add_u32 s7, s7, 4096
s_waitcnt lgkmcnt(6)
s_waitcnt vmcnt(17)
v_mfma_f32_32x32x16_bf16 v[112:127], a[160:163], a[72:75], v[112:127]
ds_read_b64_tr_b16 a[156:157], v16 offset:43520
ds_read_b64_tr_b16 a[158:159], v16 offset:43776
v_mfma_f32_32x32x16_bf16 v[128:143], a[164:167], a[72:75], v[128:143]
ds_read_b64_tr_b16 a[160:161], v16 offset:45056
ds_read_b64_tr_b16 a[162:163], v16 offset:45312
buffer_load_dwordx4 a[112:115], v26, s[72:75], s7 offen offset:0 sc1
s_waitcnt vmcnt(17)
v_mfma_f32_32x32x16_bf16 v[112:127], a[168:171], a[76:79], v[112:127]
ds_read_b64_tr_b16 a[164:165], v16 offset:45568
ds_read_b64_tr_b16 a[166:167], v16 offset:45824
v_mfma_f32_32x32x16_bf16 v[128:143], a[172:175], a[76:79], v[128:143]
ds_read_b64_tr_b16 a[168:169], v16 offset:47104
ds_read_b64_tr_b16 a[170:171], v16 offset:47360
buffer_load_dwordx4 a[116:119], v26, s[72:75], s7 offen offset:1024 sc1
s_waitcnt lgkmcnt(6)
s_waitcnt vmcnt(16)
v_mfma_f32_32x32x16_bf16 v[112:127], a[144:147], a[80:83], v[112:127]
ds_read_b64_tr_b16 a[172:173], v16 offset:47616
ds_read_b64_tr_b16 a[174:175], v16 offset:47872
buffer_load_dwordx4 a[120:123], v26, s[72:75], s7 offen offset:2048 sc1
v_mfma_f32_32x32x16_bf16 v[128:143], a[148:151], a[80:83], v[128:143]
L_slot2:
s_waitcnt vmcnt(5)
s_barrier
ds_read_b64_tr_b16 a[144:145], v17 offset:0
ds_read_b64_tr_b16 a[146:147], v17 offset:256
v_mfma_f32_32x32x16_bf16 v[112:127], a[152:155], a[84:87], v[112:127]
ds_read_b64_tr_b16 a[148:149], v17 offset:512
ds_read_b64_tr_b16 a[150:151], v17 offset:768
buffer_load_dwordx4 a[124:127], v26, s[72:75], s7 offen offset:3072 sc1
v_mfma_f32_32x32x16_bf16 v[128:143], a[156:159], a[84:87], v[128:143]
ds_read_b64_tr_b16 a[152:153], v17 offset:2048
ds_read_b64_tr_b16 a[154:155], v17 offset:2304
s_add_u32 s7, s7, 4096
s_waitcnt lgkmcnt(6)
v_mfma_f32_32x32x16_bf16 v[112:127], a[160:163], a[88:91], v[112:127]
ds_read_b64_tr_b16 a[156:157], v17 offset:2560
ds_read_b64_tr_b16 a[158:159], v17 offset:2816
v_cmp_eq_u32 s[86:87], 0, v42
s_nop 1
v_cndmask_b32 v41, v41, v42, s[86:87]
v_max_u32 v42, 1, v42
v_cmp_ne_u32 vcc, v42, v41
s_cbranch_vccz L_csok_12
s_mov_b32 s94, 0
L_csspin_13:
buffer_load_dword v42, v43, s[80:83], 0 offen sc1
buffer_load_dword v41, v40, s[76:79], s11 offen sc1
s_waitcnt vmcnt(0)
v_cmp_eq_u32 s[86:87], 0, v42
s_nop 1
v_cndmask_b32 v41, v41, v42, s[86:87]
v_max_u32 v42, 1, v42
v_cmp_ne_u32 vcc, v42, v41
s_cbranch_vccz L_csok_12
s_add_u32 s94, s94, 1
s_cmp_lt_u32 s94, 262144
s_sleep 1
s_cbranch_scc1 L_csspin_13
v_mov_b32 v41, 108
buffer_store_dword v41, v253, s[80:83], 0 offen
s_waitcnt vmcnt(0)
L_csok_12:
v_mfma_f32_32x32x16_bf16 v[128:143], a[164:167], a[88:91], v[128:143]
ds_read_b64_tr_b16 a[160:161], v17 offset:4096
ds_read_b64_tr_b16 a[162:163], v17 offset:4352
buffer_load_dwordx4 a[128:131], v26, s[72:75], s7 offen offset:0 sc1
v_mfma_f32_32x32x16_bf16 v[112:127], a[168:171], a[92:95], v[112:127]
ds_read_b64_tr_b16 a[164:165], v17 offset:4608
ds_read_b64_tr_b16 a[166:167], v17 offset:4864
buffer_load_dwordx4 v1, s[56:59], s32 offen offset:0 lds
v_mfma_f32_32x32x16_bf16 v[128:143], a[172:175], a[92:95], v[128:143]
ds_read_b64_tr_b16 a[168:169], v17 offset:6144
ds_read_b64_tr_b16 a[170:171], v17 offset:6400
buffer_load_dwordx4 a[132:135], v26, s[72:75], s7 offen offset:1024 sc1
s_waitcnt lgkmcnt(6)
v_mfma_f32_32x32x16_bf16 v[112:127], a[144:147], a[96:99], v[112:127]
ds_read_b64_tr_b16 a[172:173], v17 offset:6656
ds_read_b64_tr_b16 a[174:175], v17 offset:6912
buffer_load_dwordx4 a[136:139], v26, s[72:75], s7 offen offset:2048 sc1
v_mfma_f32_32x32x16_bf16 v[128:143], a[148:151], a[96:99], v[128:143]
ds_read_b64_tr_b16 a[144:145], v17 offset:8192
ds_read_b64_tr_b16 a[146:147], v17 offset:8448
buffer_load_dwordx4 v2, s[56:59], s32 offen offset:1024 lds
v_mfma_f32_32x32x16_bf16 v[112:127], a[152:155], a[100:103], v[112:127]
ds_read_b64_tr_b16 a[148:149], v17 offset:8704
ds_read_b64_tr_b16 a[150:151], v17 offset:8960
buffer_load_dwordx4 a[140:143], v26, s[72:75], s7 offen offset:3072 sc1
s_mov_b32 s95, s51
v_mfma_f32_32x32x16_bf16 v[128:143], a[156:159], a[100:103], v[128:143]
ds_read_b64_tr_b16 a[152:153], v17 offset:10240
ds_read_b64_tr_b16 a[154:155], v17 offset:10496
buffer_load_dwordx4 v3, s[56:59], s32 offen offset:2048 lds
s_waitcnt lgkmcnt(6)
s_waitcnt vmcnt(12)
v_mfma_f32_32x32x16_bf16 v[112:127], a[160:163], a[104:107], v[112:127]
ds_read_b64_tr_b16 a[156:157], v17 offset:10752
ds_read_b64_tr_b16 a[158:159], v17 offset:11008
buffer_load_dwordx4 v4, s[56:59], s32 offen offset:3072 lds
s_add_u32 m0, s29, 77824
v_mfma_f32_32x32x16_bf16 v[128:143], a[164:167], a[104:107], v[128:143]
ds_read_b64_tr_b16 a[160:161], v17 offset:12288
ds_read_b64_tr_b16 a[162:163], v17 offset:12544
buffer_load_dwordx4 v5, s[56:59], s32 offen offset:0 lds
s_waitcnt vmcnt(13)
v_mfma_f32_32x32x16_bf16 v[112:127], a[168:171], a[108:111], v[112:127]
ds_read_b64_tr_b16 a[164:165], v17 offset:12800
ds_read_b64_tr_b16 a[166:167], v17 offset:13056
s_mul_i32 s98, s5, 1152
s_lshl_b32 s99, s91, 7
s_add_u32 s99, s99, s98
s_add_u32 s99, s99, 4063232
v_mfma_f32_32x32x16_bf16 v[128:143], a[172:175], a[108:111], v[128:143]
ds_read_b64_tr_b16 a[168:169], v17 offset:14336
ds_read_b64_tr_b16 a[170:171], v17 offset:14592
buffer_load_dwordx4 v6, s[56:59], s32 offen offset:1024 lds
s_waitcnt lgkmcnt(6)
s_waitcnt vmcnt(13)
v_mfma_f32_32x32x16_bf16 v[112:127], a[144:147], a[112:115], v[112:127]
ds_read_b64_tr_b16 a[172:173], v17 offset:14848
ds_read_b64_tr_b16 a[174:175], v17 offset:15104
s_xor_b32 s100, s91, 1
s_lshl_b32 s100, s100, 10
s_add_u32 s100, s100, s98
s_add_u32 s100, s100, 4063232
v_lshrrev_b32 v176, 1, v176
v_mfma_f32_32x32x16_bf16 v[128:143], a[148:151], a[112:115], v[128:143]
ds_read_b64_tr_b16 a[144:145], v17 offset:16384
ds_read_b64_tr_b16 a[146:147], v17 offset:16640
buffer_load_dword a200, v176, s[76:79], s99 offen offset:0 sc1
s_waitcnt vmcnt(13)
v_mfma_f32_32x32x16_bf16 v[112:127], a[152:155], a[116:119], v[112:127]
ds_read_b64_tr_b16 a[148:149], v17 offset:16896
ds_read_b64_tr_b16 a[150:151], v17 offset:17152
buffer_load_dword a201, v176, s[76:79], s99 offen offset:128 sc1
buffer_load_dword a202, v176, s[76:79], s99 offen offset:256 sc1
buffer_load_dword a203, v176, s[76:79], s99 offen offset:384 sc1
buffer_load_dword a204, v176, s[76:79], s99 offen offset:512 sc1
buffer_load_dword a205, v176, s[76:79], s99 offen offset:640 sc1
buffer_load_dword a206, v176, s[76:79], s99 offen offset:768 sc1
buffer_load_dword a207, v176, s[76:79], s99 offen offset:896 sc1
buffer_load_dword a208, v176, s[76:79], s100 offen offset:0 sc1
v_mfma_f32_32x32x16_bf16 v[128:143], a[156:159], a[116:119], v[128:143]
ds_read_b64_tr_b16 a[152:153], v17 offset:18432
ds_read_b64_tr_b16 a[154:155], v17 offset:18688
s_waitcnt lgkmcnt(6)
s_waitcnt vmcnt(20)
v_mfma_f32_32x32x16_bf16 v[112:127], a[160:163], a[120:123], v[112:127]
ds_read_b64_tr_b16 a[156:157], v17 offset:18944
ds_read_b64_tr_b16 a[158:159], v17 offset:19200
s_add_u32 s32, s16, 1769600
s_add_u32 m0, s29, 98304
v_mfma_f32_32x32x16_bf16 v[128:143], a[164:167], a[120:123], v[128:143]
ds_read_b64_tr_b16 a[160:161], v17 offset:20480
ds_read_b64_tr_b16 a[162:163], v17 offset:20736
buffer_load_dwordx4 v1, s[56:59], s32 offen offset:0 lds
s_waitcnt vmcnt(20)
v_mfma_f32_32x32x16_bf16 v[112:127], a[168:171], a[124:127], v[112:127]
ds_read_b64_tr_b16 a[164:165], v17 offset:20992
ds_read_b64_tr_b16 a[166:167], v17 offset:21248
v_mfma_f32_32x32x16_bf16 v[128:143], a[172:175], a[124:127], v[128:143]
ds_read_b64_tr_b16 a[168:169], v17 offset:22528
ds_read_b64_tr_b16 a[170:171], v17 offset:22784
buffer_load_dwordx4 v2, s[56:59], s32 offen offset:1024 lds
s_waitcnt lgkmcnt(6)
s_waitcnt vmcnt(20)
v_mfma_f32_32x32x16_bf16 v[112:127], a[144:147], a[128:131], v[112:127]
ds_read_b64_tr_b16 a[172:173], v17 offset:23040
ds_read_b64_tr_b16 a[174:175], v17 offset:23296
v_mfma_f32_32x32x16_bf16 v[128:143], a[148:151], a[128:131], v[128:143]
L_slot3:
s_waitcnt vmcnt(11)
s_barrier
ds_read_b64_tr_b16 a[144:145], v17 offset:24576
ds_read_b64_tr_b16 a[146:147], v17 offset:24832
buffer_load_dwordx4 v3, s[56:59], s32 offen offset:2048 lds
v_mfma_f32_32x32x16_bf16 v[112:127], a[152:155], a[132:135], v[112:127]
ds_read_b64_tr_b16 a[148:149], v17 offset:25088
ds_read_b64_tr_b16 a[150:151], v17 offset:25344
buffer_load_dwordx4 a[176:179], v26, s[72:75], s95 offen sc1
v_mfma_f32_32x32x16_bf16 v[128:143], a[156:159], a[132:135], v[128:143]
ds_read_b64_tr_b16 a[152:153], v17 offset:26624
ds_read_b64_tr_b16 a[154:155], v17 offset:26880
buffer_load_dwordx4 v4, s[56:59], s32 offen offset:3072 lds
s_waitcnt lgkmcnt(6)
v_mfma_f32_32x32x16_bf16 v[112:127], a[160:163], a[136:139], v[112:127]
ds_read_b64_tr_b16 a[156:157], v17 offset:27136
ds_read_b64_tr_b16 a[158:159], v17 offset:27392
buffer_load_dwordx4 a[180:183], v26, s[72:75], s95 offen offset:1024 sc1
s_add_u32 m0, s29, 102400
v_mfma_f32_32x32x16_bf16 v[128:143], a[164:167], a[136:139], v[128:143]
ds_read_b64_tr_b16 a[160:161], v17 offset:28672
ds_read_b64_tr_b16 a[162:163], v17 offset:28928
buffer_load_dwordx4 v5, s[56:59], s32 offen offset:0 lds
v_mfma_f32_32x32x16_bf16 v[112:127], a[168:171], a[140:143], v[112:127]
ds_read_b64_tr_b16 a[164:165], v17 offset:29184
ds_read_b64_tr_b16 a[166:167], v17 offset:29440
buffer_load_dwordx2 a[192:193], v30, s[72:75], s95 offen offset:2048 sc1
v_mfma_f32_32x32x16_bf16 v[128:143], a[172:175], a[140:143], v[128:143]
s_waitcnt vmcnt(13)
v_mfma_f32_32x32x16_bf16 v[112:127], a[200:203], a[212:215], v[112:127]
v_mfma_f32_32x32x16_bf16 v[128:143], a[200:203], a[216:219], v[128:143]
ds_read_b64_tr_b16 a[168:169], v17 offset:30720
ds_read_b64_tr_b16 a[170:171], v17 offset:30976
buffer_load_dwordx4 v6, s[56:59], s32 offen offset:1024 lds
s_waitcnt lgkmcnt(6)
v_mfma_f32_32x32x16_bf16 v[144:159], a[144:147], a[0:3], 0
ds_read_b64_tr_b16 a[172:173], v17 offset:31232
ds_read_b64_tr_b16 a[174:175], v17 offset:31488
v_mfma_f32_32x32x16_bf16 v[160:175], a[148:151], a[0:3], 0
ds_read_b64_tr_b16 a[144:145], v17 offset:32768
ds_read_b64_tr_b16 a[146:147], v17 offset:33024
s_add_u32 s32, s16, 3539072
s_add_u32 m0, s29, 122880
v_mul_f32 v112, v112, v27
v_mfma_f32_32x32x16_bf16 v[144:159], a[152:155], a[4:7], v[144:159]
ds_read_b64_tr_b16 a[148:149], v17 offset:33280
ds_read_b64_tr_b16 a[150:151], v17 offset:33536
s_xor_b32 s95, s5, 1
s_sub_u32 s95, s95, s5
s_mul_i32 s95, s95, 9216
s_add_u32 s95, s95, s51
v_mfma_f32_32x32x16_bf16 v[160:175], a[156:159], a[4:7], v[160:175]
ds_read_b64_tr_b16 a[152:153], v17 offset:34816
ds_read_b64_tr_b16 a[154:155], v17 offset:35072
buffer_load_dwordx4 v1, s[56:59], s32 offen offset:0 lds
v_mul_f32 v113, v113, v27
v_mul_f32 v114, v114, v27
s_waitcnt lgkmcnt(6)
v_mfma_f32_32x32x16_bf16 v[144:159], a[160:163], a[8:11], v[144:159]
ds_read_b64_tr_b16 a[156:157], v17 offset:35328
ds_read_b64_tr_b16 a[158:159], v17 offset:35584
buffer_load_dwordx4 a[184:187], v26, s[72:75], s95 offen sc1
buffer_load_dwordx4 a[188:191], v26, s[72:75], s95 offen offset:1024 sc1
buffer_load_dwordx2 a[194:195], v30, s[72:75], s95 offen offset:2048 sc1
v_mul_f32 v115, v115, v27
v_mfma_f32_32x32x16_bf16 v[160:175], a[164:167], a[8:11], v[160:175]
ds_read_b64_tr_b16 a[160:161], v17 offset:36864
ds_read_b64_tr_b16 a[162:163], v17 offset:37120
buffer_load_dwordx4 v2, s[56:59], s32 offen offset:1024 lds
v_fmaak_f32 v32, v112, v112, 0x409d30fc
v_fmaak_f32 v33, v113, v113, 0x409d30fc
v_fmaak_f32 v34, v114, v114, 0x409d30fc
v_mfma_f32_32x32x16_bf16 v[144:159], a[168:171], a[12:15], v[144:159]
ds_read_b64_tr_b16 a[164:165], v17 offset:37376
ds_read_b64_tr_b16 a[166:167], v17 offset:37632
v_fmaak_f32 v35, v115, v115, 0x409d30fc
v_mul_f32 v32, v112, v32
v_mul_f32 v33, v113, v33
v_mfma_f32_32x32x16_bf16 v[160:175], a[172:175], a[12:15], v[160:175]
ds_read_b64_tr_b16 a[168:169], v17 offset:38912
ds_read_b64_tr_b16 a[170:171], v17 offset:39168
buffer_load_dwordx4 v3, s[56:59], s32 offen offset:2048 lds
v_mul_f32 v34, v114, v34
v_mul_f32 v35, v115, v35
v_exp_f32 v32, v32
s_waitcnt lgkmcnt(6)
v_mfma_f32_32x32x16_bf16 v[144:159], a[144:147], a[16:19], v[144:159]
ds_read_b64_tr_b16 a[172:173], v17 offset:39424
ds_read_b64_tr_b16 a[174:175], v17 offset:39680
v_exp_f32 v33, v33
v_exp_f32 v34, v34
v_exp_f32 v35, v35
v_fma_f32 v32, v32, v29, v29
v_mfma_f32_32x32x16_bf16 v[160:175], a[148:151], a[16:19], v[160:175]
ds_read_b64_tr_b16 a[144:145], v17 offset:40960
ds_read_b64_tr_b16 a[146:147], v17 offset:41216
buffer_load_dwordx4 v4, s[56:59], s32 offen offset:3072 lds
s_add_u32 m0, s29, 126976
v_fma_f32 v33, v33, v29, v29
v_mfma_f32_32x32x16_bf16 v[144:159], a[152:155], a[20:23], v[144:159]
ds_read_b64_tr_b16 a[148:149], v17 offset:41472
ds_read_b64_tr_b16 a[150:151], v17 offset:41728
v_rcp_f32 v32, v32
v_fma_f32 v34, v34, v29, v29
v_rcp_f32 v33, v33
v_fma_f32 v35, v35, v29, v29
v_mfma_f32_32x32x16_bf16 v[160:175], a[156:159], a[20:23], v[160:175]
ds_read_b64_tr_b16 a[152:153], v17 offset:43008
ds_read_b64_tr_b16 a[154:155], v17 offset:43264
buffer_load_dwordx4 v5, s[56:59], s32 offen offset:0 lds
v_rcp_f32 v34, v34
v_mul_f32 v116, v116, v27
v_rcp_f32 v35, v35
s_waitcnt lgkmcnt(6)
v_mfma_f32_32x32x16_bf16 v[144:159], a[160:163], a[24:27], v[144:159]
ds_read_b64_tr_b16 a[156:157], v17 offset:43520
ds_read_b64_tr_b16 a[158:159], v17 offset:43776
v_mul_f32 v117, v117, v27
v_mul_f32 v118, v118, v27
v_mul_f32 v119, v119, v27
v_mfma_f32_32x32x16_bf16 v[160:175], a[164:167], a[24:27], v[160:175]
ds_read_b64_tr_b16 a[160:161], v17 offset:45056
ds_read_b64_tr_b16 a[162:163], v17 offset:45312
buffer_load_dwordx4 v6, s[56:59], s32 offen offset:1024 lds
v_fmaak_f32 v104, v116, v116, 0x409d30fc
v_fmaak_f32 v105, v117, v117, 0x409d30fc
v_fmaak_f32 v106, v118, v118, 0x409d30fc
v_mfma_f32_32x32x16_bf16 v[144:159], a[168:171], a[28:31], v[144:159]
ds_read_b64_tr_b16 a[164:165], v17 offset:45568
ds_read_b64_tr_b16 a[166:167], v17 offset:45824
v_fmaak_f32 v107, v119, v119, 0x409d30fc
v_mul_f32 v104, v116, v104
v_mul_f32 v105, v117, v105
v_mul_f32 v106, v118, v106
v_mfma_f32_32x32x16_bf16 v[160:175], a[172:175], a[28:31], v[160:175]
ds_read_b64_tr_b16 a[168:169], v17 offset:47104
ds_read_b64_tr_b16 a[170:171], v17 offset:47360
s_add_u32 s32, s16, 256
s_add_u32 m0, s29, 0
v_mul_f32 v107, v119, v107
v_exp_f32 v104, v104
s_waitcnt lgkmcnt(6)
v_mfma_f32_32x32x16_bf16 v[144:159], a[144:147], a[32:35], v[144:159]
ds_read_b64_tr_b16 a[172:173], v17 offset:47616
ds_read_b64_tr_b16 a[174:175], v17 offset:47872
buffer_load_dwordx4 v1, s[56:59], s32 offen offset:0 lds
v_mul_f32 v32, v112, v32
v_exp_f32 v105, v105
v_mfma_f32_32x32x16_bf16 v[160:175], a[148:151], a[32:35], v[160:175]
L_slot4:
s_waitcnt vmcnt(10)
s_barrier
ds_read_b64_tr_b16 a[144:145], v18 offset:0
ds_read_b64_tr_b16 a[146:147], v18 offset:256
v_mul_f32 v33, v113, v33
v_mul_f32 v34, v114, v34
v_exp_f32 v106, v106
v_mul_f32 v35, v115, v35
v_mfma_f32_32x32x16_bf16 v[144:159], a[152:155], a[36:39], v[144:159]
ds_read_b64_tr_b16 a[148:149], v18 offset:512
ds_read_b64_tr_b16 a[150:151], v18 offset:768
buffer_load_dwordx4 v2, s[56:59], s32 offen offset:1024 lds
v_exp_f32 v107, v107
v_cvt_pk_bf16_f32 v40, v32, v33
v_cvt_pk_bf16_f32 v41, v34, v35
v_mfma_f32_32x32x16_bf16 v[160:175], a[156:159], a[36:39], v[160:175]
ds_read_b64_tr_b16 a[152:153], v18 offset:2048
ds_read_b64_tr_b16 a[154:155], v18 offset:2304
v_fma_f32 v104, v104, v29, v29
v_fma_f32 v105, v105, v29, v29
v_rcp_f32 v104, v104
v_fma_f32 v106, v106, v29, v29
s_waitcnt lgkmcnt(6)
v_mfma_f32_32x32x16_bf16 v[144:159], a[160:163], a[40:43], v[144:159]
ds_read_b64_tr_b16 a[156:157], v18 offset:2560
ds_read_b64_tr_b16 a[158:159], v18 offset:2816
buffer_load_dwordx4 v3, s[56:59], s32 offen offset:2048 lds
v_rcp_f32 v105, v105
v_fma_f32 v107, v107, v29, v29
v_rcp_f32 v106, v106
v_mfma_f32_32x32x16_bf16 v[160:175], a[164:167], a[40:43], v[160:175]
ds_read_b64_tr_b16 a[160:161], v18 offset:4096
ds_read_b64_tr_b16 a[162:163], v18 offset:4352
v_mul_f32 v120, v120, v27
v_rcp_f32 v107, v107
v_mul_f32 v121, v121, v27
v_mul_f32 v122, v122, v27
v_mfma_f32_32x32x16_bf16 v[144:159], a[168:171], a[44:47], v[144:159]
ds_read_b64_tr_b16 a[164:165], v18 offset:4608
ds_read_b64_tr_b16 a[166:167], v18 offset:4864
buffer_load_dwordx4 v4, s[56:59], s32 offen offset:3072 lds
s_add_u32 m0, s29, 4096
v_mul_f32 v123, v123, v27
v_fmaak_f32 v32, v120, v120, 0x409d30fc
v_mfma_f32_32x32x16_bf16 v[160:175], a[172:175], a[44:47], v[160:175]
ds_read_b64_tr_b16 a[168:169], v18 offset:6144
ds_read_b64_tr_b16 a[170:171], v18 offset:6400
v_fmaak_f32 v33, v121, v121, 0x409d30fc
v_fmaak_f32 v34, v122, v122, 0x409d30fc
v_fmaak_f32 v35, v123, v123, 0x409d30fc
v_mul_f32 v32, v120, v32
s_waitcnt lgkmcnt(6)
v_mfma_f32_32x32x16_bf16 v[144:159], a[144:147], a[48:51], v[144:159]
ds_read_b64_tr_b16 a[172:173], v18 offset:6656
ds_read_b64_tr_b16 a[174:175], v18 offset:6912
buffer_load_dwordx4 v5, s[56:59], s32 offen offset:0 lds
v_mul_f32 v33, v121, v33
v_mul_f32 v34, v122, v34
v_mul_f32 v35, v123, v35
v_mfma_f32_32x32x16_bf16 v[160:175], a[148:151], a[48:51], v[160:175]
ds_read_b64_tr_b16 a[144:145], v18 offset:8192
ds_read_b64_tr_b16 a[146:147], v18 offset:8448
v_exp_f32 v32, v32
v_mul_f32 v104, v116, v104
v_exp_f32 v33, v33
v_mul_f32 v105, v117, v105
v_mfma_f32_32x32x16_bf16 v[144:159], a[152:155], a[52:55], v[144:159]
ds_read_b64_tr_b16 a[148:149], v18 offset:8704
ds_read_b64_tr_b16 a[150:151], v18 offset:8960
buffer_load_dwordx4 v6, s[56:59], s32 offen offset:1024 lds
s_add_u32 s32, s16, 3539200
s_add_u32 m0, s29, 49152
v_mul_f32 v106, v118, v106
v_mfma_f32_32x32x16_bf16 v[160:175], a[156:159], a[52:55], v[160:175]
ds_read_b64_tr_b16 a[152:153], v18 offset:10240
ds_read_b64_tr_b16 a[154:155], v18 offset:10496
v_exp_f32 v34, v34
v_mul_f32 v107, v119, v107
v_exp_f32 v35, v35
v_cvt_pk_bf16_f32 v42, v104, v105
s_waitcnt lgkmcnt(6)
v_mfma_f32_32x32x16_bf16 v[144:159], a[160:163], a[56:59], v[144:159]
ds_read_b64_tr_b16 a[156:157], v18 offset:10752
ds_read_b64_tr_b16 a[158:159], v18 offset:11008
buffer_load_dwordx4 v1, s[56:59], s32 offen offset:0 lds
v_cvt_pk_bf16_f32 v43, v106, v107
v_fma_f32 v32, v32, v29, v29
v_fma_f32 v33, v33, v29, v29
v_rcp_f32 v32, v32
v_mfma_f32_32x32x16_bf16 v[160:175], a[164:167], a[56:59], v[160:175]
ds_read_b64_tr_b16 a[160:161], v18 offset:12288
ds_read_b64_tr_b16 a[162:163], v18 offset:12544
s_add_u32 s95, s34, 0
v_fma_f32 v34, v34, v29, v29
v_rcp_f32 v33, v33
v_fma_f32 v35, v35, v29, v29
v_mfma_f32_32x32x16_bf16 v[144:159], a[168:171], a[60:63], v[144:159]
ds_read_b64_tr_b16 a[164:165], v18 offset:12800
ds_read_b64_tr_b16 a[166:167], v18 offset:13056
buffer_load_dwordx4 v2, s[56:59], s32 offen offset:1024 lds
v_rcp_f32 v34, v34
v_mul_f32 v124, v124, v27
v_rcp_f32 v35, v35
v_mfma_f32_32x32x16_bf16 v[160:175], a[172:175], a[60:63], v[160:175]
ds_read_b64_tr_b16 a[168:169], v18 offset:14336
ds_read_b64_tr_b16 a[170:171], v18 offset:14592
v_mul_f32 v125, v125, v27
v_mul_f32 v126, v126, v27
v_mul_f32 v127, v127, v27
v_fmaak_f32 v104, v124, v124, 0x409d30fc
s_waitcnt lgkmcnt(6)
v_mfma_f32_32x32x16_bf16 v[144:159], a[144:147], a[64:67], v[144:159]
ds_read_b64_tr_b16 a[172:173], v18 offset:14848
ds_read_b64_tr_b16 a[174:175], v18 offset:15104
buffer_load_dwordx4 v3, s[56:59], s32 offen offset:2048 lds
v_fmaak_f32 v105, v125, v125, 0x409d30fc
v_fmaak_f32 v106, v126, v126, 0x409d30fc
v_fmaak_f32 v107, v127, v127, 0x409d30fc
v_mul_f32 v104, v124, v104
v_mfma_f32_32x32x16_bf16 v[160:175], a[148:151], a[64:67], v[160:175]
ds_read_b64_tr_b16 a[144:145], v18 offset:16384
ds_read_b64_tr_b16 a[146:147], v18 offset:16640
v_mul_f32 v105, v125, v105
v_mul_f32 v106, v126, v106
v_mul_f32 v107, v127, v107
v_exp_f32 v104, v104
v_mfma_f32_32x32x16_bf16 v[144:159], a[152:155], a[68:71], v[144:159]
ds_read_b64_tr_b16 a[148:149], v18 offset:16896
ds_read_b64_tr_b16 a[150:151], v18 offset:17152
buffer_load_dwordx4 v4, s[56:59], s32 offen offset:3072 lds
s_add_u32 m0, s29, 53248
v_mul_f32 v32, v120, v32
v_exp_f32 v105, v105
v_mfma_f32_32x32x16_bf16 v[160:175], a[156:159], a[68:71], v[160:175]
ds_read_b64_tr_b16 a[152:153], v18 offset:18432
ds_read_b64_tr_b16 a[154:155], v18 offset:18688
buffer_store_dwordx4 v[40:43], v26, s[72:75], s95 offen offset:0 sc1
v_mul_f32 v33, v121, v33
s_waitcnt lgkmcnt(6)
v_mfma_f32_32x32x16_bf16 v[144:159], a[160:163], a[72:75], v[144:159]
ds_read_b64_tr_b16 a[156:157], v18 offset:18944
ds_read_b64_tr_b16 a[158:159], v18 offset:19200
buffer_load_dwordx4 v5, s[56:59], s32 offen offset:0 lds
v_mul_f32 v34, v122, v34
v_exp_f32 v106, v106
v_mul_f32 v35, v123, v35
v_mfma_f32_32x32x16_bf16 v[160:175], a[164:167], a[72:75], v[160:175]
ds_read_b64_tr_b16 a[160:161], v18 offset:20480
ds_read_b64_tr_b16 a[162:163], v18 offset:20736
v_exp_f32 v107, v107
v_cvt_pk_bf16_f32 v44, v32, v33
v_cvt_pk_bf16_f32 v45, v34, v35
v_fma_f32 v104, v104, v29, v29
v_mfma_f32_32x32x16_bf16 v[144:159], a[168:171], a[76:79], v[144:159]
ds_read_b64_tr_b16 a[164:165], v18 offset:20992
ds_read_b64_tr_b16 a[166:167], v18 offset:21248
buffer_load_dwordx4 v6, s[56:59], s32 offen offset:1024 lds
s_add_u32 s32, s16, 1769728
s_add_u32 m0, s29, 24576
v_fma_f32 v105, v105, v29, v29
v_rcp_f32 v104, v104
v_mfma_f32_32x32x16_bf16 v[160:175], a[172:175], a[76:79], v[160:175]
ds_read_b64_tr_b16 a[168:169], v18 offset:22528
ds_read_b64_tr_b16 a[170:171], v18 offset:22784
buffer_load_dwordx4 v1, s[56:59], s32 offen offset:0 lds
v_fma_f32 v106, v106, v29, v29
v_rcp_f32 v105, v105
v_fma_f32 v107, v107, v29, v29
s_waitcnt lgkmcnt(6)
v_mfma_f32_32x32x16_bf16 v[144:159], a[144:147], a[80:83], v[144:159]
ds_read_b64_tr_b16 a[172:173], v18 offset:23040
ds_read_b64_tr_b16 a[174:175], v18 offset:23296
buffer_load_dwordx4 v2, s[56:59], s32 offen offset:1024 lds
buffer_load_dwordx4 v3, s[56:59], s32 offen offset:2048 lds
buffer_load_dwordx4 v4, s[56:59], s32 offen offset:3072 lds
s_add_u32 m0, s29, 28672
s_nop 0
buffer_load_dwordx4 v5, s[56:59], s32 offen offset:0 lds
buffer_load_dwordx4 v6, s[56:59], s32 offen offset:1024 lds
v_mfma_f32_32x32x16_bf16 v[160:175], a[148:151], a[80:83], v[160:175]
L_slot5:
s_waitcnt vmcnt(19)
s_barrier
ds_read_b64_tr_b16 a[144:145], v18 offset:24576
ds_read_b64_tr_b16 a[146:147], v18 offset:24832
v_rcp_f32 v106, v106
v_mul_f32 v128, v128, v27
v_rcp_f32 v107, v107
v_mul_f32 v129, v129, v27
v_mfma_f32_32x32x16_bf16 v[144:159], a[152:155], a[84:87], v[144:159]
ds_read_b64_tr_b16 a[148:149], v18 offset:25088
ds_read_b64_tr_b16 a[150:151], v18 offset:25344
s_add_u32 s32, s16, 384
s_add_u32 m0, s29, 73728
v_mul_f32 v130, v130, v27
v_mul_f32 v131, v131, v27
v_fmaak_f32 v32, v128, v128, 0x409d30fc
v_mfma_f32_32x32x16_bf16 v[160:175], a[156:159], a[84:87], v[160:175]
ds_read_b64_tr_b16 a[152:153], v18 offset:26624
ds_read_b64_tr_b16 a[154:155], v18 offset:26880
v_fmaak_f32 v33, v129, v129, 0x409d30fc
v_fmaak_f32 v34, v130, v130, 0x409d30fc
v_fmaak_f32 v35, v131, v131, 0x409d30fc
v_mul_f32 v32, v128, v32
s_waitcnt lgkmcnt(6)
v_mfma_f32_32x32x16_bf16 v[144:159], a[160:163], a[88:91], v[144:159]
ds_read_b64_tr_b16 a[156:157], v18 offset:27136
ds_read_b64_tr_b16 a[158:159], v18 offset:27392
v_mul_f32 v33, v129, v33
v_mul_f32 v34, v130, v34
v_mul_f32 v35, v131, v35
v_exp_f32 v32, v32
v_mul_f32 v104, v124, v104
v_mfma_f32_32x32x16_bf16 v[160:175], a[164:167], a[88:91], v[160:175]
ds_read_b64_tr_b16 a[160:161], v18 offset:28672
ds_read_b64_tr_b16 a[162:163], v18 offset:28928
v_exp_f32 v33, v33
v_mul_f32 v105, v125, v105
v_mul_f32 v106, v126, v106
v_exp_f32 v34, v34
v_mul_f32 v107, v127, v107
v_mfma_f32_32x32x16_bf16 v[144:159], a[168:171], a[92:95], v[144:159]
ds_read_b64_tr_b16 a[164:165], v18 offset:29184
ds_read_b64_tr_b16 a[166:167], v18 offset:29440
buffer_load_dwordx4 v1, s[56:59], s32 offen offset:0 lds
v_exp_f32 v35, v35
v_cvt_pk_bf16_f32 v46, v104, v105
v_cvt_pk_bf16_f32 v47, v106, v107
v_mfma_f32_32x32x16_bf16 v[160:175], a[172:175], a[92:95], v[160:175]
ds_read_b64_tr_b16 a[168:169], v18 offset:30720
ds_read_b64_tr_b16 a[170:171], v18 offset:30976
v_fma_f32 v32, v32, v29, v29
v_fma_f32 v33, v33, v29, v29
v_rcp_f32 v32, v32
v_fma_f32 v34, v34, v29, v29
v_rcp_f32 v33, v33
s_waitcnt lgkmcnt(6)
v_mfma_f32_32x32x16_bf16 v[144:159], a[144:147], a[96:99], v[144:159]
ds_read_b64_tr_b16 a[172:173], v18 offset:31232
ds_read_b64_tr_b16 a[174:175], v18 offset:31488
buffer_load_dwordx4 v2, s[56:59], s32 offen offset:1024 lds
v_fma_f32 v35, v35, v29, v29
v_rcp_f32 v34, v34
v_mul_f32 v132, v132, v27
v_rcp_f32 v35, v35
v_mfma_f32_32x32x16_bf16 v[160:175], a[148:151], a[96:99], v[160:175]
ds_read_b64_tr_b16 a[144:145], v18 offset:32768
ds_read_b64_tr_b16 a[146:147], v18 offset:33024
v_mul_f32 v133, v133, v27
v_mul_f32 v134, v134, v27
v_mul_f32 v135, v135, v27
v_fmaak_f32 v104, v132, v132, 0x409d30fc
v_mfma_f32_32x32x16_bf16 v[144:159], a[152:155], a[100:103], v[144:159]
ds_read_b64_tr_b16 a[148:149], v18 offset:33280
ds_read_b64_tr_b16 a[150:151], v18 offset:33536
v_fmaak_f32 v105, v133, v133, 0x409d30fc
v_fmaak_f32 v106, v134, v134, 0x409d30fc
v_fmaak_f32 v107, v135, v135, 0x409d30fc
v_mul_f32 v104, v132, v104
v_mul_f32 v105, v133, v105
v_mfma_f32_32x32x16_bf16 v[160:175], a[156:159], a[100:103], v[160:175]
ds_read_b64_tr_b16 a[152:153], v18 offset:34816
ds_read_b64_tr_b16 a[154:155], v18 offset:35072
buffer_load_dwordx4 v3, s[56:59], s32 offen offset:2048 lds
v_mul_f32 v106, v134, v106
v_mul_f32 v107, v135, v107
v_exp_f32 v104, v104
v_mul_f32 v32, v128, v32
s_waitcnt lgkmcnt(6)
v_mfma_f32_32x32x16_bf16 v[144:159], a[160:163], a[104:107], v[144:159]
ds_read_b64_tr_b16 a[156:157], v18 offset:35328
ds_read_b64_tr_b16 a[158:159], v18 offset:35584
v_exp_f32 v105, v105
v_mul_f32 v33, v129, v33
v_mul_f32 v34, v130, v34
v_exp_f32 v106, v106
v_mul_f32 v35, v131, v35
v_mfma_f32_32x32x16_bf16 v[160:175], a[164:167], a[104:107], v[160:175]
ds_read_b64_tr_b16 a[160:161], v18 offset:36864
ds_read_b64_tr_b16 a[162:163], v18 offset:37120
buffer_store_dwordx4 v[44:47], v26, s[72:75], s95 offen offset:1024 sc1
v_mfma_f32_32x32x16_bf16 v[144:159], a[168:171], a[108:111], v[144:159]
ds_read_b64_tr_b16 a[164:165], v18 offset:37376
ds_read_b64_tr_b16 a[166:167], v18 offset:37632
v_exp_f32 v107, v107
v_cvt_pk_bf16_f32 v48, v32, v33
v_cvt_pk_bf16_f32 v49, v34, v35
v_fma_f32 v104, v104, v29, v29
v_fma_f32 v105, v105, v29, v29
v_mfma_f32_32x32x16_bf16 v[160:175], a[172:175], a[108:111], v[160:175]
ds_read_b64_tr_b16 a[168:169], v18 offset:38912
ds_read_b64_tr_b16 a[170:171], v18 offset:39168
v_rcp_f32 v104, v104
v_fma_f32 v106, v106, v29, v29
v_rcp_f32 v105, v105
v_fma_f32 v107, v107, v29, v29
v_rcp_f32 v106, v106
s_waitcnt lgkmcnt(6)
v_mfma_f32_32x32x16_bf16 v[144:159], a[144:147], a[112:115], v[144:159]
ds_read_b64_tr_b16 a[172:173], v18 offset:39424
ds_read_b64_tr_b16 a[174:175], v18 offset:39680
buffer_load_dwordx4 v4, s[56:59], s32 offen offset:3072 lds
s_add_u32 m0, s29, 77824
v_mul_f32 v136, v136, v27
v_rcp_f32 v107, v107
v_mul_f32 v137, v137, v27
v_mfma_f32_32x32x16_bf16 v[160:175], a[148:151], a[112:115], v[160:175]
ds_read_b64_tr_b16 a[144:145], v18 offset:40960
ds_read_b64_tr_b16 a[146:147], v18 offset:41216
v_mul_f32 v138, v138, v27
v_mul_f32 v139, v139, v27
v_fmaak_f32 v32, v136, v136, 0x409d30fc
v_fmaak_f32 v33, v137, v137, 0x409d30fc
v_mfma_f32_32x32x16_bf16 v[144:159], a[152:155], a[116:119], v[144:159]
ds_read_b64_tr_b16 a[148:149], v18 offset:41472
ds_read_b64_tr_b16 a[150:151], v18 offset:41728
v_fmaak_f32 v34, v138, v138, 0x409d30fc
v_fmaak_f32 v35, v139, v139, 0x409d30fc
v_mul_f32 v32, v136, v32
v_mul_f32 v33, v137, v33
v_mul_f32 v34, v138, v34
v_mfma_f32_32x32x16_bf16 v[160:175], a[156:159], a[116:119], v[160:175]
ds_read_b64_tr_b16 a[152:153], v18 offset:43008
ds_read_b64_tr_b16 a[154:155], v18 offset:43264
buffer_load_dwordx4 v5, s[56:59], s32 offen offset:0 lds
v_mul_f32 v35, v139, v35
v_exp_f32 v32, v32
v_mul_f32 v104, v132, v104
v_exp_f32 v33, v33
s_waitcnt lgkmcnt(6)
v_mfma_f32_32x32x16_bf16 v[144:159], a[160:163], a[120:123], v[144:159]
ds_read_b64_tr_b16 a[156:157], v18 offset:43520
ds_read_b64_tr_b16 a[158:159], v18 offset:43776
v_mul_f32 v105, v133, v105
v_mul_f32 v106, v134, v106
v_exp_f32 v34, v34
v_mul_f32 v107, v135, v107
v_exp_f32 v35, v35
v_mfma_f32_32x32x16_bf16 v[160:175], a[164:167], a[120:123], v[160:175]
ds_read_b64_tr_b16 a[160:161], v18 offset:45056
ds_read_b64_tr_b16 a[162:163], v18 offset:45312
buffer_load_dwordx4 v6, s[56:59], s32 offen offset:1024 lds
v_cvt_pk_bf16_f32 v50, v104, v105
v_cvt_pk_bf16_f32 v51, v106, v107
v_fma_f32 v32, v32, v29, v29
v_mfma_f32_32x32x16_bf16 v[144:159], a[168:171], a[124:127], v[144:159]
ds_read_b64_tr_b16 a[164:165], v18 offset:45568
ds_read_b64_tr_b16 a[166:167], v18 offset:45824
v_fma_f32 v33, v33, v29, v29
v_rcp_f32 v32, v32
v_fma_f32 v34, v34, v29, v29
v_rcp_f32 v33, v33
v_fma_f32 v35, v35, v29, v29
v_rcp_f32 v34, v34
v_mfma_f32_32x32x16_bf16 v[160:175], a[172:175], a[124:127], v[160:175]
ds_read_b64_tr_b16 a[168:169], v18 offset:47104
ds_read_b64_tr_b16 a[170:171], v18 offset:47360
v_mul_f32 v140, v140, v27
v_rcp_f32 v35, v35
v_mul_f32 v141, v141, v27
v_mul_f32 v142, v142, v27
v_mul_f32 v143, v143, v27
s_waitcnt lgkmcnt(6)
v_mfma_f32_32x32x16_bf16 v[144:159], a[144:147], a[128:131], v[144:159]
ds_read_b64_tr_b16 a[172:173], v18 offset:47616
ds_read_b64_tr_b16 a[174:175], v18 offset:47872
buffer_store_dwordx4 v[48:51], v26, s[72:75], s95 offen offset:2048 sc1
v_fmaak_f32 v104, v140, v140, 0x409d30fc
v_mfma_f32_32x32x16_bf16 v[160:175], a[148:151], a[128:131], v[160:175]
L_slot6:
s_waitcnt vmcnt(21)
s_barrier
ds_read_b64_tr_b16 a[144:145], v16 offset:0
ds_read_b64_tr_b16 a[146:147], v16 offset:256
v_fmaak_f32 v105, v141, v141, 0x409d30fc
v_fmaak_f32 v106, v142, v142, 0x409d30fc
v_fmaak_f32 v107, v143, v143, 0x409d30fc
v_mul_f32 v104, v140, v104
v_mul_f32 v105, v141, v105
v_mfma_f32_32x32x16_bf16 v[144:159], a[152:155], a[132:135], v[144:159]
ds_read_b64_tr_b16 a[148:149], v16 offset:512
ds_read_b64_tr_b16 a[150:151], v16 offset:768
v_mul_f32 v106, v142, v106
v_mul_f32 v107, v143, v107
v_exp_f32 v104, v104
v_mul_f32 v32, v136, v32
v_exp_f32 v105, v105
v_mfma_f32_32x32x16_bf16 v[160:175], a[156:159], a[132:135], v[160:175]
ds_read_b64_tr_b16 a[152:153], v16 offset:2048
ds_read_b64_tr_b16 a[154:155], v16 offset:2304
v_mul_f32 v33, v137, v33
v_mul_f32 v34, v138, v34
v_exp_f32 v106, v106
v_mul_f32 v35, v139, v35
v_exp_f32 v107, v107
s_waitcnt lgkmcnt(6)
v_mfma_f32_32x32x16_bf16 v[144:159], a[160:163], a[136:139], v[144:159]
ds_read_b64_tr_b16 a[156:157], v16 offset:2560
ds_read_b64_tr_b16 a[158:159], v16 offset:2816
v_cvt_pk_bf16_f32 v52, v32, v33
v_cvt_pk_bf16_f32 v53, v34, v35
v_fma_f32 v104, v104, v29, v29
v_fma_f32 v105, v105, v29, v29
v_rcp_f32 v104, v104
v_fma_f32 v106, v106, v29, v29
v_mfma_f32_32x32x16_bf16 v[160:175], a[164:167], a[136:139], v[160:175]
ds_read_b64_tr_b16 a[160:161], v16 offset:4096
ds_read_b64_tr_b16 a[162:163], v16 offset:4352
v_rcp_f32 v105, v105
v_fma_f32 v107, v107, v29, v29
v_rcp_f32 v106, v106
v_rcp_f32 v107, v107
v_mul_f32 v104, v140, v104
v_mfma_f32_32x32x16_bf16 v[144:159], a[168:171], a[140:143], v[144:159]
ds_read_b64_tr_b16 a[164:165], v16 offset:4608
ds_read_b64_tr_b16 a[166:167], v16 offset:4864
v_mul_f32 v105, v141, v105
v_mul_f32 v106, v142, v106
v_mul_f32 v107, v143, v107
v_cvt_pk_bf16_f32 v54, v104, v105
v_cvt_pk_bf16_f32 v55, v106, v107
v_mfma_f32_32x32x16_bf16 v[160:175], a[172:175], a[140:143], v[160:175]
v_mfma_f32_32x32x16_bf16 v[144:159], a[202:205], a[212:215], v[144:159]
v_mfma_f32_32x32x16_bf16 v[160:175], a[202:205], a[216:219], v[160:175]
ds_read_b64_tr_b16 a[168:169], v16 offset:6144
ds_read_b64_tr_b16 a[170:171], v16 offset:6400
buffer_store_dwordx4 v[52:55], v26, s[72:75], s95 offen offset:3072 sc1
s_waitcnt lgkmcnt(6)
v_mfma_f32_32x32x16_bf16 v[112:127], a[144:147], a[0:3], 0
ds_read_b64_tr_b16 a[172:173], v16 offset:6656
ds_read_b64_tr_b16 a[174:175], v16 offset:6912
s_add_u32 s32, s16, 1769856
s_add_u32 m0, s29, 98304
v_mfma_f32_32x32x16_bf16 v[128:143], a[148:151], a[0:3], 0
ds_read_b64_tr_b16 a[144:145], v16 offset:8192
ds_read_b64_tr_b16 a[146:147], v16 offset:8448
buffer_load_dwordx4 v1, s[56:59], s32 offen offset:0 lds
v_mul_f32 v144, v144, v27
v_mul_f32 v145, v145, v27
v_mfma_f32_32x32x16_bf16 v[112:127], a[152:155], a[4:7], v[112:127]
ds_read_b64_tr_b16 a[148:149], v16 offset:8704
ds_read_b64_tr_b16 a[150:151], v16 offset:8960
v_mul_f32 v146, v146, v27
v_mul_f32 v147, v147, v27
v_fmaak_f32 v32, v144, v144, 0x409d30fc
v_fmaak_f32 v33, v145, v145, 0x409d30fc
v_mfma_f32_32x32x16_bf16 v[128:143], a[156:159], a[4:7], v[128:143]
ds_read_b64_tr_b16 a[152:153], v16 offset:10240
ds_read_b64_tr_b16 a[154:155], v16 offset:10496
v_fmaak_f32 v34, v146, v146, 0x409d30fc
v_fmaak_f32 v35, v147, v147, 0x409d30fc
v_mul_f32 v32, v144, v32
s_waitcnt lgkmcnt(6)
v_mfma_f32_32x32x16_bf16 v[112:127], a[160:163], a[8:11], v[112:127]
ds_read_b64_tr_b16 a[156:157], v16 offset:10752
ds_read_b64_tr_b16 a[158:159], v16 offset:11008
buffer_load_dwordx4 v2, s[56:59], s32 offen offset:1024 lds
v_mul_f32 v33, v145, v33
v_mul_f32 v34, v146, v34
v_mul_f32 v35, v147, v35
v_mfma_f32_32x32x16_bf16 v[128:143], a[164:167], a[8:11], v[128:143]
ds_read_b64_tr_b16 a[160:161], v16 offset:12288
ds_read_b64_tr_b16 a[162:163], v16 offset:12544
v_exp_f32 v32, v32
v_exp_f32 v33, v33
v_exp_f32 v34, v34
v_mfma_f32_32x32x16_bf16 v[112:127], a[168:171], a[12:15], v[112:127]
ds_read_b64_tr_b16 a[164:165], v16 offset:12800
ds_read_b64_tr_b16 a[166:167], v16 offset:13056
v_exp_f32 v35, v35
v_fma_f32 v32, v32, v29, v29
v_fma_f32 v33, v33, v29, v29
v_rcp_f32 v32, v32
v_mfma_f32_32x32x16_bf16 v[128:143], a[172:175], a[12:15], v[128:143]
ds_read_b64_tr_b16 a[168:169], v16 offset:14336
ds_read_b64_tr_b16 a[170:171], v16 offset:14592
buffer_load_dwordx4 v3, s[56:59], s32 offen offset:2048 lds
v_fma_f32 v34, v34, v29, v29
v_rcp_f32 v33, v33
s_waitcnt lgkmcnt(6)
v_mfma_f32_32x32x16_bf16 v[112:127], a[144:147], a[16:19], v[112:127]
ds_read_b64_tr_b16 a[172:173], v16 offset:14848
ds_read_b64_tr_b16 a[174:175], v16 offset:15104
v_fma_f32 v35, v35, v29, v29
v_rcp_f32 v34, v34
v_mul_f32 v148, v148, v27
v_rcp_f32 v35, v35
v_mfma_f32_32x32x16_bf16 v[128:143], a[148:151], a[16:19], v[128:143]
ds_read_b64_tr_b16 a[144:145], v16 offset:16384
ds_read_b64_tr_b16 a[146:147], v16 offset:16640
buffer_load_dwordx4 v4, s[56:59], s32 offen offset:3072 lds
s_add_u32 m0, s29, 102400
v_mul_f32 v149, v149, v27
v_mfma_f32_32x32x16_bf16 v[112:127], a[152:155], a[20:23], v[112:127]
ds_read_b64_tr_b16 a[148:149], v16 offset:16896
ds_read_b64_tr_b16 a[150:151], v16 offset:17152
v_mul_f32 v150, v150, v27
v_mul_f32 v151, v151, v27
v_fmaak_f32 v104, v148, v148, 0x409d30fc
v_fmaak_f32 v105, v149, v149, 0x409d30fc
v_mfma_f32_32x32x16_bf16 v[128:143], a[156:159], a[20:23], v[128:143]
ds_read_b64_tr_b16 a[152:153], v16 offset:18432
ds_read_b64_tr_b16 a[154:155], v16 offset:18688
v_fmaak_f32 v106, v150, v150, 0x409d30fc
v_fmaak_f32 v107, v151, v151, 0x409d30fc
v_mul_f32 v104, v148, v104
s_waitcnt lgkmcnt(6)
v_mfma_f32_32x32x16_bf16 v[112:127], a[160:163], a[24:27], v[112:127]
ds_read_b64_tr_b16 a[156:157], v16 offset:18944
ds_read_b64_tr_b16 a[158:159], v16 offset:19200
buffer_load_dwordx4 v5, s[56:59], s32 offen offset:0 lds
v_mul_f32 v105, v149, v105
v_mul_f32 v106, v150, v106
v_mul_f32 v107, v151, v107
v_mfma_f32_32x32x16_bf16 v[128:143], a[164:167], a[24:27], v[128:143]
ds_read_b64_tr_b16 a[160:161], v16 offset:20480
ds_read_b64_tr_b16 a[162:163], v16 offset:20736
v_exp_f32 v104, v104
v_mul_f32 v32, v144, v32
v_exp_f32 v105, v105
v_mfma_f32_32x32x16_bf16 v[112:127], a[168:171], a[28:31], v[112:127]
ds_read_b64_tr_b16 a[164:165], v16 offset:20992
ds_read_b64_tr_b16 a[166:167], v16 offset:21248
buffer_load_dwordx4 v6, s[56:59], s32 offen offset:1024 lds
v_mul_f32 v33, v145, v33
v_mul_f32 v34, v146, v34
v_exp_f32 v106, v106
v_mfma_f32_32x32x16_bf16 v[128:143], a[172:175], a[28:31], v[128:143]
ds_read_b64_tr_b16 a[168:169], v16 offset:22528
ds_read_b64_tr_b16 a[170:171], v16 offset:22784
v_mul_f32 v35, v147, v35
v_exp_f32 v107, v107
v_cvt_pk_bf16_f32 v56, v32, v33
v_cvt_pk_bf16_f32 v57, v34, v35
s_waitcnt lgkmcnt(6)
v_mfma_f32_32x32x16_bf16 v[112:127], a[144:147], a[32:35], v[112:127]
ds_read_b64_tr_b16 a[172:173], v16 offset:23040
ds_read_b64_tr_b16 a[174:175], v16 offset:23296
v_fma_f32 v104, v104, v29, v29
v_fma_f32 v105, v105, v29, v29
v_rcp_f32 v104, v104
v_mfma_f32_32x32x16_bf16 v[128:143], a[148:151], a[32:35], v[128:143]
L_slot7:
s_waitcnt vmcnt(15)
s_barrier
ds_read_b64_tr_b16 a[144:145], v16 offset:24576
ds_read_b64_tr_b16 a[146:147], v16 offset:24832
v_fma_f32 v106, v106, v29, v29
v_rcp_f32 v105, v105
v_fma_f32 v107, v107, v29, v29
v_rcp_f32 v106, v106
v_mfma_f32_32x32x16_bf16 v[112:127], a[152:155], a[36:39], v[112:127]
ds_read_b64_tr_b16 a[148:149], v16 offset:25088
ds_read_b64_tr_b16 a[150:151], v16 offset:25344
s_add_u32 s32, s16, 3539328
s_add_u32 m0, s29, 122880
v_mul_f32 v152, v152, v27
v_mfma_f32_32x32x16_bf16 v[128:143], a[156:159], a[36:39], v[128:143]
ds_read_b64_tr_b16 a[152:153], v16 offset:26624
ds_read_b64_tr_b16 a[154:155], v16 offset:26880
buffer_load_dwordx4 v1, s[56:59], s32 offen offset:0 lds
v_rcp_f32 v107, v107
v_mul_f32 v153, v153, v27
v_mul_f32 v154, v154, v27
s_waitcnt lgkmcnt(6)
v_mfma_f32_32x32x16_bf16 v[112:127], a[160:163], a[40:43], v[112:127]
ds_read_b64_tr_b16 a[156:157], v16 offset:27136
ds_read_b64_tr_b16 a[158:159], v16 offset:27392
v_mul_f32 v155, v155, v27
v_fmaak_f32 v32, v152, v152, 0x409d30fc
v_fmaak_f32 v33, v153, v153, 0x409d30fc
v_fmaak_f32 v34, v154, v154, 0x409d30fc
v_mfma_f32_32x32x16_bf16 v[128:143], a[164:167], a[40:43], v[128:143]
ds_read_b64_tr_b16 a[160:161], v16 offset:28672
ds_read_b64_tr_b16 a[162:163], v16 offset:28928
buffer_load_dwordx4 v2, s[56:59], s32 offen offset:1024 lds
v_fmaak_f32 v35, v155, v155, 0x409d30fc
v_mul_f32 v32, v152, v32
v_mfma_f32_32x32x16_bf16 v[112:127], a[168:171], a[44:47], v[112:127]
ds_read_b64_tr_b16 a[164:165], v16 offset:29184
ds_read_b64_tr_b16 a[166:167], v16 offset:29440
v_mul_f32 v33, v153, v33
v_mul_f32 v34, v154, v34
v_mul_f32 v35, v155, v35
v_exp_f32 v32, v32
v_mfma_f32_32x32x16_bf16 v[128:143], a[172:175], a[44:47], v[128:143]
ds_read_b64_tr_b16 a[168:169], v16 offset:30720
ds_read_b64_tr_b16 a[170:171], v16 offset:30976
v_mul_f32 v104, v148, v104
v_exp_f32 v33, v33
v_mul_f32 v105, v149, v105
v_mul_f32 v106, v150, v106
s_waitcnt lgkmcnt(6)
v_mfma_f32_32x32x16_bf16 v[112:127], a[144:147], a[48:51], v[112:127]
ds_read_b64_tr_b16 a[172:173], v16 offset:31232
ds_read_b64_tr_b16 a[174:175], v16 offset:31488
buffer_load_dwordx4 v3, s[56:59], s32 offen offset:2048 lds
v_exp_f32 v34, v34
v_mul_f32 v107, v151, v107
v_exp_f32 v35, v35
v_mfma_f32_32x32x16_bf16 v[128:143], a[148:151], a[48:51], v[128:143]
ds_read_b64_tr_b16 a[144:145], v16 offset:32768
ds_read_b64_tr_b16 a[146:147], v16 offset:33024
v_cvt_pk_bf16_f32 v58, v104, v105
v_cvt_pk_bf16_f32 v59, v106, v107
v_fma_f32 v32, v32, v29, v29
v_mfma_f32_32x32x16_bf16 v[112:127], a[152:155], a[52:55], v[112:127]
ds_read_b64_tr_b16 a[148:149], v16 offset:33280
ds_read_b64_tr_b16 a[150:151], v16 offset:33536
s_add_u32 s95, s34, 4096
v_fma_f32 v33, v33, v29, v29
v_rcp_f32 v32, v32
v_fma_f32 v34, v34, v29, v29
v_mfma_f32_32x32x16_bf16 v[128:143], a[156:159], a[52:55], v[128:143]
ds_read_b64_tr_b16 a[152:153], v16 offset:34816
ds_read_b64_tr_b16 a[154:155], v16 offset:35072
buffer_load_dwordx4 v4, s[56:59], s32 offen offset:3072 lds
s_add_u32 m0, s29, 126976
v_rcp_f32 v33, v33
v_fma_f32 v35, v35, v29, v29
s_waitcnt lgkmcnt(6)
v_mfma_f32_32x32x16_bf16 v[112:127], a[160:163], a[56:59], v[112:127]
ds_read_b64_tr_b16 a[156:157], v16 offset:35328
ds_read_b64_tr_b16 a[158:159], v16 offset:35584
v_rcp_f32 v34, v34
v_mul_f32 v156, v156, v27
v_rcp_f32 v35, v35
v_mul_f32 v157, v157, v27
v_mfma_f32_32x32x16_bf16 v[128:143], a[164:167], a[56:59], v[128:143]
ds_read_b64_tr_b16 a[160:161], v16 offset:36864
ds_read_b64_tr_b16 a[162:163], v16 offset:37120
buffer_store_dwordx4 v[56:59], v26, s[72:75], s95 offen offset:0 sc1
v_mfma_f32_32x32x16_bf16 v[112:127], a[168:171], a[60:63], v[112:127]
ds_read_b64_tr_b16 a[164:165], v16 offset:37376
ds_read_b64_tr_b16 a[166:167], v16 offset:37632
v_mul_f32 v158, v158, v27
v_mul_f32 v159, v159, v27
v_fmaak_f32 v104, v156, v156, 0x409d30fc
v_mfma_f32_32x32x16_bf16 v[128:143], a[172:175], a[60:63], v[128:143]
ds_read_b64_tr_b16 a[168:169], v16 offset:38912
ds_read_b64_tr_b16 a[170:171], v16 offset:39168
v_fmaak_f32 v105, v157, v157, 0x409d30fc
v_fmaak_f32 v106, v158, v158, 0x409d30fc
v_fmaak_f32 v107, v159, v159, 0x409d30fc
v_mul_f32 v104, v156, v104
s_waitcnt lgkmcnt(6)
v_mfma_f32_32x32x16_bf16 v[112:127], a[144:147], a[64:67], v[112:127]
ds_read_b64_tr_b16 a[172:173], v16 offset:39424
ds_read_b64_tr_b16 a[174:175], v16 offset:39680
buffer_load_dwordx4 v5, s[56:59], s32 offen offset:0 lds
v_mul_f32 v105, v157, v105
v_mul_f32 v106, v158, v106
v_mul_f32 v107, v159, v107
v_mfma_f32_32x32x16_bf16 v[128:143], a[148:151], a[64:67], v[128:143]
ds_read_b64_tr_b16 a[144:145], v16 offset:40960
ds_read_b64_tr_b16 a[146:147], v16 offset:41216
v_exp_f32 v104, v104
v_mul_f32 v32, v152, v32
v_exp_f32 v105, v105
v_mul_f32 v33, v153, v33
v_mfma_f32_32x32x16_bf16 v[112:127], a[152:155], a[68:71], v[112:127]
ds_read_b64_tr_b16 a[148:149], v16 offset:41472
ds_read_b64_tr_b16 a[150:151], v16 offset:41728
v_mul_f32 v34, v154, v34
v_exp_f32 v106, v106
v_mul_f32 v35, v155, v35
v_exp_f32 v107, v107
v_mfma_f32_32x32x16_bf16 v[128:143], a[156:159], a[68:71], v[128:143]
ds_read_b64_tr_b16 a[152:153], v16 offset:43008
ds_read_b64_tr_b16 a[154:155], v16 offset:43264
buffer_load_dwordx4 v6, s[56:59], s32 offen offset:1024 lds
v_cvt_pk_bf16_f32 v60, v32, v33
v_cvt_pk_bf16_f32 v61, v34, v35
s_waitcnt lgkmcnt(6)
v_mfma_f32_32x32x16_bf16 v[112:127], a[160:163], a[72:75], v[112:127]
ds_read_b64_tr_b16 a[156:157], v16 offset:43520
ds_read_b64_tr_b16 a[158:159], v16 offset:43776
v_fma_f32 v104, v104, v29, v29
v_fma_f32 v105, v105, v29, v29
v_rcp_f32 v104, v104
v_fma_f32 v106, v106, v29, v29
v_mfma_f32_32x32x16_bf16 v[128:143], a[164:167], a[72:75], v[128:143]
ds_read_b64_tr_b16 a[160:161], v16 offset:45056
ds_read_b64_tr_b16 a[162:163], v16 offset:45312
v_rcp_f32 v105, v105
v_fma_f32 v107, v107, v29, v29
v_rcp_f32 v106, v106
v_mul_f32 v160, v160, v27
v_mfma_f32_32x32x16_bf16 v[112:127], a[168:171], a[76:79], v[112:127]
ds_read_b64_tr_b16 a[164:165], v16 offset:45568
ds_read_b64_tr_b16 a[166:167], v16 offset:45824
v_rcp_f32 v107, v107
v_mul_f32 v161, v161, v27
v_mul_f32 v162, v162, v27
v_mul_f32 v163, v163, v27
v_mfma_f32_32x32x16_bf16 v[128:143], a[172:175], a[76:79], v[128:143]
ds_read_b64_tr_b16 a[168:169], v16 offset:47104
ds_read_b64_tr_b16 a[170:171], v16 offset:47360
v_fmaak_f32 v32, v160, v160, 0x409d30fc
v_fmaak_f32 v33, v161, v161, 0x409d30fc
v_fmaak_f32 v34, v162, v162, 0x409d30fc
v_fmaak_f32 v35, v163, v163, 0x409d30fc
s_waitcnt lgkmcnt(6)
v_mfma_f32_32x32x16_bf16 v[112:127], a[144:147], a[80:83], v[112:127]
ds_read_b64_tr_b16 a[172:173], v16 offset:47616
ds_read_b64_tr_b16 a[174:175], v16 offset:47872
v_mul_f32 v32, v160, v32
v_mul_f32 v33, v161, v33
v_mul_f32 v34, v162, v34
v_mfma_f32_32x32x16_bf16 v[128:143], a[148:151], a[80:83], v[128:143]
L_slot8:
s_barrier
ds_read_b64_tr_b16 a[144:145], v17 offset:0
ds_read_b64_tr_b16 a[146:147], v17 offset:256
v_mul_f32 v35, v163, v35
v_exp_f32 v32, v32
v_mul_f32 v104, v156, v104
v_exp_f32 v33, v33
v_mfma_f32_32x32x16_bf16 v[112:127], a[152:155], a[84:87], v[112:127]
ds_read_b64_tr_b16 a[148:149], v17 offset:512
ds_read_b64_tr_b16 a[150:151], v17 offset:768
s_mul_i32 s32, s3, 737280
s_add_u32 s32, s32, s17
s_add_u32 s32, s32, 0
s_mul_i32 s94, s3, 5120
s_add_u32 m0, s94, 0
v_mfma_f32_32x32x16_bf16 v[128:143], a[156:159], a[84:87], v[128:143]
ds_read_b64_tr_b16 a[152:153], v17 offset:2048
ds_read_b64_tr_b16 a[154:155], v17 offset:2304
buffer_load_dwordx4 v13, s[56:59], s32 offen lds
s_add_u32 s32, s32, 147456
s_add_u32 m0, s94, 1024
v_mul_f32 v105, v157, v105
s_waitcnt lgkmcnt(6)
v_mfma_f32_32x32x16_bf16 v[112:127], a[160:163], a[88:91], v[112:127]
ds_read_b64_tr_b16 a[156:157], v17 offset:2560
ds_read_b64_tr_b16 a[158:159], v17 offset:2816
v_mul_f32 v106, v158, v106
v_exp_f32 v34, v34
v_mul_f32 v107, v159, v107
v_exp_f32 v35, v35
v_cvt_pk_bf16_f32 v62, v104, v105
v_mfma_f32_32x32x16_bf16 v[128:143], a[164:167], a[88:91], v[128:143]
ds_read_b64_tr_b16 a[160:161], v17 offset:4096
ds_read_b64_tr_b16 a[162:163], v17 offset:4352
buffer_load_dwordx4 v13, s[56:59], s32 offen lds
s_add_u32 s32, s32, 147456
s_add_u32 m0, s94, 2048
v_cvt_pk_bf16_f32 v63, v106, v107
v_mfma_f32_32x32x16_bf16 v[112:127], a[168:171], a[92:95], v[112:127]
ds_read_b64_tr_b16 a[164:165], v17 offset:4608
ds_read_b64_tr_b16 a[166:167], v17 offset:4864
v_fma_f32 v32, v32, v29, v29
v_fma_f32 v33, v33, v29, v29
v_rcp_f32 v32, v32
v_fma_f32 v34, v34, v29, v29
v_rcp_f32 v33, v33
v_mfma_f32_32x32x16_bf16 v[128:143], a[172:175], a[92:95], v[128:143]
ds_read_b64_tr_b16 a[168:169], v17 offset:6144
ds_read_b64_tr_b16 a[170:171], v17 offset:6400
v_fma_f32 v35, v35, v29, v29
v_rcp_f32 v34, v34
v_mul_f32 v164, v164, v27
v_rcp_f32 v35, v35
s_waitcnt lgkmcnt(6)
v_mfma_f32_32x32x16_bf16 v[112:127], a[144:147], a[96:99], v[112:127]
ds_read_b64_tr_b16 a[172:173], v17 offset:6656
ds_read_b64_tr_b16 a[174:175], v17 offset:6912
buffer_store_dwordx4 v[60:63], v26, s[72:75], s95 offen offset:1024 sc1
v_mul_f32 v165, v165, v27
v_mfma_f32_32x32x16_bf16 v[128:143], a[148:151], a[96:99], v[128:143]
ds_read_b64_tr_b16 a[144:145], v17 offset:8192
ds_read_b64_tr_b16 a[146:147], v17 offset:8448
v_mul_f32 v166, v166, v27
v_mul_f32 v167, v167, v27
v_fmaak_f32 v104, v164, v164, 0x409d30fc
v_fmaak_f32 v105, v165, v165, 0x409d30fc
v_mfma_f32_32x32x16_bf16 v[112:127], a[152:155], a[100:103], v[112:127]
ds_read_b64_tr_b16 a[148:149], v17 offset:8704
ds_read_b64_tr_b16 a[150:151], v17 offset:8960
v_fmaak_f32 v106, v166, v166, 0x409d30fc
v_fmaak_f32 v107, v167, v167, 0x409d30fc
v_mul_f32 v104, v164, v104
v_mul_f32 v105, v165, v105
v_mul_f32 v106, v166, v106
v_mfma_f32_32x32x16_bf16 v[128:143], a[156:159], a[100:103], v[128:143]
ds_read_b64_tr_b16 a[152:153], v17 offset:10240
ds_read_b64_tr_b16 a[154:155], v17 offset:10496
buffer_load_dwordx4 v13, s[56:59], s32 offen lds
s_add_u32 s32, s32, 147456
s_add_u32 m0, s94, 3072
v_mul_f32 v107, v167, v107
v_exp_f32 v104, v104
s_waitcnt lgkmcnt(6)
v_mfma_f32_32x32x16_bf16 v[112:127], a[160:163], a[104:107], v[112:127]
ds_read_b64_tr_b16 a[156:157], v17 offset:10752
ds_read_b64_tr_b16 a[158:159], v17 offset:11008
v_mul_f32 v32, v160, v32
v_exp_f32 v105, v105
v_mul_f32 v33, v161, v33
v_mul_f32 v34, v162, v34
v_mfma_f32_32x32x16_bf16 v[128:143], a[164:167], a[104:107], v[128:143]
ds_read_b64_tr_b16 a[160:161], v17 offset:12288
ds_read_b64_tr_b16 a[162:163], v17 offset:12544
buffer_load_dwordx4 v13, s[56:59], s32 offen lds
s_add_u32 s32, s32, 147456
s_add_u32 m0, s94, 4096
v_exp_f32 v106, v106
v_mul_f32 v35, v163, v35
v_mfma_f32_32x32x16_bf16 v[112:127], a[168:171], a[108:111], v[112:127]
ds_read_b64_tr_b16 a[164:165], v17 offset:12800
ds_read_b64_tr_b16 a[166:167], v17 offset:13056
v_exp_f32 v107, v107
v_cvt_pk_bf16_f32 v64, v32, v33
v_cvt_pk_bf16_f32 v65, v34, v35
v_fma_f32 v104, v104, v29, v29
v_mfma_f32_32x32x16_bf16 v[128:143], a[172:175], a[108:111], v[128:143]
ds_read_b64_tr_b16 a[168:169], v17 offset:14336
ds_read_b64_tr_b16 a[170:171], v17 offset:14592
v_fma_f32 v105, v105, v29, v29
v_rcp_f32 v104, v104
v_fma_f32 v106, v106, v29, v29
v_rcp_f32 v105, v105
v_fma_f32 v107, v107, v29, v29
s_waitcnt lgkmcnt(6)
v_mfma_f32_32x32x16_bf16 v[112:127], a[144:147], a[112:115], v[112:127]
ds_read_b64_tr_b16 a[172:173], v17 offset:14848
ds_read_b64_tr_b16 a[174:175], v17 offset:15104
buffer_load_dwordx4 v13, s[56:59], s32 offen lds
v_rcp_f32 v106, v106
v_mul_f32 v168, v168, v27
v_rcp_f32 v107, v107
v_mul_f32 v169, v169, v27
v_mfma_f32_32x32x16_bf16 v[128:143], a[148:151], a[112:115], v[128:143]
ds_read_b64_tr_b16 a[144:145], v17 offset:16384
ds_read_b64_tr_b16 a[146:147], v17 offset:16640
v_mul_f32 v170, v170, v27
v_mul_f32 v171, v171, v27
v_fmaak_f32 v32, v168, v168, 0x409d30fc
v_fmaak_f32 v33, v169, v169, 0x409d30fc
v_mfma_f32_32x32x16_bf16 v[112:127], a[152:155], a[116:119], v[112:127]
ds_read_b64_tr_b16 a[148:149], v17 offset:16896
ds_read_b64_tr_b16 a[150:151], v17 offset:17152
v_fmaak_f32 v34, v170, v170, 0x409d30fc
v_fmaak_f32 v35, v171, v171, 0x409d30fc
v_mul_f32 v32, v168, v32
v_mul_f32 v33, v169, v33
v_mul_f32 v34, v170, v34
v_mfma_f32_32x32x16_bf16 v[128:143], a[156:159], a[116:119], v[128:143]
ds_read_b64_tr_b16 a[152:153], v17 offset:18432
ds_read_b64_tr_b16 a[154:155], v17 offset:18688
v_mul_f32 v35, v171, v35
v_exp_f32 v32, v32
v_mul_f32 v104, v164, v104
v_exp_f32 v33, v33
s_waitcnt lgkmcnt(6)
v_mfma_f32_32x32x16_bf16 v[112:127], a[160:163], a[120:123], v[112:127]
ds_read_b64_tr_b16 a[156:157], v17 offset:18944
ds_read_b64_tr_b16 a[158:159], v17 offset:19200
v_mul_f32 v105, v165, v105
v_mul_f32 v106, v166, v106
v_exp_f32 v34, v34
v_mul_f32 v107, v167, v107
v_exp_f32 v35, v35
v_mfma_f32_32x32x16_bf16 v[128:143], a[164:167], a[120:123], v[128:143]
ds_read_b64_tr_b16 a[160:161], v17 offset:20480
ds_read_b64_tr_b16 a[162:163], v17 offset:20736
v_cvt_pk_bf16_f32 v66, v104, v105
v_cvt_pk_bf16_f32 v67, v106, v107
v_fma_f32 v32, v32, v29, v29
v_fma_f32 v33, v33, v29, v29
v_rcp_f32 v32, v32
v_mfma_f32_32x32x16_bf16 v[112:127], a[168:171], a[124:127], v[112:127]
ds_read_b64_tr_b16 a[164:165], v17 offset:20992
ds_read_b64_tr_b16 a[166:167], v17 offset:21248
buffer_store_dwordx4 v[64:67], v26, s[72:75], s95 offen offset:2048 sc1
v_fma_f32 v34, v34, v29, v29
v_mfma_f32_32x32x16_bf16 v[128:143], a[172:175], a[124:127], v[128:143]
ds_read_b64_tr_b16 a[168:169], v17 offset:22528
ds_read_b64_tr_b16 a[170:171], v17 offset:22784
v_rcp_f32 v33, v33
v_fma_f32 v35, v35, v29, v29
v_rcp_f32 v34, v34
v_mul_f32 v172, v172, v27
v_rcp_f32 v35, v35
s_waitcnt lgkmcnt(6)
v_mfma_f32_32x32x16_bf16 v[112:127], a[144:147], a[128:131], v[112:127]
ds_read_b64_tr_b16 a[172:173], v17 offset:23040
ds_read_b64_tr_b16 a[174:175], v17 offset:23296
v_mul_f32 v173, v173, v27
v_mul_f32 v174, v174, v27
v_mul_f32 v175, v175, v27
v_fmaak_f32 v104, v172, v172, 0x409d30fc
v_fmaak_f32 v105, v173, v173, 0x409d30fc
v_mfma_f32_32x32x16_bf16 v[128:143], a[148:151], a[128:131], v[128:143]
L_slot9:
s_waitcnt vmcnt(22)
s_barrier
ds_read_b64_tr_b16 a[144:145], v17 offset:24576
ds_read_b64_tr_b16 a[146:147], v17 offset:24832
v_fmaak_f32 v106, v174, v174, 0x409d30fc
v_fmaak_f32 v107, v175, v175, 0x409d30fc
v_mul_f32 v104, v172, v104
v_mul_f32 v105, v173, v105
v_mul_f32 v106, v174, v106
v_mfma_f32_32x32x16_bf16 v[112:127], a[152:155], a[132:135], v[112:127]
ds_read_b64_tr_b16 a[148:149], v17 offset:25088
ds_read_b64_tr_b16 a[150:151], v17 offset:25344
v_mul_f32 v107, v175, v107
v_exp_f32 v104, v104
v_mul_f32 v32, v168, v32
v_exp_f32 v105, v105
v_mul_f32 v33, v169, v33
v_mfma_f32_32x32x16_bf16 v[128:143], a[156:159], a[132:135], v[128:143]
ds_read_b64_tr_b16 a[152:153], v17 offset:26624
ds_read_b64_tr_b16 a[154:155], v17 offset:26880
v_mul_f32 v34, v170, v34
v_exp_f32 v106, v106
v_mul_f32 v35, v171, v35
v_exp_f32 v107, v107
v_cvt_pk_bf16_f32 v68, v32, v33
s_waitcnt lgkmcnt(6)
v_mfma_f32_32x32x16_bf16 v[112:127], a[160:163], a[136:139], v[112:127]
ds_read_b64_tr_b16 a[156:157], v17 offset:27136
ds_read_b64_tr_b16 a[158:159], v17 offset:27392
v_cvt_pk_bf16_f32 v69, v34, v35
v_fma_f32 v104, v104, v29, v29
v_fma_f32 v105, v105, v29, v29
v_rcp_f32 v104, v104
v_fma_f32 v106, v106, v29, v29
v_mfma_f32_32x32x16_bf16 v[128:143], a[164:167], a[136:139], v[128:143]
ds_read_b64_tr_b16 a[160:161], v17 offset:28672
ds_read_b64_tr_b16 a[162:163], v17 offset:28928
v_rcp_f32 v105, v105
v_fma_f32 v107, v107, v29, v29
v_rcp_f32 v106, v106
v_rcp_f32 v107, v107
v_mul_f32 v104, v172, v104
v_mfma_f32_32x32x16_bf16 v[112:127], a[168:171], a[140:143], v[112:127]
ds_read_b64_tr_b16 a[164:165], v17 offset:29184
ds_read_b64_tr_b16 a[166:167], v17 offset:29440
v_mul_f32 v105, v173, v105
v_mul_f32 v106, v174, v106
v_mul_f32 v107, v175, v107
v_cvt_pk_bf16_f32 v70, v104, v105
v_cvt_pk_bf16_f32 v71, v106, v107
v_mfma_f32_32x32x16_bf16 v[128:143], a[172:175], a[140:143], v[128:143]
v_mfma_f32_32x32x16_bf16 v[112:127], a[204:207], a[212:215], v[112:127]
v_mfma_f32_32x32x16_bf16 v[128:143], a[204:207], a[216:219], v[128:143]
ds_read_b64_tr_b16 a[168:169], v17 offset:30720
ds_read_b64_tr_b16 a[170:171], v17 offset:30976
buffer_store_dwordx4 v[68:71], v26, s[72:75], s95 offen offset:3072 sc1
s_waitcnt lgkmcnt(6)
v_mfma_f32_32x32x16_bf16 v[144:159], a[144:147], a[0:3], 0
ds_read_b64_tr_b16 a[172:173], v17 offset:31232
ds_read_b64_tr_b16 a[174:175], v17 offset:31488
v_mfma_f32_32x32x16_bf16 v[160:175], a[148:151], a[0:3], 0
ds_read_b64_tr_b16 a[144:145], v17 offset:32768
ds_read_b64_tr_b16 a[146:147], v17 offset:33024
s_nop 0
v_mul_f32 v112, v112, v27
v_mul_f32 v113, v113, v27
v_mul_f32 v114, v114, v27
v_mfma_f32_32x32x16_bf16 v[144:159], a[152:155], a[4:7], v[144:159]
ds_read_b64_tr_b16 a[148:149], v17 offset:33280
ds_read_b64_tr_b16 a[150:151], v17 offset:33536
v_mul_f32 v115, v115, v27
v_fmaak_f32 v32, v112, v112, 0x409d30fc
v_fmaak_f32 v33, v113, v113, 0x409d30fc
v_fmaak_f32 v34, v114, v114, 0x409d30fc
v_mfma_f32_32x32x16_bf16 v[160:175], a[156:159], a[4:7], v[160:175]
ds_read_b64_tr_b16 a[152:153], v17 offset:34816
ds_read_b64_tr_b16 a[154:155], v17 offset:35072
v_fmaak_f32 v35, v115, v115, 0x409d30fc
v_mul_f32 v32, v112, v32
v_mul_f32 v33, v113, v33
s_waitcnt lgkmcnt(6)
v_mfma_f32_32x32x16_bf16 v[144:159], a[160:163], a[8:11], v[144:159]
ds_read_b64_tr_b16 a[156:157], v17 offset:35328
ds_read_b64_tr_b16 a[158:159], v17 offset:35584
v_mul_f32 v34, v114, v34
v_mul_f32 v35, v115, v35
v_exp_f32 v32, v32
v_exp_f32 v33, v33
v_mfma_f32_32x32x16_bf16 v[160:175], a[164:167], a[8:11], v[160:175]
ds_read_b64_tr_b16 a[160:161], v17 offset:36864
ds_read_b64_tr_b16 a[162:163], v17 offset:37120
v_exp_f32 v34, v34
v_exp_f32 v35, v35
v_fma_f32 v32, v32, v29, v29
v_fma_f32 v33, v33, v29, v29
v_mfma_f32_32x32x16_bf16 v[144:159], a[168:171], a[12:15], v[144:159]
ds_read_b64_tr_b16 a[164:165], v17 offset:37376
ds_read_b64_tr_b16 a[166:167], v17 offset:37632
v_rcp_f32 v32, v32
v_fma_f32 v34, v34, v29, v29
v_rcp_f32 v33, v33
v_mfma_f32_32x32x16_bf16 v[160:175], a[172:175], a[12:15], v[160:175]
ds_read_b64_tr_b16 a[168:169], v17 offset:38912
ds_read_b64_tr_b16 a[170:171], v17 offset:39168
v_fma_f32 v35, v35, v29, v29
v_rcp_f32 v34, v34
v_mul_f32 v116, v116, v27
v_rcp_f32 v35, v35
s_waitcnt lgkmcnt(6)
v_mfma_f32_32x32x16_bf16 v[144:159], a[144:147], a[16:19], v[144:159]
ds_read_b64_tr_b16 a[172:173], v17 offset:39424
ds_read_b64_tr_b16 a[174:175], v17 offset:39680
v_mul_f32 v117, v117, v27
v_mul_f32 v118, v118, v27
v_mul_f32 v119, v119, v27
v_fmaak_f32 v104, v116, v116, 0x409d30fc
v_mfma_f32_32x32x16_bf16 v[160:175], a[148:151], a[16:19], v[160:175]
ds_read_b64_tr_b16 a[144:145], v17 offset:40960
ds_read_b64_tr_b16 a[146:147], v17 offset:41216
v_fmaak_f32 v105, v117, v117, 0x409d30fc
v_fmaak_f32 v106, v118, v118, 0x409d30fc
v_fmaak_f32 v107, v119, v119, 0x409d30fc
v_mfma_f32_32x32x16_bf16 v[144:159], a[152:155], a[20:23], v[144:159]
ds_read_b64_tr_b16 a[148:149], v17 offset:41472
ds_read_b64_tr_b16 a[150:151], v17 offset:41728
v_mul_f32 v104, v116, v104
v_mul_f32 v105, v117, v105
v_mul_f32 v106, v118, v106
v_mul_f32 v107, v119, v107
v_mfma_f32_32x32x16_bf16 v[160:175], a[156:159], a[20:23], v[160:175]
ds_read_b64_tr_b16 a[152:153], v17 offset:43008
ds_read_b64_tr_b16 a[154:155], v17 offset:43264
v_exp_f32 v104, v104
v_mul_f32 v32, v112, v32
v_exp_f32 v105, v105
v_mul_f32 v33, v113, v33
s_waitcnt lgkmcnt(6)
v_mfma_f32_32x32x16_bf16 v[144:159], a[160:163], a[24:27], v[144:159]
ds_read_b64_tr_b16 a[156:157], v17 offset:43520
ds_read_b64_tr_b16 a[158:159], v17 offset:43776
v_mul_f32 v34, v114, v34
v_exp_f32 v106, v106
v_mul_f32 v35, v115, v35
v_mfma_f32_32x32x16_bf16 v[160:175], a[164:167], a[24:27], v[160:175]
ds_read_b64_tr_b16 a[160:161], v17 offset:45056
ds_read_b64_tr_b16 a[162:163], v17 offset:45312
s_mul_i32 s32, s3, 589824
s_add_u32 s32, s32, s17
s_add_u32 s32, s32, 2949120
s_mul_i32 s94, s3, 4096
s_add_u32 m0, s94, 24576
v_mfma_f32_32x32x16_bf16 v[144:159], a[168:171], a[28:31], v[144:159]
ds_read_b64_tr_b16 a[164:165], v17 offset:45568
ds_read_b64_tr_b16 a[166:167], v17 offset:45824
buffer_load_dwordx4 v13, s[56:59], s32 offen lds
s_add_u32 s32, s32, 147456
s_add_u32 m0, s94, 25600
v_exp_f32 v107, v107
v_cvt_pk_bf16_f32 v72, v32, v33
v_mfma_f32_32x32x16_bf16 v[160:175], a[172:175], a[28:31], v[160:175]
ds_read_b64_tr_b16 a[168:169], v17 offset:47104
ds_read_b64_tr_b16 a[170:171], v17 offset:47360
buffer_load_dwordx4 v13, s[56:59], s32 offen lds
s_add_u32 s32, s32, 147456
s_add_u32 m0, s94, 26624
s_nop 0
buffer_load_dwordx4 v13, s[56:59], s32 offen lds
s_add_u32 s32, s32, 147456
s_add_u32 m0, s94, 27648
s_nop 0
buffer_load_dwordx4 v13, s[56:59], s32 offen lds
s_waitcnt lgkmcnt(6)
v_mfma_f32_32x32x16_bf16 v[144:159], a[144:147], a[32:35], v[144:159]
ds_read_b64_tr_b16 a[172:173], v17 offset:47616
ds_read_b64_tr_b16 a[174:175], v17 offset:47872
v_cvt_pk_bf16_f32 v73, v34, v35
v_fma_f32 v104, v104, v29, v29
v_fma_f32 v105, v105, v29, v29
v_rcp_f32 v104, v104
v_mfma_f32_32x32x16_bf16 v[160:175], a[148:151], a[32:35], v[160:175]
L_slot10:
s_waitcnt vmcnt(19)
s_barrier
ds_read_b64_tr_b16 a[144:145], v18 offset:0
ds_read_b64_tr_b16 a[146:147], v18 offset:256
v_fma_f32 v106, v106, v29, v29
v_rcp_f32 v105, v105
v_fma_f32 v107, v107, v29, v29
v_mfma_f32_32x32x16_bf16 v[144:159], a[152:155], a[36:39], v[144:159]
ds_read_b64_tr_b16 a[148:149], v18 offset:512
ds_read_b64_tr_b16 a[150:151], v18 offset:768
s_add_u32 s32, s18, 0
s_add_u32 m0, s29, 49152
v_rcp_f32 v106, v106
v_mul_f32 v120, v120, v27
v_mfma_f32_32x32x16_bf16 v[160:175], a[156:159], a[36:39], v[160:175]
ds_read_b64_tr_b16 a[152:153], v18 offset:2048
ds_read_b64_tr_b16 a[154:155], v18 offset:2304
buffer_load_dwordx4 v7, s[60:63], s32 offen offset:0 lds
v_rcp_f32 v107, v107
v_mul_f32 v121, v121, v27
v_mul_f32 v122, v122, v27
s_waitcnt lgkmcnt(6)
v_mfma_f32_32x32x16_bf16 v[144:159], a[160:163], a[40:43], v[144:159]
ds_read_b64_tr_b16 a[156:157], v18 offset:2560
ds_read_b64_tr_b16 a[158:159], v18 offset:2816
v_mul_f32 v123, v123, v27
v_fmaak_f32 v32, v120, v120, 0x409d30fc
v_fmaak_f32 v33, v121, v121, 0x409d30fc
v_fmaak_f32 v34, v122, v122, 0x409d30fc
v_mfma_f32_32x32x16_bf16 v[160:175], a[164:167], a[40:43], v[160:175]
ds_read_b64_tr_b16 a[160:161], v18 offset:4096
ds_read_b64_tr_b16 a[162:163], v18 offset:4352
v_fmaak_f32 v35, v123, v123, 0x409d30fc
v_mul_f32 v32, v120, v32
v_mul_f32 v33, v121, v33
v_mfma_f32_32x32x16_bf16 v[144:159], a[168:171], a[44:47], v[144:159]
ds_read_b64_tr_b16 a[164:165], v18 offset:4608
ds_read_b64_tr_b16 a[166:167], v18 offset:4864
buffer_load_dwordx4 v8, s[60:63], s32 offen offset:1024 lds
v_mul_f32 v34, v122, v34
v_mul_f32 v35, v123, v35
v_exp_f32 v32, v32
v_mfma_f32_32x32x16_bf16 v[160:175], a[172:175], a[44:47], v[160:175]
ds_read_b64_tr_b16 a[168:169], v18 offset:6144
ds_read_b64_tr_b16 a[170:171], v18 offset:6400
v_mul_f32 v104, v116, v104
v_exp_f32 v33, v33
v_mul_f32 v105, v117, v105
v_mul_f32 v106, v118, v106
s_waitcnt lgkmcnt(6)
v_mfma_f32_32x32x16_bf16 v[144:159], a[144:147], a[48:51], v[144:159]
ds_read_b64_tr_b16 a[172:173], v18 offset:6656
ds_read_b64_tr_b16 a[174:175], v18 offset:6912
buffer_load_dwordx4 v9, s[60:63], s32 offen offset:2048 lds
v_exp_f32 v34, v34
v_mul_f32 v107, v119, v107
v_mfma_f32_32x32x16_bf16 v[160:175], a[148:151], a[48:51], v[160:175]
ds_read_b64_tr_b16 a[144:145], v18 offset:8192
ds_read_b64_tr_b16 a[146:147], v18 offset:8448
v_exp_f32 v35, v35
v_cvt_pk_bf16_f32 v74, v104, v105
v_cvt_pk_bf16_f32 v75, v106, v107
v_fma_f32 v32, v32, v29, v29
v_mfma_f32_32x32x16_bf16 v[144:159], a[152:155], a[52:55], v[144:159]
ds_read_b64_tr_b16 a[148:149], v18 offset:8704
ds_read_b64_tr_b16 a[150:151], v18 offset:8960
s_add_u32 s95, s34, 8192
v_fma_f32 v33, v33, v29, v29
v_rcp_f32 v32, v32
v_fma_f32 v34, v34, v29, v29
v_mfma_f32_32x32x16_bf16 v[160:175], a[156:159], a[52:55], v[160:175]
ds_read_b64_tr_b16 a[152:153], v18 offset:10240
ds_read_b64_tr_b16 a[154:155], v18 offset:10496
buffer_load_dwordx4 v10, s[60:63], s32 offen offset:3072 lds
s_add_u32 m0, s29, 53248
v_rcp_f32 v33, v33
v_fma_f32 v35, v35, v29, v29
s_waitcnt lgkmcnt(6)
v_mfma_f32_32x32x16_bf16 v[144:159], a[160:163], a[56:59], v[144:159]
ds_read_b64_tr_b16 a[156:157], v18 offset:10752
ds_read_b64_tr_b16 a[158:159], v18 offset:11008
v_rcp_f32 v34, v34
v_mul_f32 v124, v124, v27
v_rcp_f32 v35, v35
v_mul_f32 v125, v125, v27
v_mfma_f32_32x32x16_bf16 v[160:175], a[164:167], a[56:59], v[160:175]
ds_read_b64_tr_b16 a[160:161], v18 offset:12288
ds_read_b64_tr_b16 a[162:163], v18 offset:12544
v_mul_f32 v126, v126, v27
v_mul_f32 v127, v127, v27
v_fmaak_f32 v104, v124, v124, 0x409d30fc
v_mfma_f32_32x32x16_bf16 v[144:159], a[168:171], a[60:63], v[144:159]
ds_read_b64_tr_b16 a[164:165], v18 offset:12800
ds_read_b64_tr_b16 a[166:167], v18 offset:13056
buffer_store_dwordx4 v[72:75], v26, s[72:75], s95 offen offset:0 sc1
v_mfma_f32_32x32x16_bf16 v[160:175], a[172:175], a[60:63], v[160:175]
ds_read_b64_tr_b16 a[168:169], v18 offset:14336
ds_read_b64_tr_b16 a[170:171], v18 offset:14592
v_fmaak_f32 v105, v125, v125, 0x409d30fc
v_fmaak_f32 v106, v126, v126, 0x409d30fc
v_fmaak_f32 v107, v127, v127, 0x409d30fc
v_mul_f32 v104, v124, v104
s_waitcnt lgkmcnt(6)
v_mfma_f32_32x32x16_bf16 v[144:159], a[144:147], a[64:67], v[144:159]
ds_read_b64_tr_b16 a[172:173], v18 offset:14848
ds_read_b64_tr_b16 a[174:175], v18 offset:15104
buffer_load_dwordx4 v11, s[60:63], s32 offen offset:0 lds
v_mul_f32 v105, v125, v105
v_mul_f32 v106, v126, v106
v_mul_f32 v107, v127, v107
v_mfma_f32_32x32x16_bf16 v[160:175], a[148:151], a[64:67], v[160:175]
ds_read_b64_tr_b16 a[144:145], v18 offset:16384
ds_read_b64_tr_b16 a[146:147], v18 offset:16640
v_exp_f32 v104, v104
v_mul_f32 v32, v120, v32
v_exp_f32 v105, v105
v_mul_f32 v33, v121, v33
v_mfma_f32_32x32x16_bf16 v[144:159], a[152:155], a[68:71], v[144:159]
ds_read_b64_tr_b16 a[148:149], v18 offset:16896
ds_read_b64_tr_b16 a[150:151], v18 offset:17152
v_mul_f32 v34, v122, v34
v_exp_f32 v106, v106
v_mul_f32 v35, v123, v35
v_exp_f32 v107, v107
v_mfma_f32_32x32x16_bf16 v[160:175], a[156:159], a[68:71], v[160:175]
ds_read_b64_tr_b16 a[152:153], v18 offset:18432
ds_read_b64_tr_b16 a[154:155], v18 offset:18688
buffer_load_dwordx4 v12, s[60:63], s32 offen offset:1024 lds
v_cvt_pk_bf16_f32 v76, v32, v33
v_cvt_pk_bf16_f32 v77, v34, v35
s_waitcnt lgkmcnt(6)
v_mfma_f32_32x32x16_bf16 v[144:159], a[160:163], a[72:75], v[144:159]
ds_read_b64_tr_b16 a[156:157], v18 offset:18944
ds_read_b64_tr_b16 a[158:159], v18 offset:19200
v_fma_f32 v104, v104, v29, v29
v_fma_f32 v105, v105, v29, v29
v_rcp_f32 v104, v104
v_fma_f32 v106, v106, v29, v29
v_mfma_f32_32x32x16_bf16 v[160:175], a[164:167], a[72:75], v[160:175]
ds_read_b64_tr_b16 a[160:161], v18 offset:20480
ds_read_b64_tr_b16 a[162:163], v18 offset:20736
v_rcp_f32 v105, v105
v_fma_f32 v107, v107, v29, v29
v_rcp_f32 v106, v106
v_mul_f32 v128, v128, v27
v_mfma_f32_32x32x16_bf16 v[144:159], a[168:171], a[76:79], v[144:159]
ds_read_b64_tr_b16 a[164:165], v18 offset:20992
ds_read_b64_tr_b16 a[166:167], v18 offset:21248
v_rcp_f32 v107, v107
v_mul_f32 v129, v129, v27
v_mul_f32 v130, v130, v27
v_mul_f32 v131, v131, v27
v_mfma_f32_32x32x16_bf16 v[160:175], a[172:175], a[76:79], v[160:175]
ds_read_b64_tr_b16 a[168:169], v18 offset:22528
ds_read_b64_tr_b16 a[170:171], v18 offset:22784
v_fmaak_f32 v32, v128, v128, 0x409d30fc
v_fmaak_f32 v33, v129, v129, 0x409d30fc
v_fmaak_f32 v34, v130, v130, 0x409d30fc
v_fmaak_f32 v35, v131, v131, 0x409d30fc
s_waitcnt lgkmcnt(6)
v_mfma_f32_32x32x16_bf16 v[144:159], a[144:147], a[80:83], v[144:159]
ds_read_b64_tr_b16 a[172:173], v18 offset:23040
ds_read_b64_tr_b16 a[174:175], v18 offset:23296
v_mul_f32 v32, v128, v32
v_mul_f32 v33, v129, v33
v_mul_f32 v34, v130, v34
v_mfma_f32_32x32x16_bf16 v[160:175], a[148:151], a[80:83], v[160:175]
L_slot11:
s_waitcnt vmcnt(19)
s_barrier
ds_read_b64_tr_b16 a[144:145], v18 offset:24576
ds_read_b64_tr_b16 a[146:147], v18 offset:24832
v_mul_f32 v35, v131, v35
v_exp_f32 v32, v32
v_mul_f32 v104, v124, v104
v_exp_f32 v33, v33
v_mfma_f32_32x32x16_bf16 v[144:159], a[152:155], a[84:87], v[144:159]
ds_read_b64_tr_b16 a[148:149], v18 offset:25088
ds_read_b64_tr_b16 a[150:151], v18 offset:25344
s_add_u32 s32, s18, 128
s_add_u32 m0, s29, 73728
v_mul_f32 v105, v125, v105
v_mul_f32 v106, v126, v106
v_mfma_f32_32x32x16_bf16 v[160:175], a[156:159], a[84:87], v[160:175]
ds_read_b64_tr_b16 a[152:153], v18 offset:26624
ds_read_b64_tr_b16 a[154:155], v18 offset:26880
buffer_load_dwordx4 v7, s[60:63], s32 offen offset:0 lds
v_exp_f32 v34, v34
v_mul_f32 v107, v127, v107
v_exp_f32 v35, v35
v_cvt_pk_bf16_f32 v78, v104, v105
s_waitcnt lgkmcnt(6)
v_mfma_f32_32x32x16_bf16 v[144:159], a[160:163], a[88:91], v[144:159]
ds_read_b64_tr_b16 a[156:157], v18 offset:27136
ds_read_b64_tr_b16 a[158:159], v18 offset:27392
v_cvt_pk_bf16_f32 v79, v106, v107
v_fma_f32 v32, v32, v29, v29
v_fma_f32 v33, v33, v29, v29
v_rcp_f32 v32, v32
v_mfma_f32_32x32x16_bf16 v[160:175], a[164:167], a[88:91], v[160:175]
ds_read_b64_tr_b16 a[160:161], v18 offset:28672
ds_read_b64_tr_b16 a[162:163], v18 offset:28928
buffer_load_dwordx4 v8, s[60:63], s32 offen offset:1024 lds
v_fma_f32 v34, v34, v29, v29
v_rcp_f32 v33, v33
v_fma_f32 v35, v35, v29, v29
v_mfma_f32_32x32x16_bf16 v[144:159], a[168:171], a[92:95], v[144:159]
ds_read_b64_tr_b16 a[164:165], v18 offset:29184
ds_read_b64_tr_b16 a[166:167], v18 offset:29440
v_rcp_f32 v34, v34
v_mul_f32 v132, v132, v27
v_rcp_f32 v35, v35
v_mul_f32 v133, v133, v27
v_mfma_f32_32x32x16_bf16 v[160:175], a[172:175], a[92:95], v[160:175]
ds_read_b64_tr_b16 a[168:169], v18 offset:30720
ds_read_b64_tr_b16 a[170:171], v18 offset:30976
v_mul_f32 v134, v134, v27
v_mul_f32 v135, v135, v27
v_fmaak_f32 v104, v132, v132, 0x409d30fc
v_fmaak_f32 v105, v133, v133, 0x409d30fc
s_waitcnt lgkmcnt(6)
v_mfma_f32_32x32x16_bf16 v[144:159], a[144:147], a[96:99], v[144:159]
ds_read_b64_tr_b16 a[172:173], v18 offset:31232
ds_read_b64_tr_b16 a[174:175], v18 offset:31488
buffer_load_dwordx4 v9, s[60:63], s32 offen offset:2048 lds
v_fmaak_f32 v106, v134, v134, 0x409d30fc
v_fmaak_f32 v107, v135, v135, 0x409d30fc
v_mul_f32 v104, v132, v104
v_mul_f32 v105, v133, v105
v_mfma_f32_32x32x16_bf16 v[160:175], a[148:151], a[96:99], v[160:175]
ds_read_b64_tr_b16 a[144:145], v18 offset:32768
ds_read_b64_tr_b16 a[146:147], v18 offset:33024
v_mul_f32 v106, v134, v106
v_mul_f32 v107, v135, v107
v_exp_f32 v104, v104
v_mul_f32 v32, v128, v32
v_mfma_f32_32x32x16_bf16 v[144:159], a[152:155], a[100:103], v[144:159]
ds_read_b64_tr_b16 a[148:149], v18 offset:33280
ds_read_b64_tr_b16 a[150:151], v18 offset:33536
v_exp_f32 v105, v105
v_mul_f32 v33, v129, v33
v_mul_f32 v34, v130, v34
v_exp_f32 v106, v106
v_mfma_f32_32x32x16_bf16 v[160:175], a[156:159], a[100:103], v[160:175]
ds_read_b64_tr_b16 a[152:153], v18 offset:34816
ds_read_b64_tr_b16 a[154:155], v18 offset:35072
buffer_store_dwordx4 v[76:79], v26, s[72:75], s95 offen offset:1024 sc1
v_mul_f32 v35, v131, v35
s_waitcnt lgkmcnt(6)
v_mfma_f32_32x32x16_bf16 v[144:159], a[160:163], a[104:107], v[144:159]
ds_read_b64_tr_b16 a[156:157], v18 offset:35328
ds_read_b64_tr_b16 a[158:159], v18 offset:35584
v_exp_f32 v107, v107
v_cvt_pk_bf16_f32 v80, v32, v33
v_cvt_pk_bf16_f32 v81, v34, v35
v_fma_f32 v104, v104, v29, v29
v_mfma_f32_32x32x16_bf16 v[160:175], a[164:167], a[104:107], v[160:175]
ds_read_b64_tr_b16 a[160:161], v18 offset:36864
ds_read_b64_tr_b16 a[162:163], v18 offset:37120
buffer_load_dwordx4 v10, s[60:63], s32 offen offset:3072 lds
s_add_u32 m0, s29, 77824
v_fma_f32 v105, v105, v29, v29
v_rcp_f32 v104, v104
v_mfma_f32_32x32x16_bf16 v[144:159], a[168:171], a[108:111], v[144:159]
ds_read_b64_tr_b16 a[164:165], v18 offset:37376
ds_read_b64_tr_b16 a[166:167], v18 offset:37632
v_fma_f32 v106, v106, v29, v29
v_rcp_f32 v105, v105
v_fma_f32 v107, v107, v29, v29
v_rcp_f32 v106, v106
v_mfma_f32_32x32x16_bf16 v[160:175], a[172:175], a[108:111], v[160:175]
ds_read_b64_tr_b16 a[168:169], v18 offset:38912
ds_read_b64_tr_b16 a[170:171], v18 offset:39168
v_mul_f32 v136, v136, v27
v_rcp_f32 v107, v107
v_mul_f32 v137, v137, v27
v_mul_f32 v138, v138, v27
v_mul_f32 v139, v139, v27
s_waitcnt lgkmcnt(6)
v_mfma_f32_32x32x16_bf16 v[144:159], a[144:147], a[112:115], v[144:159]
ds_read_b64_tr_b16 a[172:173], v18 offset:39424
ds_read_b64_tr_b16 a[174:175], v18 offset:39680
buffer_load_dwordx4 v11, s[60:63], s32 offen offset:0 lds
v_fmaak_f32 v32, v136, v136, 0x409d30fc
v_fmaak_f32 v33, v137, v137, 0x409d30fc
v_fmaak_f32 v34, v138, v138, 0x409d30fc
v_mfma_f32_32x32x16_bf16 v[160:175], a[148:151], a[112:115], v[160:175]
ds_read_b64_tr_b16 a[144:145], v18 offset:40960
ds_read_b64_tr_b16 a[146:147], v18 offset:41216
v_fmaak_f32 v35, v139, v139, 0x409d30fc
v_mul_f32 v32, v136, v32
v_mul_f32 v33, v137, v33
v_mul_f32 v34, v138, v34
v_mfma_f32_32x32x16_bf16 v[144:159], a[152:155], a[116:119], v[144:159]
ds_read_b64_tr_b16 a[148:149], v18 offset:41472
ds_read_b64_tr_b16 a[150:151], v18 offset:41728
v_mul_f32 v35, v139, v35
v_exp_f32 v32, v32
v_mul_f32 v104, v132, v104
v_exp_f32 v33, v33
v_mul_f32 v105, v133, v105
v_mfma_f32_32x32x16_bf16 v[160:175], a[156:159], a[116:119], v[160:175]
ds_read_b64_tr_b16 a[152:153], v18 offset:43008
ds_read_b64_tr_b16 a[154:155], v18 offset:43264
buffer_load_dwordx4 v12, s[60:63], s32 offen offset:1024 lds
v_mul_f32 v106, v134, v106
v_exp_f32 v34, v34
v_mul_f32 v107, v135, v107
s_waitcnt lgkmcnt(6)
v_mfma_f32_32x32x16_bf16 v[144:159], a[160:163], a[120:123], v[144:159]
ds_read_b64_tr_b16 a[156:157], v18 offset:43520
ds_read_b64_tr_b16 a[158:159], v18 offset:43776
v_exp_f32 v35, v35
v_cvt_pk_bf16_f32 v82, v104, v105
v_cvt_pk_bf16_f32 v83, v106, v107
v_fma_f32 v32, v32, v29, v29
v_mfma_f32_32x32x16_bf16 v[160:175], a[164:167], a[120:123], v[160:175]
ds_read_b64_tr_b16 a[160:161], v18 offset:45056
ds_read_b64_tr_b16 a[162:163], v18 offset:45312
buffer_store_dwordx4 v[80:83], v26, s[72:75], s95 offen offset:2048 sc1
v_fma_f32 v33, v33, v29, v29
v_mfma_f32_32x32x16_bf16 v[144:159], a[168:171], a[124:127], v[144:159]
ds_read_b64_tr_b16 a[164:165], v18 offset:45568
ds_read_b64_tr_b16 a[166:167], v18 offset:45824
v_rcp_f32 v32, v32
v_fma_f32 v34, v34, v29, v29
v_rcp_f32 v33, v33
v_fma_f32 v35, v35, v29, v29
v_rcp_f32 v34, v34
v_mfma_f32_32x32x16_bf16 v[160:175], a[172:175], a[124:127], v[160:175]
ds_read_b64_tr_b16 a[168:169], v18 offset:47104
ds_read_b64_tr_b16 a[170:171], v18 offset:47360
v_mul_f32 v140, v140, v27
v_rcp_f32 v35, v35
v_mul_f32 v141, v141, v27
v_mul_f32 v142, v142, v27
s_waitcnt lgkmcnt(6)
v_mfma_f32_32x32x16_bf16 v[144:159], a[144:147], a[128:131], v[144:159]
ds_read_b64_tr_b16 a[172:173], v18 offset:47616
ds_read_b64_tr_b16 a[174:175], v18 offset:47872
v_mul_f32 v143, v143, v27
v_fmaak_f32 v104, v140, v140, 0x409d30fc
v_fmaak_f32 v105, v141, v141, 0x409d30fc
v_fmaak_f32 v106, v142, v142, 0x409d30fc
v_fmaak_f32 v107, v143, v143, 0x409d30fc
v_mfma_f32_32x32x16_bf16 v[160:175], a[148:151], a[128:131], v[160:175]
L_slot12:
s_waitcnt vmcnt(21)
s_barrier
ds_read_b64_tr_b16 a[144:145], v25 offset:0
ds_read_b64_tr_b16 a[146:147], v25 offset:256
v_mul_f32 v104, v140, v104
v_mul_f32 v105, v141, v105
v_mul_f32 v106, v142, v106
v_mul_f32 v107, v143, v107
v_exp_f32 v104, v104
v_mfma_f32_32x32x16_bf16 v[144:159], a[152:155], a[132:135], v[144:159]
ds_read_b64_tr_b16 a[148:149], v25 offset:1024
ds_read_b64_tr_b16 a[150:151], v25 offset:1280
v_mul_f32 v32, v136, v32
v_exp_f32 v105, v105
v_mul_f32 v33, v137, v33
v_mul_f32 v34, v138, v34
v_mfma_f32_32x32x16_bf16 v[160:175], a[156:159], a[132:135], v[160:175]
ds_read_b64_tr_b16 a[152:153], v25 offset:2048
ds_read_b64_tr_b16 a[154:155], v25 offset:2304
v_exp_f32 v106, v106
v_mul_f32 v35, v139, v35
v_exp_f32 v107, v107
v_cvt_pk_bf16_f32 v84, v32, v33
v_cvt_pk_bf16_f32 v85, v34, v35
s_waitcnt lgkmcnt(6)
v_mfma_f32_32x32x16_bf16 v[144:159], a[160:163], a[136:139], v[144:159]
ds_read_b64_tr_b16 a[156:157], v25 offset:3072
ds_read_b64_tr_b16 a[158:159], v25 offset:3328
v_fma_f32 v104, v104, v29, v29
v_fma_f32 v105, v105, v29, v29
v_rcp_f32 v104, v104
v_fma_f32 v106, v106, v29, v29
v_rcp_f32 v105, v105
v_mfma_f32_32x32x16_bf16 v[160:175], a[164:167], a[136:139], v[160:175]
ds_read_b64_tr_b16 a[160:161], v25 offset:4096
ds_read_b64_tr_b16 a[162:163], v25 offset:4352
v_fma_f32 v107, v107, v29, v29
v_rcp_f32 v106, v106
v_rcp_f32 v107, v107
v_mul_f32 v104, v140, v104
v_mfma_f32_32x32x16_bf16 v[144:159], a[168:171], a[140:143], v[144:159]
ds_read_b64_tr_b16 a[164:165], v25 offset:5120
ds_read_b64_tr_b16 a[166:167], v25 offset:5376
v_mul_f32 v105, v141, v105
v_mul_f32 v106, v142, v106
v_mul_f32 v107, v143, v107
v_cvt_pk_bf16_f32 v86, v104, v105
v_cvt_pk_bf16_f32 v87, v106, v107
v_mfma_f32_32x32x16_bf16 v[160:175], a[172:175], a[140:143], v[160:175]
v_mfma_f32_32x32x16_bf16 v[144:159], a[206:209], a[212:215], v[144:159]
v_mfma_f32_32x32x16_bf16 v[160:175], a[206:209], a[216:219], v[160:175]
ds_read_b64_tr_b16 a[168:169], v25 offset:6144
ds_read_b64_tr_b16 a[170:171], v25 offset:6400
buffer_store_dwordx4 v[84:87], v26, s[72:75], s95 offen offset:3072 sc1
s_waitcnt lgkmcnt(6)
v_mfma_f32_32x32x16_bf16 v[112:127], a[144:147], a[0:3], 0
ds_read_b64_tr_b16 a[172:173], v25 offset:7168
ds_read_b64_tr_b16 a[174:175], v25 offset:7424
s_add_u32 s32, s18, 256
s_add_u32 m0, s29, 98304
v_mfma_f32_32x32x16_bf16 v[112:127], a[148:151], a[4:7], v[112:127]
ds_read_b64_tr_b16 a[144:145], v25 offset:8192
ds_read_b64_tr_b16 a[146:147], v25 offset:8448
buffer_load_dwordx4 v7, s[60:63], s32 offen offset:0 lds
v_mul_f32 v144, v144, v27
v_mul_f32 v145, v145, v27
v_mul_f32 v146, v146, v27
v_mfma_f32_32x32x16_bf16 v[112:127], a[152:155], a[8:11], v[112:127]
ds_read_b64_tr_b16 a[148:149], v25 offset:9216
ds_read_b64_tr_b16 a[150:151], v25 offset:9472
buffer_load_dwordx4 v8, s[60:63], s32 offen offset:1024 lds
v_mul_f32 v147, v147, v27
v_fmaak_f32 v32, v144, v144, 0x409d30fc
v_fmaak_f32 v33, v145, v145, 0x409d30fc
v_mfma_f32_32x32x16_bf16 v[112:127], a[156:159], a[12:15], v[112:127]
ds_read_b64_tr_b16 a[152:153], v25 offset:10240
ds_read_b64_tr_b16 a[154:155], v25 offset:10496
v_fmaak_f32 v34, v146, v146, 0x409d30fc
v_fmaak_f32 v35, v147, v147, 0x409d30fc
v_mul_f32 v32, v144, v32
v_mul_f32 v33, v145, v33
v_mul_f32 v34, v146, v34
s_waitcnt lgkmcnt(6)
v_mfma_f32_32x32x16_bf16 v[112:127], a[160:163], a[16:19], v[112:127]
ds_read_b64_tr_b16 a[156:157], v25 offset:11264
ds_read_b64_tr_b16 a[158:159], v25 offset:11520
buffer_load_dwordx4 v9, s[60:63], s32 offen offset:2048 lds
v_mul_f32 v35, v147, v35
v_exp_f32 v32, v32
v_exp_f32 v33, v33
v_mfma_f32_32x32x16_bf16 v[112:127], a[164:167], a[20:23], v[112:127]
ds_read_b64_tr_b16 a[160:161], v25 offset:12288
ds_read_b64_tr_b16 a[162:163], v25 offset:12544
v_exp_f32 v34, v34
v_exp_f32 v35, v35
v_fma_f32 v32, v32, v29, v29
v_fma_f32 v33, v33, v29, v29
v_rcp_f32 v32, v32
v_mfma_f32_32x32x16_bf16 v[112:127], a[168:171], a[24:27], v[112:127]
ds_read_b64_tr_b16 a[164:165], v25 offset:13312
ds_read_b64_tr_b16 a[166:167], v25 offset:13568
buffer_load_dwordx4 v10, s[60:63], s32 offen offset:3072 lds
s_add_u32 m0, s29, 102400
v_fma_f32 v34, v34, v29, v29
v_rcp_f32 v33, v33
v_mfma_f32_32x32x16_bf16 v[112:127], a[172:175], a[28:31], v[112:127]
ds_read_b64_tr_b16 a[168:169], v25 offset:14336
ds_read_b64_tr_b16 a[170:171], v25 offset:14592
v_fma_f32 v35, v35, v29, v29
v_rcp_f32 v34, v34
v_mul_f32 v148, v148, v27
v_rcp_f32 v35, v35
s_waitcnt lgkmcnt(6)
v_mfma_f32_32x32x16_bf16 v[112:127], a[144:147], a[32:35], v[112:127]
ds_read_b64_tr_b16 a[172:173], v25 offset:15360
ds_read_b64_tr_b16 a[174:175], v25 offset:15616
buffer_load_dwordx4 v11, s[60:63], s32 offen offset:0 lds
v_mul_f32 v149, v149, v27
v_mul_f32 v150, v150, v27
v_mul_f32 v151, v151, v27
v_fmaak_f32 v104, v148, v148, 0x409d30fc
v_mfma_f32_32x32x16_bf16 v[112:127], a[148:151], a[36:39], v[112:127]
ds_read_b64_tr_b16 a[144:145], v25 offset:16384
ds_read_b64_tr_b16 a[146:147], v25 offset:16640
v_fmaak_f32 v105, v149, v149, 0x409d30fc
v_fmaak_f32 v106, v150, v150, 0x409d30fc
v_fmaak_f32 v107, v151, v151, 0x409d30fc
v_mul_f32 v104, v148, v104
v_mfma_f32_32x32x16_bf16 v[112:127], a[152:155], a[40:43], v[112:127]
ds_read_b64_tr_b16 a[148:149], v25 offset:17408
ds_read_b64_tr_b16 a[150:151], v25 offset:17664
buffer_load_dwordx4 v12, s[60:63], s32 offen offset:1024 lds
v_mul_f32 v105, v149, v105
v_mul_f32 v106, v150, v106
v_mul_f32 v107, v151, v107
v_exp_f32 v104, v104
v_mfma_f32_32x32x16_bf16 v[112:127], a[156:159], a[44:47], v[112:127]
ds_read_b64_tr_b16 a[152:153], v25 offset:18432
ds_read_b64_tr_b16 a[154:155], v25 offset:18688
v_mul_f32 v32, v144, v32
v_exp_f32 v105, v105
v_mul_f32 v33, v145, v33
v_mul_f32 v34, v146, v34
s_waitcnt lgkmcnt(6)
v_mfma_f32_32x32x16_bf16 v[112:127], a[160:163], a[48:51], v[112:127]
ds_read_b64_tr_b16 a[156:157], v25 offset:19456
ds_read_b64_tr_b16 a[158:159], v25 offset:19712
v_exp_f32 v106, v106
v_mul_f32 v35, v147, v35
v_exp_f32 v107, v107
v_cvt_pk_bf16_f32 v88, v32, v33
v_cvt_pk_bf16_f32 v89, v34, v35
v_mfma_f32_32x32x16_bf16 v[112:127], a[164:167], a[52:55], v[112:127]
L_slot13:
s_waitcnt vmcnt(22)
s_barrier
ds_read_b64_tr_b16 a[160:161], v25 offset:24576
ds_read_b64_tr_b16 a[162:163], v25 offset:24832
v_fma_f32 v104, v104, v29, v29
v_fma_f32 v105, v105, v29, v29
v_rcp_f32 v104, v104
v_fma_f32 v106, v106, v29, v29
v_mfma_f32_32x32x16_bf16 v[112:127], a[168:171], a[56:59], v[112:127]
ds_read_b64_tr_b16 a[164:165], v25 offset:25600
ds_read_b64_tr_b16 a[166:167], v25 offset:25856
s_add_u32 m0, s30, 122880
s_add_u32 s32, s20, 0
v_rcp_f32 v105, v105
v_fma_f32 v107, v107, v29, v29
v_rcp_f32 v106, v106
v_mfma_f32_32x32x16_bf16 v[112:127], a[172:175], a[60:63], v[112:127]
ds_read_b64_tr_b16 a[168:169], v25 offset:26624
ds_read_b64_tr_b16 a[170:171], v25 offset:26880
buffer_load_dwordx4 v14, s[60:63], s32 offen offset:0 lds
s_add_u32 s32, s21, 0
v_mul_f32 v152, v152, v27
v_rcp_f32 v107, v107
v_mul_f32 v153, v153, v27
s_waitcnt lgkmcnt(6)
v_mfma_f32_32x32x16_bf16 v[112:127], a[144:147], a[64:67], v[112:127]
ds_read_b64_tr_b16 a[172:173], v25 offset:27648
ds_read_b64_tr_b16 a[174:175], v25 offset:27904
v_mul_f32 v154, v154, v27
v_mul_f32 v155, v155, v27
v_fmaak_f32 v32, v152, v152, 0x409d30fc
v_fmaak_f32 v33, v153, v153, 0x409d30fc
v_fmaak_f32 v34, v154, v154, 0x409d30fc
v_mfma_f32_32x32x16_bf16 v[112:127], a[148:151], a[68:71], v[112:127]
ds_read_b64_tr_b16 a[144:145], v25 offset:28672
ds_read_b64_tr_b16 a[146:147], v25 offset:28928
buffer_load_dwordx4 v14, s[60:63], s32 offen offset:1024 lds
s_add_u32 s32, s22, 0
v_fmaak_f32 v35, v155, v155, 0x409d30fc
v_mul_f32 v32, v152, v32
v_mfma_f32_32x32x16_bf16 v[112:127], a[152:155], a[72:75], v[112:127]
ds_read_b64_tr_b16 a[148:149], v25 offset:29696
ds_read_b64_tr_b16 a[150:151], v25 offset:29952
v_mul_f32 v33, v153, v33
v_mul_f32 v34, v154, v34
v_mul_f32 v35, v155, v35
v_exp_f32 v32, v32
v_mul_f32 v104, v148, v104
v_mfma_f32_32x32x16_bf16 v[112:127], a[156:159], a[76:79], v[112:127]
ds_read_b64_tr_b16 a[152:153], v25 offset:30720
ds_read_b64_tr_b16 a[154:155], v25 offset:30976
v_exp_f32 v33, v33
v_mul_f32 v105, v149, v105
v_mul_f32 v106, v150, v106
v_exp_f32 v34, v34
v_mul_f32 v107, v151, v107
s_waitcnt lgkmcnt(6)
v_mfma_f32_32x32x16_bf16 v[112:127], a[160:163], a[80:83], v[112:127]
ds_read_b64_tr_b16 a[156:157], v25 offset:31744
ds_read_b64_tr_b16 a[158:159], v25 offset:32000
buffer_load_dwordx4 v14, s[60:63], s32 offen offset:2048 lds
s_add_u32 m0, s31, 135168
s_add_u32 s32, s26, 0
v_exp_f32 v35, v35
v_cvt_pk_bf16_f32 v90, v104, v105
v_mfma_f32_32x32x16_bf16 v[112:127], a[164:167], a[84:87], v[112:127]
ds_read_b64_tr_b16 a[160:161], v25 offset:32768
ds_read_b64_tr_b16 a[162:163], v25 offset:33024
v_cvt_pk_bf16_f32 v91, v106, v107
v_fma_f32 v32, v32, v29, v29
v_fma_f32 v33, v33, v29, v29
v_rcp_f32 v32, v32
v_fma_f32 v34, v34, v29, v29
v_mfma_f32_32x32x16_bf16 v[112:127], a[168:171], a[88:91], v[112:127]
ds_read_b64_tr_b16 a[164:165], v25 offset:33792
ds_read_b64_tr_b16 a[166:167], v25 offset:34048
buffer_load_dwordx4 v14, s[64:67], s32 offen lds
s_add_u32 m0, s31, 139264
s_add_u32 s32, s27, 0
s_add_u32 s95, s34, 12288
v_rcp_f32 v33, v33
v_mfma_f32_32x32x16_bf16 v[112:127], a[172:175], a[92:95], v[112:127]
ds_read_b64_tr_b16 a[168:169], v25 offset:34816
ds_read_b64_tr_b16 a[170:171], v25 offset:35072
v_fma_f32 v35, v35, v29, v29
v_rcp_f32 v34, v34
v_mul_f32 v156, v156, v27
v_rcp_f32 v35, v35
v_mul_f32 v157, v157, v27
s_waitcnt lgkmcnt(6)
v_mfma_f32_32x32x16_bf16 v[112:127], a[144:147], a[96:99], v[112:127]
ds_read_b64_tr_b16 a[172:173], v25 offset:35840
ds_read_b64_tr_b16 a[174:175], v25 offset:36096
buffer_load_dwordx4 v14, s[64:67], s32 offen lds
v_mul_f32 v158, v158, v27
v_mul_f32 v159, v159, v27
v_fmaak_f32 v104, v156, v156, 0x409d30fc
v_fmaak_f32 v105, v157, v157, 0x409d30fc
v_mfma_f32_32x32x16_bf16 v[112:127], a[148:151], a[100:103], v[112:127]
ds_read_b64_tr_b16 a[144:145], v25 offset:36864
ds_read_b64_tr_b16 a[146:147], v25 offset:37120
s_and_b32 s94, s31, 1024
s_cmp_ge_u32 s3, 2
s_cselect_b32 s94, 4096, s94
s_add_u32 m0, s94, 143360
s_add_u32 s32, s28, 0
v_mfma_f32_32x32x16_bf16 v[112:127], a[152:155], a[104:107], v[112:127]
ds_read_b64_tr_b16 a[148:149], v25 offset:37888
ds_read_b64_tr_b16 a[150:151], v25 offset:38144
buffer_load_dwordx4 v15, s[64:67], s32 offen lds
v_fmaak_f32 v106, v158, v158, 0x409d30fc
v_fmaak_f32 v107, v159, v159, 0x409d30fc
v_mul_f32 v104, v156, v104
v_mul_f32 v105, v157, v105
v_mfma_f32_32x32x16_bf16 v[112:127], a[156:159], a[108:111], v[112:127]
ds_read_b64_tr_b16 a[152:153], v25 offset:38912
ds_read_b64_tr_b16 a[154:155], v25 offset:39168
v_mul_f32 v106, v158, v106
v_mul_f32 v107, v159, v107
v_exp_f32 v104, v104
v_mul_f32 v32, v152, v32
v_exp_f32 v105, v105
s_waitcnt lgkmcnt(6)
v_mfma_f32_32x32x16_bf16 v[112:127], a[160:163], a[112:115], v[112:127]
ds_read_b64_tr_b16 a[156:157], v25 offset:39936
ds_read_b64_tr_b16 a[158:159], v25 offset:40192
buffer_store_dwordx4 v[88:91], v26, s[72:75], s95 offen offset:0 sc1
v_mul_f32 v33, v153, v33
v_mfma_f32_32x32x16_bf16 v[112:127], a[164:167], a[116:119], v[112:127]
L_slot14:
s_waitcnt vmcnt(22)
s_waitcnt vmcnt(13)
s_barrier
s_add_u32 s100, s12, 20480
buffer_store_dword a255, v253, s[72:75], s100 offen sc1
ds_read_b64_tr_b16 a[160:161], v20 offset:0
ds_read_b64_tr_b16 a[162:163], v20 offset:1024
v_mul_f32 v34, v154, v34
v_exp_f32 v106, v106
v_mul_f32 v35, v155, v35
v_exp_f32 v107, v107
v_cvt_pk_bf16_f32 v92, v32, v33
v_mfma_f32_32x32x16_bf16 v[112:127], a[168:171], a[120:123], v[112:127]
ds_read_b64_tr_b16 a[164:165], v20 offset:512
ds_read_b64_tr_b16 a[166:167], v20 offset:1536
s_add_u32 m0, s30, 0
s_add_u32 s32, s20, 128
v_cvt_pk_bf16_f32 v93, v34, v35
v_fma_f32 v104, v104, v29, v29
v_fma_f32 v105, v105, v29, v29
v_rcp_f32 v104, v104
v_mfma_f32_32x32x16_bf16 v[112:127], a[172:175], a[124:127], v[112:127]
ds_read_b64_tr_b16 a[168:169], v20 offset:2048
ds_read_b64_tr_b16 a[170:171], v20 offset:3072
v_fma_f32 v106, v106, v29, v29
v_rcp_f32 v105, v105
v_fma_f32 v107, v107, v29, v29
v_rcp_f32 v106, v106
v_mul_f32 v160, v160, v27
s_waitcnt lgkmcnt(6)
v_mfma_f32_32x32x16_bf16 v[112:127], a[144:147], a[128:131], v[112:127]
ds_read_b64_tr_b16 a[172:173], v20 offset:2560
ds_read_b64_tr_b16 a[174:175], v20 offset:3584
buffer_load_dwordx4 v14, s[60:63], s32 offen offset:0 lds
s_add_u32 s32, s21, 128
v_rcp_f32 v107, v107
v_mul_f32 v161, v161, v27
v_mul_f32 v162, v162, v27
v_mul_f32 v163, v163, v27
v_mfma_f32_32x32x16_bf16 v[112:127], a[148:151], a[132:135], v[112:127]
ds_read_b64_tr_b16 a[144:145], v20 offset:4096
ds_read_b64_tr_b16 a[146:147], v20 offset:5120
v_fmaak_f32 v32, v160, v160, 0x409d30fc
v_fmaak_f32 v33, v161, v161, 0x409d30fc
v_fmaak_f32 v34, v162, v162, 0x409d30fc
v_fmaak_f32 v35, v163, v163, 0x409d30fc
v_mul_f32 v32, v160, v32
v_mul_f32 v33, v161, v33
v_mfma_f32_32x32x16_bf16 v[112:127], a[152:155], a[136:139], v[112:127]
ds_read_b64_tr_b16 a[148:149], v20 offset:4608
ds_read_b64_tr_b16 a[150:151], v20 offset:5632
buffer_load_dwordx4 v14, s[60:63], s32 offen offset:1024 lds
s_add_u32 s32, s22, 128
v_mul_f32 v34, v162, v34
v_mul_f32 v35, v163, v35
v_exp_f32 v32, v32
v_mfma_f32_32x32x16_bf16 v[112:127], a[156:159], a[140:143], v[112:127]
v_mfma_f32_32x32x16_bf16 v[112:127], a[208:211], a[212:215], v[112:127]
ds_read_b64_tr_b16 a[152:153], v20 offset:6144
ds_read_b64_tr_b16 a[154:155], v20 offset:7168
v_mul_f32 v104, v156, v104
v_exp_f32 v33, v33
v_mul_f32 v105, v157, v105
v_mul_f32 v106, v158, v106
v_exp_f32 v34, v34
v_mul_f32 v107, v159, v107
s_waitcnt lgkmcnt(6)
v_mfma_f32_32x32x16_bf16 v[176:191], a[160:163], v[40:43], 0
ds_read_b64_tr_b16 a[156:157], v20 offset:6656
ds_read_b64_tr_b16 a[158:159], v20 offset:7680
v_exp_f32 v35, v35
v_cvt_pk_bf16_f32 v94, v104, v105
v_cvt_pk_bf16_f32 v95, v106, v107
v_fma_f32 v32, v32, v29, v29
v_fma_f32 v33, v33, v29, v29
v_rcp_f32 v32, v32
v_mfma_f32_32x32x16_bf16 v[192:207], a[164:167], v[40:43], 0
ds_read_b64_tr_b16 a[160:161], v20 offset:8192
ds_read_b64_tr_b16 a[162:163], v20 offset:9216
buffer_load_dwordx4 v14, s[60:63], s32 offen offset:2048 lds
s_add_u32 m0, s31, 12288
s_add_u32 s32, s26, 128
v_fma_f32 v34, v34, v29, v29
v_rcp_f32 v33, v33
v_fma_f32 v35, v35, v29, v29
v_mfma_f32_32x32x16_bf16 v[176:191], a[168:171], v[44:47], v[176:191]
ds_read_b64_tr_b16 a[164:165], v20 offset:8704
ds_read_b64_tr_b16 a[166:167], v20 offset:9728
s_and_b32 s91, s5, 1
s_xor_b32 s96, s5, 1
s_lshl_b32 s96, s96, 2
v_mov_b32 v30, s96
v_and_b32 v39, 7, v0
v_lshlrev_b32 v39, 1, v39
v_mfma_f32_32x32x16_bf16 v[192:207], a[172:175], v[44:47], v[192:207]
ds_read_b64_tr_b16 a[168:169], v20 offset:10240
ds_read_b64_tr_b16 a[170:171], v20 offset:11264
v_add_u32 v39, s91, v39
v_lshlrev_b32 v28, 2, v39
v_rcp_f32 v34, v34
v_mul_f32 v164, v164, v27
v_rcp_f32 v35, v35
v_mul_f32 v165, v165, v27
s_waitcnt lgkmcnt(6)
v_mfma_f32_32x32x16_bf16 v[176:191], a[144:147], v[48:51], v[176:191]
ds_read_b64_tr_b16 a[172:173], v20 offset:10752
ds_read_b64_tr_b16 a[174:175], v20 offset:11776
buffer_load_dwordx4 v14, s[64:67], s32 offen lds
s_add_u32 m0, s31, 16384
s_add_u32 s32, s27, 128
v_mul_f32 v166, v166, v27
v_mul_f32 v167, v167, v27
v_fmaak_f32 v104, v164, v164, 0x409d30fc
v_fmaak_f32 v105, v165, v165, 0x409d30fc
v_mfma_f32_32x32x16_bf16 v[192:207], a[148:151], v[48:51], v[192:207]
ds_read_b64_tr_b16 a[144:145], v20 offset:12288
ds_read_b64_tr_b16 a[146:147], v20 offset:13312
v_fmaak_f32 v106, v166, v166, 0x409d30fc
v_fmaak_f32 v107, v167, v167, 0x409d30fc
v_mul_f32 v104, v164, v104
v_mul_f32 v105, v165, v105
v_mul_f32 v106, v166, v106
v_mul_f32 v107, v167, v107
v_mfma_f32_32x32x16_bf16 v[176:191], a[152:155], v[52:55], v[176:191]
ds_read_b64_tr_b16 a[148:149], v20 offset:12800
ds_read_b64_tr_b16 a[150:151], v20 offset:13824
buffer_store_dwordx4 v[92:95], v26, s[72:75], s95 offen offset:1024 sc1
v_exp_f32 v104, v104
v_mul_f32 v32, v160, v32
v_mfma_f32_32x32x16_bf16 v[192:207], a[156:159], v[52:55], v[192:207]
ds_read_b64_tr_b16 a[152:153], v20 offset:14336
ds_read_b64_tr_b16 a[154:155], v20 offset:15360
v_exp_f32 v105, v105
v_mul_f32 v33, v161, v33
v_mul_f32 v34, v162, v34
v_exp_f32 v106, v106
v_mul_f32 v35, v163, v35
v_exp_f32 v107, v107
v_cvt_pk_bf16_f32 v96, v32, v33
s_waitcnt lgkmcnt(6)
v_mfma_f32_32x32x16_bf16 v[176:191], a[160:163], v[56:59], v[176:191]
ds_read_b64_tr_b16 a[156:157], v20 offset:14848
ds_read_b64_tr_b16 a[158:159], v20 offset:15872
v_cvt_pk_bf16_f32 v97, v34, v35
v_fma_f32 v104, v104, v29, v29
v_fma_f32 v105, v105, v29, v29
v_rcp_f32 v104, v104
v_fma_f32 v106, v106, v29, v29
v_rcp_f32 v105, v105
v_mfma_f32_32x32x16_bf16 v[192:207], a[164:167], v[56:59], v[192:207]
ds_read_b64_tr_b16 a[160:161], v20 offset:16384
ds_read_b64_tr_b16 a[162:163], v20 offset:17408
buffer_load_dwordx4 v14, s[64:67], s32 offen lds
s_and_b32 s94, s31, 1024
s_cmp_ge_u32 s3, 2
s_cselect_b32 s94, 126976, s94
s_add_u32 m0, s94, 20480
s_add_u32 s32, s28, 128
v_mfma_f32_32x32x16_bf16 v[176:191], a[168:171], v[60:63], v[176:191]
ds_read_b64_tr_b16 a[164:165], v20 offset:16896
ds_read_b64_tr_b16 a[166:167], v20 offset:17920
v_fma_f32 v107, v107, v29, v29
v_rcp_f32 v106, v106
v_mul_f32 v168, v168, v27
v_rcp_f32 v107, v107
v_mul_f32 v169, v169, v27
v_mul_f32 v170, v170, v27
v_mul_f32 v171, v171, v27
v_mfma_f32_32x32x16_bf16 v[192:207], a[172:175], v[60:63], v[192:207]
ds_read_b64_tr_b16 a[168:169], v20 offset:18432
ds_read_b64_tr_b16 a[170:171], v20 offset:19456
v_fmaak_f32 v32, v168, v168, 0x409d30fc
v_fmaak_f32 v33, v169, v169, 0x409d30fc
v_fmaak_f32 v34, v170, v170, 0x409d30fc
v_fmaak_f32 v35, v171, v171, 0x409d30fc
v_mul_f32 v32, v168, v32
v_mul_f32 v33, v169, v33
s_waitcnt lgkmcnt(6)
v_mfma_f32_32x32x16_bf16 v[176:191], a[144:147], v[64:67], v[176:191]
ds_read_b64_tr_b16 a[172:173], v20 offset:18944
ds_read_b64_tr_b16 a[174:175], v20 offset:19968
buffer_load_dwordx4 v15, s[64:67], s32 offen lds
v_mul_f32 v34, v170, v34
v_mul_f32 v35, v171, v35
v_exp_f32 v32, v32
v_mul_f32 v104, v164, v104
v_exp_f32 v33, v33
v_mfma_f32_32x32x16_bf16 v[192:207], a[148:151], v[64:67], v[192:207]
ds_read_b64_tr_b16 a[144:145], v20 offset:20480
ds_read_b64_tr_b16 a[146:147], v20 offset:21504
v_mul_f32 v105, v165, v105
v_mul_f32 v106, v166, v106
v_exp_f32 v34, v34
v_mul_f32 v107, v167, v107
v_exp_f32 v35, v35
v_cvt_pk_bf16_f32 v98, v104, v105
v_cvt_pk_bf16_f32 v99, v106, v107
v_mfma_f32_32x32x16_bf16 v[176:191], a[152:155], v[68:71], v[176:191]
ds_read_b64_tr_b16 a[148:149], v20 offset:20992
ds_read_b64_tr_b16 a[150:151], v20 offset:22016
buffer_store_dwordx4 v[96:99], v26, s[72:75], s95 offen offset:2048 sc1
v_fma_f32 v32, v32, v29, v29
v_fma_f32 v33, v33, v29, v29
v_mfma_f32_32x32x16_bf16 v[192:207], a[156:159], v[68:71], v[192:207]
ds_read_b64_tr_b16 a[152:153], v20 offset:22528
ds_read_b64_tr_b16 a[154:155], v20 offset:23552
v_rcp_f32 v32, v32
v_fma_f32 v34, v34, v29, v29
v_rcp_f32 v33, v33
v_fma_f32 v35, v35, v29, v29
v_rcp_f32 v34, v34
v_mul_f32 v172, v172, v27
v_rcp_f32 v35, v35
s_waitcnt lgkmcnt(6)
v_mfma_f32_32x32x16_bf16 v[176:191], a[160:163], v[72:75], v[176:191]
ds_read_b64_tr_b16 a[156:157], v20 offset:23040
ds_read_b64_tr_b16 a[158:159], v20 offset:24064
v_mul_f32 v173, v173, v27
v_mul_f32 v174, v174, v27
v_mul_f32 v175, v175, v27
v_fmaak_f32 v104, v172, v172, 0x409d30fc
v_fmaak_f32 v105, v173, v173, 0x409d30fc
v_fmaak_f32 v106, v174, v174, 0x409d30fc
v_fmaak_f32 v107, v175, v175, 0x409d30fc
v_mfma_f32_32x32x16_bf16 v[192:207], a[164:167], v[72:75], v[192:207]
L_slot15:
s_barrier
ds_read_b64_tr_b16 a[160:161], v20 offset:24576
ds_read_b64_tr_b16 a[162:163], v20 offset:25600
s_movk_i32 s100, 20480
v_mul_f32 v104, v172, v104
v_mul_f32 v105, v173, v105
v_mul_f32 v106, v174, v106
v_mul_f32 v107, v175, v107
v_exp_f32 v104, v104
v_mul_f32 v32, v168, v32
v_mfma_f32_32x32x16_bf16 v[176:191], a[168:171], v[76:79], v[176:191]
ds_read_b64_tr_b16 a[164:165], v20 offset:25088
ds_read_b64_tr_b16 a[166:167], v20 offset:26112
buffer_load_dword v39, v30, s[72:75], s100 offen sc1
v_exp_f32 v105, v105
v_mul_f32 v33, v169, v33
v_mul_f32 v34, v170, v34
v_exp_f32 v106, v106
v_mul_f32 v35, v171, v35
v_exp_f32 v107, v107
v_cvt_pk_bf16_f32 v100, v32, v33
v_mfma_f32_32x32x16_bf16 v[192:207], a[172:175], v[76:79], v[192:207]
ds_read_b64_tr_b16 a[168:169], v20 offset:26624
ds_read_b64_tr_b16 a[170:171], v20 offset:27648
v_cvt_pk_bf16_f32 v101, v34, v35
v_fma_f32 v104, v104, v29, v29
v_fma_f32 v105, v105, v29, v29
v_rcp_f32 v104, v104
v_fma_f32 v106, v106, v29, v29
v_rcp_f32 v105, v105
v_fma_f32 v107, v107, v29, v29
v_rcp_f32 v106, v106
s_waitcnt lgkmcnt(6)
v_mfma_f32_32x32x16_bf16 v[176:191], a[144:147], v[80:83], v[176:191]
ds_read_b64_tr_b16 a[172:173], v20 offset:27136
ds_read_b64_tr_b16 a[174:175], v20 offset:28160
v_rcp_f32 v107, v107
v_mul_f32 v104, v172, v104
v_mul_f32 v105, v173, v105
v_mul_f32 v106, v174, v106
v_mul_f32 v107, v175, v107
v_cvt_pk_bf16_f32 v102, v104, v105
v_cvt_pk_bf16_f32 v103, v106, v107
v_mfma_f32_32x32x16_bf16 v[192:207], a[148:151], v[80:83], v[192:207]
ds_read_b64_tr_b16 a[144:145], v20 offset:28672
ds_read_b64_tr_b16 a[146:147], v20 offset:29696
buffer_store_dwordx4 v[100:103], v26, s[72:75], s95 offen offset:3072 sc1
v_mfma_f32_32x32x16_bf16 v[176:191], a[152:155], v[84:87], v[176:191]
ds_read_b64_tr_b16 a[148:149], v20 offset:29184
ds_read_b64_tr_b16 a[150:151], v20 offset:30208
s_add_u32 m0, s30, 24576
s_add_u32 s32, s20, 256
v_mul_f32 v112, v112, v27
v_mul_f32 v113, v113, v27
v_mfma_f32_32x32x16_bf16 v[192:207], a[156:159], v[84:87], v[192:207]
ds_read_b64_tr_b16 a[152:153], v20 offset:30720
ds_read_b64_tr_b16 a[154:155], v20 offset:31744
buffer_load_dwordx4 v14, s[60:63], s32 offen offset:0 lds
s_add_u32 s32, s21, 256
v_mul_f32 v114, v114, v27
v_mul_f32 v115, v115, v27
s_waitcnt lgkmcnt(6)
v_mfma_f32_32x32x16_bf16 v[208:223], a[160:163], v[40:43], 0
ds_read_b64_tr_b16 a[156:157], v20 offset:31232
ds_read_b64_tr_b16 a[158:159], v20 offset:32256
v_fmaak_f32 v32, v112, v112, 0x409d30fc
v_fmaak_f32 v33, v113, v113, 0x409d30fc
v_fmaak_f32 v34, v114, v114, 0x409d30fc
v_fmaak_f32 v35, v115, v115, 0x409d30fc
v_mul_f32 v32, v112, v32
v_mfma_f32_32x32x16_bf16 v[224:239], a[164:167], v[40:43], 0
ds_read_b64_tr_b16 a[160:161], v20 offset:32768
ds_read_b64_tr_b16 a[162:163], v20 offset:33792
v_mul_f32 v33, v113, v33
v_mul_f32 v34, v114, v34
v_mul_f32 v35, v115, v35
v_exp_f32 v32, v32
v_mfma_f32_32x32x16_bf16 v[208:223], a[168:171], v[44:47], v[208:223]
ds_read_b64_tr_b16 a[164:165], v20 offset:33280
ds_read_b64_tr_b16 a[166:167], v20 offset:34304
buffer_load_dwordx4 v14, s[60:63], s32 offen offset:1024 lds
s_add_u32 s32, s22, 256
v_exp_f32 v33, v33
v_exp_f32 v34, v34
v_mfma_f32_32x32x16_bf16 v[224:239], a[172:175], v[44:47], v[224:239]
ds_read_b64_tr_b16 a[168:169], v20 offset:34816
ds_read_b64_tr_b16 a[170:171], v20 offset:35840
v_exp_f32 v35, v35
v_fma_f32 v32, v32, v29, v29
v_fma_f32 v33, v33, v29, v29
v_rcp_f32 v32, v32
s_waitcnt lgkmcnt(6)
v_mfma_f32_32x32x16_bf16 v[208:223], a[144:147], v[48:51], v[208:223]
ds_read_b64_tr_b16 a[172:173], v20 offset:35328
ds_read_b64_tr_b16 a[174:175], v20 offset:36352
v_fma_f32 v34, v34, v29, v29
v_rcp_f32 v33, v33
v_fma_f32 v35, v35, v29, v29
v_rcp_f32 v34, v34
v_mfma_f32_32x32x16_bf16 v[224:239], a[148:151], v[48:51], v[224:239]
ds_read_b64_tr_b16 a[144:145], v20 offset:36864
ds_read_b64_tr_b16 a[146:147], v20 offset:37888
buffer_load_dwordx4 v14, s[60:63], s32 offen offset:2048 lds
s_add_u32 m0, s31, 36864
s_add_u32 s32, s26, 256
v_mul_f32 v116, v116, v27
v_rcp_f32 v35, v35
v_mfma_f32_32x32x16_bf16 v[208:223], a[152:155], v[52:55], v[208:223]
ds_read_b64_tr_b16 a[148:149], v20 offset:37376
ds_read_b64_tr_b16 a[150:151], v20 offset:38400
v_mul_f32 v117, v117, v27
v_mul_f32 v118, v118, v27
v_mul_f32 v119, v119, v27
v_fmaak_f32 v240, v116, v116, 0x409d30fc
v_mfma_f32_32x32x16_bf16 v[224:239], a[156:159], v[52:55], v[224:239]
ds_read_b64_tr_b16 a[152:153], v20 offset:38912
ds_read_b64_tr_b16 a[154:155], v20 offset:39936
buffer_load_dwordx4 v14, s[64:67], s32 offen lds
s_add_u32 m0, s31, 40960
s_add_u32 s32, s27, 256
v_fmaak_f32 v241, v117, v117, 0x409d30fc
s_waitcnt lgkmcnt(6)
v_mfma_f32_32x32x16_bf16 v[208:223], a[160:163], v[56:59], v[208:223]
ds_read_b64_tr_b16 a[156:157], v20 offset:39424
ds_read_b64_tr_b16 a[158:159], v20 offset:40448
v_fmaak_f32 v242, v118, v118, 0x409d30fc
v_fmaak_f32 v243, v119, v119, 0x409d30fc
v_mul_f32 v240, v116, v240
v_mul_f32 v241, v117, v241
v_mfma_f32_32x32x16_bf16 v[224:239], a[164:167], v[56:59], v[224:239]
ds_read_b64_tr_b16 a[160:161], v20 offset:40960
ds_read_b64_tr_b16 a[162:163], v20 offset:41984
v_mul_f32 v242, v118, v242
v_mul_f32 v243, v119, v243
v_exp_f32 v240, v240
v_mul_f32 v32, v112, v32
v_mfma_f32_32x32x16_bf16 v[208:223], a[168:171], v[60:63], v[208:223]
ds_read_b64_tr_b16 a[164:165], v20 offset:41472
ds_read_b64_tr_b16 a[166:167], v20 offset:42496
buffer_load_dwordx4 v14, s[64:67], s32 offen lds
v_exp_f32 v241, v241
v_mul_f32 v33, v113, v33
v_mul_f32 v34, v114, v34
v_exp_f32 v242, v242
v_mfma_f32_32x32x16_bf16 v[224:239], a[172:175], v[60:63], v[224:239]
ds_read_b64_tr_b16 a[168:169], v20 offset:43008
ds_read_b64_tr_b16 a[170:171], v20 offset:44032
v_mul_f32 v35, v115, v35
v_exp_f32 v243, v243
v_cvt_pk_bf16_f32 v104, v32, v33
v_cvt_pk_bf16_f32 v105, v34, v35
s_waitcnt lgkmcnt(6)
v_mfma_f32_32x32x16_bf16 v[208:223], a[144:147], v[64:67], v[208:223]
ds_read_b64_tr_b16 a[172:173], v20 offset:43520
ds_read_b64_tr_b16 a[174:175], v20 offset:44544
v_fma_f32 v240, v240, v29, v29
v_fma_f32 v241, v241, v29, v29
v_rcp_f32 v240, v240
v_fma_f32 v242, v242, v29, v29
v_mfma_f32_32x32x16_bf16 v[224:239], a[148:151], v[64:67], v[224:239]
ds_read_b64_tr_b16 a[144:145], v20 offset:45056
ds_read_b64_tr_b16 a[146:147], v20 offset:46080
v_rcp_f32 v241, v241
v_fma_f32 v243, v243, v29, v29
v_rcp_f32 v242, v242
v_mul_f32 v120, v120, v27
v_mfma_f32_32x32x16_bf16 v[208:223], a[152:155], v[68:71], v[208:223]
ds_read_b64_tr_b16 a[148:149], v20 offset:45568
ds_read_b64_tr_b16 a[150:151], v20 offset:46592
s_and_b32 s94, s31, 1024
s_cmp_ge_u32 s3, 2
s_cselect_b32 s94, 102400, s94
s_add_u32 m0, s94, 45056
s_add_u32 s32, s28, 256
v_mfma_f32_32x32x16_bf16 v[224:239], a[156:159], v[68:71], v[224:239]
ds_read_b64_tr_b16 a[152:153], v20 offset:47104
ds_read_b64_tr_b16 a[154:155], v20 offset:48128
buffer_load_dwordx4 v15, s[64:67], s32 offen lds
v_rcp_f32 v243, v243
v_mul_f32 v121, v121, v27
v_mul_f32 v122, v122, v27
s_waitcnt lgkmcnt(6)
v_mfma_f32_32x32x16_bf16 v[208:223], a[160:163], v[72:75], v[208:223]
ds_read_b64_tr_b16 a[156:157], v20 offset:47616
ds_read_b64_tr_b16 a[158:159], v20 offset:48640
v_mul_f32 v123, v123, v27
v_fmaak_f32 v32, v120, v120, 0x409d30fc
v_fmaak_f32 v33, v121, v121, 0x409d30fc
v_fmaak_f32 v34, v122, v122, 0x409d30fc
v_mfma_f32_32x32x16_bf16 v[224:239], a[164:167], v[72:75], v[224:239]
L_slot16:
s_waitcnt vmcnt(24)
s_barrier
ds_read_b64_tr_b16 a[160:161], v21 offset:0
ds_read_b64_tr_b16 a[162:163], v21 offset:1024
v_fmaak_f32 v35, v123, v123, 0x409d30fc
v_mul_f32 v32, v120, v32
v_mul_f32 v33, v121, v33
v_mul_f32 v34, v122, v34
v_mfma_f32_32x32x16_bf16 v[208:223], a[168:171], v[76:79], v[208:223]
ds_read_b64_tr_b16 a[164:165], v21 offset:512
ds_read_b64_tr_b16 a[166:167], v21 offset:1536
v_mul_f32 v35, v123, v35
v_exp_f32 v32, v32
v_mul_f32 v240, v116, v240
v_exp_f32 v33, v33
v_mfma_f32_32x32x16_bf16 v[224:239], a[172:175], v[76:79], v[224:239]
ds_read_b64_tr_b16 a[168:169], v21 offset:2048
ds_read_b64_tr_b16 a[170:171], v21 offset:3072
v_mul_f32 v241, v117, v241
v_mul_f32 v242, v118, v242
v_exp_f32 v34, v34
v_mul_f32 v243, v119, v243
v_exp_f32 v35, v35
s_waitcnt lgkmcnt(6)
v_mfma_f32_32x32x16_bf16 v[208:223], a[144:147], v[80:83], v[208:223]
ds_read_b64_tr_b16 a[172:173], v21 offset:2560
ds_read_b64_tr_b16 a[174:175], v21 offset:3584
v_cvt_pk_bf16_f32 v106, v240, v241
v_cvt_pk_bf16_f32 v107, v242, v243
v_fma_f32 v32, v32, v29, v29
v_fma_f32 v33, v33, v29, v29
v_mfma_f32_32x32x16_bf16 v[224:239], a[148:151], v[80:83], v[224:239]
ds_read_b64_tr_b16 a[144:145], v21 offset:4096
ds_read_b64_tr_b16 a[146:147], v21 offset:5120
s_add_u32 s95, s34, 16384
v_rcp_f32 v32, v32
v_fma_f32 v34, v34, v29, v29
v_rcp_f32 v33, v33
v_fma_f32 v35, v35, v29, v29
v_mfma_f32_32x32x16_bf16 v[208:223], a[152:155], v[84:87], v[208:223]
ds_read_b64_tr_b16 a[148:149], v21 offset:4608
ds_read_b64_tr_b16 a[150:151], v21 offset:5632
buffer_store_dwordx4 v[104:107], v26, s[72:75], s95 offen offset:0 sc1
v_mfma_f32_32x32x16_bf16 v[224:239], a[156:159], v[84:87], v[224:239]
ds_read_b64_tr_b16 a[152:153], v21 offset:6144
ds_read_b64_tr_b16 a[154:155], v21 offset:7168
v_rcp_f32 v34, v34
v_mul_f32 v124, v124, v27
v_rcp_f32 v35, v35
v_mul_f32 v125, v125, v27
v_mul_f32 v126, v126, v27
s_waitcnt lgkmcnt(6)
v_mfma_f32_32x32x16_bf16 v[144:159], a[160:163], v[40:43], 0
ds_read_b64_tr_b16 a[156:157], v21 offset:6656
ds_read_b64_tr_b16 a[158:159], v21 offset:7680
v_mul_f32 v127, v127, v27
v_fmaak_f32 v240, v124, v124, 0x409d30fc
v_fmaak_f32 v241, v125, v125, 0x409d30fc
v_fmaak_f32 v242, v126, v126, 0x409d30fc
v_fmaak_f32 v243, v127, v127, 0x409d30fc
v_mfma_f32_32x32x16_bf16 v[160:175], a[164:167], v[40:43], 0
ds_read_b64_tr_b16 a[160:161], v21 offset:8192
ds_read_b64_tr_b16 a[162:163], v21 offset:9216
v_mul_f32 v240, v124, v240
v_mul_f32 v241, v125, v241
v_mul_f32 v242, v126, v242
v_mul_f32 v243, v127, v243
v_mfma_f32_32x32x16_bf16 v[144:159], a[168:171], v[44:47], v[144:159]
ds_read_b64_tr_b16 a[164:165], v21 offset:8704
ds_read_b64_tr_b16 a[166:167], v21 offset:9728
v_exp_f32 v240, v240
v_mul_f32 v32, v120, v32
v_exp_f32 v241, v241
v_mul_f32 v33, v121, v33
v_mul_f32 v34, v122, v34
v_mfma_f32_32x32x16_bf16 v[160:175], a[172:175], v[44:47], v[160:175]
ds_read_b64_tr_b16 a[168:169], v21 offset:10240
ds_read_b64_tr_b16 a[170:171], v21 offset:11264
v_exp_f32 v242, v242
v_mul_f32 v35, v123, v35
v_exp_f32 v243, v243
v_cvt_pk_bf16_f32 v108, v32, v33
v_cvt_pk_bf16_f32 v109, v34, v35
s_waitcnt lgkmcnt(6)
v_mfma_f32_32x32x16_bf16 v[144:159], a[144:147], v[48:51], v[144:159]
ds_read_b64_tr_b16 a[172:173], v21 offset:10752
ds_read_b64_tr_b16 a[174:175], v21 offset:11776
v_fma_f32 v240, v240, v29, v29
v_fma_f32 v241, v241, v29, v29
v_rcp_f32 v240, v240
v_fma_f32 v242, v242, v29, v29
v_rcp_f32 v241, v241
v_mfma_f32_32x32x16_bf16 v[160:175], a[148:151], v[48:51], v[160:175]
ds_read_b64_tr_b16 a[144:145], v21 offset:12288
ds_read_b64_tr_b16 a[146:147], v21 offset:13312
v_fma_f32 v243, v243, v29, v29
v_rcp_f32 v242, v242
v_rcp_f32 v243, v243
v_mul_f32 v240, v124, v240
v_mfma_f32_32x32x16_bf16 v[144:159], a[152:155], v[52:55], v[144:159]
ds_read_b64_tr_b16 a[148:149], v21 offset:12800
ds_read_b64_tr_b16 a[150:151], v21 offset:13824
v_mul_f32 v241, v125, v241
v_mul_f32 v242, v126, v242
v_mul_f32 v243, v127, v243
v_cvt_pk_bf16_f32 v110, v240, v241
v_cvt_pk_bf16_f32 v111, v242, v243
v_mfma_f32_32x32x16_bf16 v[160:175], a[156:159], v[52:55], v[160:175]
ds_read_b64_tr_b16 a[152:153], v21 offset:14336
ds_read_b64_tr_b16 a[154:155], v21 offset:15360
buffer_store_dwordx4 v[108:111], v26, s[72:75], s95 offen offset:1024 sc1
s_waitcnt lgkmcnt(6)
v_mfma_f32_32x32x16_bf16 v[144:159], a[160:163], v[56:59], v[144:159]
ds_read_b64_tr_b16 a[156:157], v21 offset:14848
ds_read_b64_tr_b16 a[158:159], v21 offset:15872
s_add_u32 m0, s29, 49152
v_mfma_f32_32x32x16_bf16 v[160:175], a[164:167], v[56:59], v[160:175]
ds_read_b64_tr_b16 a[160:161], v21 offset:16384
ds_read_b64_tr_b16 a[162:163], v21 offset:17408
buffer_load_dwordx4 v36, s[52:55], s40 offen lds
s_waitcnt vmcnt(10)
v_cmp_ne_u32 vcc, s6, v39
s_cbranch_vccz L_ok_14
s_movk_i32 s100, 20480
s_mov_b32 s96, 0
L_spin_15:
buffer_load_dword v39, v30, s[72:75], s100 offen sc1
s_waitcnt vmcnt(0)
v_cmp_ne_u32 vcc, s6, v39
s_cbranch_vccz L_spun_16
s_add_u32 s96, s96, 1
s_cmp_lt_u32 s96, 262144
s_sleep 1
s_cbranch_scc1 L_spin_15
v_mov_b32 v39, 104
buffer_store_dword v39, v253, s[80:83], 0 offen
s_waitcnt vmcnt(0)
L_spun_16:
s_nop 0
L_ok_14:
v_mfma_f32_32x32x16_bf16 v[144:159], a[168:171], v[60:63], v[144:159]
ds_read_b64_tr_b16 a[164:165], v21 offset:16896
ds_read_b64_tr_b16 a[166:167], v21 offset:17920
s_add_u32 m0, s29, 50176
s_add_u32 s98, s101, 0
v_mfma_f32_32x32x16_bf16 v[160:175], a[172:175], v[60:63], v[160:175]
ds_read_b64_tr_b16 a[168:169], v21 offset:18432
ds_read_b64_tr_b16 a[170:171], v21 offset:19456
buffer_load_dwordx4 v36, s[52:55], s41 offen lds
s_add_u32 m0, s29, 51200
s_waitcnt lgkmcnt(6)
v_mfma_f32_32x32x16_bf16 v[144:159], a[144:147], v[64:67], v[144:159]
ds_read_b64_tr_b16 a[172:173], v21 offset:18944
ds_read_b64_tr_b16 a[174:175], v21 offset:19968
buffer_load_dwordx4 v36, s[52:55], s42 offen lds
s_add_u32 m0, s29, 52224
v_mfma_f32_32x32x16_bf16 v[160:175], a[148:151], v[64:67], v[160:175]
ds_read_b64_tr_b16 a[144:145], v21 offset:20480
ds_read_b64_tr_b16 a[146:147], v21 offset:21504
buffer_load_dwordx4 v36, s[52:55], s43 offen lds
s_add_u32 m0, s29, 53248
v_mfma_f32_32x32x16_bf16 v[144:159], a[152:155], v[68:71], v[144:159]
ds_read_b64_tr_b16 a[148:149], v21 offset:20992
ds_read_b64_tr_b16 a[150:151], v21 offset:22016
buffer_load_dwordx4 v37, s[52:55], s44 offen lds
s_add_u32 m0, s29, 54272
v_mfma_f32_32x32x16_bf16 v[160:175], a[156:159], v[68:71], v[160:175]
ds_read_b64_tr_b16 a[152:153], v21 offset:22528
ds_read_b64_tr_b16 a[154:155], v21 offset:23552
buffer_load_dwordx4 v37, s[52:55], s45 offen lds
s_waitcnt lgkmcnt(6)
v_mfma_f32_32x32x16_bf16 v[144:159], a[160:163], v[72:75], v[144:159]
ds_read_b64_tr_b16 a[156:157], v21 offset:23040
ds_read_b64_tr_b16 a[158:159], v21 offset:24064
v_mfma_f32_32x32x16_bf16 v[160:175], a[164:167], v[72:75], v[160:175]
L_slot17:
s_barrier
ds_read_b64_tr_b16 a[160:161], v18 offset:36864
ds_read_b64_tr_b16 a[162:163], v18 offset:37120
v_mfma_f32_32x32x16_bf16 v[144:159], a[168:171], v[76:79], v[144:159]
ds_read_b64_tr_b16 a[164:165], v18 offset:37376
ds_read_b64_tr_b16 a[166:167], v18 offset:37632
s_add_u32 s32, s19, 0
s_add_u32 m0, s29, 73728
v_mfma_f32_32x32x16_bf16 v[160:175], a[172:175], v[76:79], v[160:175]
ds_read_b64_tr_b16 a[168:169], v18 offset:38912
ds_read_b64_tr_b16 a[170:171], v18 offset:39168
s_waitcnt lgkmcnt(6)
v_mfma_f32_32x32x16_bf16 v[144:159], a[144:147], v[80:83], v[144:159]
ds_read_b64_tr_b16 a[172:173], v18 offset:39424
ds_read_b64_tr_b16 a[174:175], v18 offset:39680
v_mfma_f32_32x32x16_bf16 v[160:175], a[148:151], v[80:83], v[160:175]
ds_read_b64_tr_b16 a[144:145], v18 offset:40960
ds_read_b64_tr_b16 a[146:147], v18 offset:41216
buffer_load_dwordx4 a[0:3], v26, s[72:75], s98 offen offset:0 sc1
v_mfma_f32_32x32x16_bf16 v[144:159], a[152:155], v[84:87], v[144:159]
ds_read_b64_tr_b16 a[148:149], v18 offset:41472
ds_read_b64_tr_b16 a[150:151], v18 offset:41728
v_mfma_f32_32x32x16_bf16 v[160:175], a[156:159], v[84:87], v[160:175]
ds_read_b64_tr_b16 a[152:153], v18 offset:43008
ds_read_b64_tr_b16 a[154:155], v18 offset:43264
buffer_load_dwordx4 v7, s[60:63], s32 offen offset:0 lds
s_waitcnt lgkmcnt(6)
v_mfma_f32_32x32x16_bf16 v[176:191], a[160:163], a[176:179], v[176:191]
ds_read_b64_tr_b16 a[156:157], v18 offset:43520
ds_read_b64_tr_b16 a[158:159], v18 offset:43776
v_mfma_f32_32x32x16_bf16 v[192:207], a[164:167], a[176:179], v[192:207]
ds_read_b64_tr_b16 a[160:161], v24 offset:45056
ds_read_b64_tr_b16 a[162:163], v24 offset:46080
v_mfma_f32_32x32x16_bf16 v[176:191], a[168:171], a[180:183], v[176:191]
ds_read_b64_tr_b16 a[164:165], v24 offset:45568
ds_read_b64_tr_b16 a[166:167], v24 offset:46592
buffer_load_dwordx4 v8, s[60:63], s32 offen offset:1024 lds
v_mfma_f32_32x32x16_bf16 v[192:207], a[172:175], a[180:183], v[192:207]
ds_read_b64_tr_b16 a[168:169], v21 offset:24576
ds_read_b64_tr_b16 a[170:171], v21 offset:25600
s_waitcnt lgkmcnt(6)
v_mfma_f32_32x32x16_bf16 v[176:191], a[144:147], a[184:187], v[176:191]
ds_read_b64_tr_b16 a[172:173], v21 offset:25088
ds_read_b64_tr_b16 a[174:175], v21 offset:26112
v_mfma_f32_32x32x16_bf16 v[192:207], a[148:151], a[184:187], v[192:207]
ds_read_b64_tr_b16 a[144:145], v21 offset:26624
ds_read_b64_tr_b16 a[146:147], v21 offset:27648
buffer_load_dwordx4 a[4:7], v26, s[72:75], s98 offen offset:1024 sc1
v_mfma_f32_32x32x16_bf16 v[176:191], a[152:155], a[188:191], v[176:191]
ds_read_b64_tr_b16 a[148:149], v21 offset:27136
ds_read_b64_tr_b16 a[150:151], v21 offset:28160
buffer_load_dwordx4 v9, s[60:63], s32 offen offset:2048 lds
v_mfma_f32_32x32x16_bf16 v[192:207], a[156:159], a[188:191], v[192:207]
ds_read_b64_tr_b16 a[152:153], v21 offset:28672
ds_read_b64_tr_b16 a[154:155], v21 offset:29696
s_waitcnt lgkmcnt(6)
v_mfma_f32_32x32x16_bf16 v[176:191], a[160:163], a[192:195], v[176:191]
ds_read_b64_tr_b16 a[156:157], v21 offset:29184
ds_read_b64_tr_b16 a[158:159], v21 offset:30208
buffer_load_dwordx4 v10, s[60:63], s32 offen offset:3072 lds
s_add_u32 m0, s29, 77824
v_mfma_f32_32x32x16_bf16 v[192:207], a[164:167], a[192:195], v[192:207]
ds_read_b64_tr_b16 a[160:161], v21 offset:30720
ds_read_b64_tr_b16 a[162:163], v21 offset:31744
v_mfma_f32_32x32x16_bf16 v[176:191], a[168:171], v[88:91], v[176:191]
ds_read_b64_tr_b16 a[164:165], v21 offset:31232
ds_read_b64_tr_b16 a[166:167], v21 offset:32256
buffer_load_dwordx4 v11, s[60:63], s32 offen offset:0 lds
v_mfma_f32_32x32x16_bf16 v[192:207], a[172:175], v[88:91], v[192:207]
ds_read_b64_tr_b16 a[168:169], v21 offset:32768
ds_read_b64_tr_b16 a[170:171], v21 offset:33792
s_waitcnt lgkmcnt(6)
v_mfma_f32_32x32x16_bf16 v[176:191], a[144:147], v[92:95], v[176:191]
ds_read_b64_tr_b16 a[172:173], v21 offset:33280
ds_read_b64_tr_b16 a[174:175], v21 offset:34304
buffer_load_dwordx4 v12, s[60:63], s32 offen offset:1024 lds
v_mfma_f32_32x32x16_bf16 v[192:207], a[148:151], v[92:95], v[192:207]
ds_read_b64_tr_b16 a[144:145], v21 offset:34816
ds_read_b64_tr_b16 a[146:147], v21 offset:35840
v_mfma_f32_32x32x16_bf16 v[176:191], a[152:155], v[96:99], v[176:191]
ds_read_b64_tr_b16 a[148:149], v21 offset:35328
ds_read_b64_tr_b16 a[150:151], v21 offset:36352
v_mfma_f32_32x32x16_bf16 v[192:207], a[156:159], v[96:99], v[192:207]
L_slot18:
s_waitcnt vmcnt(14)
s_barrier
s_add_u32 s100, s12, 22528
buffer_store_dword a255, v253, s[72:75], s100 offen sc1
ds_read_b64_tr_b16 a[152:153], v16 offset:12288
ds_read_b64_tr_b16 a[154:155], v16 offset:12544
s_waitcnt lgkmcnt(6)
v_mfma_f32_32x32x16_bf16 v[176:191], a[160:163], v[100:103], v[176:191]
ds_read_b64_tr_b16 a[156:157], v16 offset:12800
ds_read_b64_tr_b16 a[158:159], v16 offset:13056
buffer_load_dwordx4 a[8:11], v26, s[72:75], s98 offen offset:2048 sc1
s_add_u32 s32, s19, 128
s_add_u32 m0, s29, 98304
v_mfma_f32_32x32x16_bf16 v[192:207], a[164:167], v[100:103], v[192:207]
ds_read_b64_tr_b16 a[160:161], v16 offset:14336
ds_read_b64_tr_b16 a[162:163], v16 offset:14592
v_mfma_f32_32x32x16_bf16 v[176:191], a[168:171], v[104:107], v[176:191]
ds_read_b64_tr_b16 a[164:165], v16 offset:14848
ds_read_b64_tr_b16 a[166:167], v16 offset:15104
buffer_load_dwordx4 a[12:15], v26, s[72:75], s98 offen offset:3072 sc1
s_add_u32 s98, s101, 4096
v_mfma_f32_32x32x16_bf16 v[192:207], a[172:175], v[104:107], v[192:207]
ds_read_b64_tr_b16 a[168:169], v16 offset:16384
ds_read_b64_tr_b16 a[170:171], v16 offset:16640
s_waitcnt lgkmcnt(6)
v_mfma_f32_32x32x16_bf16 v[176:191], a[144:147], v[108:111], v[176:191]
ds_read_b64_tr_b16 a[172:173], v16 offset:16896
ds_read_b64_tr_b16 a[174:175], v16 offset:17152
v_mfma_f32_32x32x16_bf16 v[192:207], a[148:151], v[108:111], v[192:207]
ds_read_b64_tr_b16 a[144:145], v16 offset:18432
ds_read_b64_tr_b16 a[146:147], v16 offset:18688
buffer_load_dwordx4 v7, s[60:63], s32 offen offset:0 lds
v_mfma_f32_32x32x16_bf16 v[208:223], a[152:155], a[176:179], v[208:223]
ds_read_b64_tr_b16 a[148:149], v16 offset:18944
ds_read_b64_tr_b16 a[150:151], v16 offset:19200
v_mfma_f32_32x32x16_bf16 v[224:239], a[156:159], a[176:179], v[224:239]
ds_read_b64_tr_b16 a[152:153], v22 offset:20480
ds_read_b64_tr_b16 a[154:155], v22 offset:21504
s_waitcnt lgkmcnt(6)
v_mfma_f32_32x32x16_bf16 v[208:223], a[160:163], a[180:183], v[208:223]
ds_read_b64_tr_b16 a[156:157], v22 offset:20992
ds_read_b64_tr_b16 a[158:159], v22 offset:22016
buffer_load_dwordx4 a[16:19], v26, s[72:75], s98 offen offset:0 sc1
v_mfma_f32_32x32x16_bf16 v[224:239], a[164:167], a[180:183], v[224:239]
ds_read_b64_tr_b16 a[160:161], v19 offset:0
ds_read_b64_tr_b16 a[162:163], v19 offset:1024
v_mfma_f32_32x32x16_bf16 v[208:223], a[168:171], a[184:187], v[208:223]
ds_read_b64_tr_b16 a[164:165], v19 offset:512
ds_read_b64_tr_b16 a[166:167], v19 offset:1536
buffer_load_dwordx4 v8, s[60:63], s32 offen offset:1024 lds
v_mfma_f32_32x32x16_bf16 v[224:239], a[172:175], a[184:187], v[224:239]
ds_read_b64_tr_b16 a[168:169], v19 offset:2048
ds_read_b64_tr_b16 a[170:171], v19 offset:3072
s_waitcnt lgkmcnt(6)
v_mfma_f32_32x32x16_bf16 v[208:223], a[144:147], a[188:191], v[208:223]
ds_read_b64_tr_b16 a[172:173], v19 offset:2560
ds_read_b64_tr_b16 a[174:175], v19 offset:3584
buffer_load_dwordx4 v9, s[60:63], s32 offen offset:2048 lds
v_mfma_f32_32x32x16_bf16 v[224:239], a[148:151], a[188:191], v[224:239]
ds_read_b64_tr_b16 a[144:145], v19 offset:4096
ds_read_b64_tr_b16 a[146:147], v19 offset:5120
v_mfma_f32_32x32x16_bf16 v[208:223], a[152:155], a[192:195], v[208:223]
ds_read_b64_tr_b16 a[148:149], v19 offset:4608
ds_read_b64_tr_b16 a[150:151], v19 offset:5632
buffer_load_dwordx4 v10, s[60:63], s32 offen offset:3072 lds
s_add_u32 m0, s29, 102400
v_mfma_f32_32x32x16_bf16 v[224:239], a[156:159], a[192:195], v[224:239]
ds_read_b64_tr_b16 a[152:153], v19 offset:6144
ds_read_b64_tr_b16 a[154:155], v19 offset:7168
s_waitcnt lgkmcnt(6)
v_mfma_f32_32x32x16_bf16 v[208:223], a[160:163], v[88:91], v[208:223]
ds_read_b64_tr_b16 a[156:157], v19 offset:6656
ds_read_b64_tr_b16 a[158:159], v19 offset:7680
buffer_load_dwordx4 v11, s[60:63], s32 offen offset:0 lds
v_mfma_f32_32x32x16_bf16 v[224:239], a[164:167], v[88:91], v[224:239]
ds_read_b64_tr_b16 a[160:161], v19 offset:8192
ds_read_b64_tr_b16 a[162:163], v19 offset:9216
v_mfma_f32_32x32x16_bf16 v[208:223], a[168:171], v[92:95], v[208:223]
ds_read_b64_tr_b16 a[164:165], v19 offset:8704
ds_read_b64_tr_b16 a[166:167], v19 offset:9728
buffer_load_dwordx4 v12, s[60:63], s32 offen offset:1024 lds
v_mfma_f32_32x32x16_bf16 v[224:239], a[172:175], v[92:95], v[224:239]
ds_read_b64_tr_b16 a[168:169], v19 offset:10240
ds_read_b64_tr_b16 a[170:171], v19 offset:11264
s_waitcnt lgkmcnt(6)
v_mfma_f32_32x32x16_bf16 v[208:223], a[144:147], v[96:99], v[208:223]
ds_read_b64_tr_b16 a[172:173], v19 offset:10752
ds_read_b64_tr_b16 a[174:175], v19 offset:11776
v_mfma_f32_32x32x16_bf16 v[224:239], a[148:151], v[96:99], v[224:239]
L_slot19:
s_barrier
ds_read_b64_tr_b16 a[144:145], v16 offset:36864
ds_read_b64_tr_b16 a[146:147], v16 offset:37120
v_mfma_f32_32x32x16_bf16 v[208:223], a[152:155], v[100:103], v[208:223]
ds_read_b64_tr_b16 a[148:149], v16 offset:37376
ds_read_b64_tr_b16 a[150:151], v16 offset:37632
buffer_load_dwordx4 a[20:23], v26, s[72:75], s98 offen offset:1024 sc1
s_add_u32 s32, s19, 256
s_add_u32 m0, s29, 122880
v_mfma_f32_32x32x16_bf16 v[224:239], a[156:159], v[100:103], v[224:239]
ds_read_b64_tr_b16 a[152:153], v16 offset:38912
ds_read_b64_tr_b16 a[154:155], v16 offset:39168
s_waitcnt lgkmcnt(6)
v_mfma_f32_32x32x16_bf16 v[208:223], a[160:163], v[104:107], v[208:223]
ds_read_b64_tr_b16 a[156:157], v16 offset:39424
ds_read_b64_tr_b16 a[158:159], v16 offset:39680
buffer_load_dwordx4 a[24:27], v26, s[72:75], s98 offen offset:2048 sc1
v_mfma_f32_32x32x16_bf16 v[224:239], a[164:167], v[104:107], v[224:239]
ds_read_b64_tr_b16 a[160:161], v16 offset:40960
ds_read_b64_tr_b16 a[162:163], v16 offset:41216
v_mfma_f32_32x32x16_bf16 v[208:223], a[168:171], v[108:111], v[208:223]
ds_read_b64_tr_b16 a[164:165], v16 offset:41472
ds_read_b64_tr_b16 a[166:167], v16 offset:41728
v_mfma_f32_32x32x16_bf16 v[224:239], a[172:175], v[108:111], v[224:239]
ds_read_b64_tr_b16 a[168:169], v16 offset:43008
ds_read_b64_tr_b16 a[170:171], v16 offset:43264
buffer_load_dwordx4 a[28:31], v26, s[72:75], s98 offen offset:3072 sc1
s_add_u32 s98, s101, 8192
s_waitcnt lgkmcnt(6)
v_mfma_f32_32x32x16_bf16 v[144:159], a[144:147], a[176:179], v[144:159]
ds_read_b64_tr_b16 a[172:173], v16 offset:43520
ds_read_b64_tr_b16 a[174:175], v16 offset:43776
v_mfma_f32_32x32x16_bf16 v[160:175], a[148:151], a[176:179], v[160:175]
ds_read_b64_tr_b16 a[144:145], v22 offset:45056
ds_read_b64_tr_b16 a[146:147], v22 offset:46080
v_mfma_f32_32x32x16_bf16 v[144:159], a[152:155], a[180:183], v[144:159]
ds_read_b64_tr_b16 a[148:149], v22 offset:45568
ds_read_b64_tr_b16 a[150:151], v22 offset:46592
buffer_load_dwordx4 v7, s[60:63], s32 offen offset:0 lds
v_mfma_f32_32x32x16_bf16 v[160:175], a[156:159], a[180:183], v[160:175]
ds_read_b64_tr_b16 a[152:153], v19 offset:24576
ds_read_b64_tr_b16 a[154:155], v19 offset:25600
s_waitcnt lgkmcnt(6)
v_mfma_f32_32x32x16_bf16 v[144:159], a[160:163], a[184:187], v[144:159]
ds_read_b64_tr_b16 a[156:157], v19 offset:25088
ds_read_b64_tr_b16 a[158:159], v19 offset:26112
buffer_load_dwordx4 v8, s[60:63], s32 offen offset:1024 lds
v_mfma_f32_32x32x16_bf16 v[160:175], a[164:167], a[184:187], v[160:175]
ds_read_b64_tr_b16 a[160:161], v19 offset:26624
ds_read_b64_tr_b16 a[162:163], v19 offset:27648
v_mfma_f32_32x32x16_bf16 v[144:159], a[168:171], a[188:191], v[144:159]
ds_read_b64_tr_b16 a[164:165], v19 offset:27136
ds_read_b64_tr_b16 a[166:167], v19 offset:28160
buffer_load_dwordx4 v9, s[60:63], s32 offen offset:2048 lds
v_mfma_f32_32x32x16_bf16 v[160:175], a[172:175], a[188:191], v[160:175]
ds_read_b64_tr_b16 a[168:169], v19 offset:28672
ds_read_b64_tr_b16 a[170:171], v19 offset:29696
s_waitcnt lgkmcnt(6)
v_mfma_f32_32x32x16_bf16 v[144:159], a[144:147], a[192:195], v[144:159]
ds_read_b64_tr_b16 a[172:173], v19 offset:29184
ds_read_b64_tr_b16 a[174:175], v19 offset:30208
buffer_load_dwordx4 v10, s[60:63], s32 offen offset:3072 lds
s_add_u32 m0, s29, 126976
v_mfma_f32_32x32x16_bf16 v[160:175], a[148:151], a[192:195], v[160:175]
ds_read_b64_tr_b16 a[144:145], v19 offset:30720
ds_read_b64_tr_b16 a[146:147], v19 offset:31744
v_mfma_f32_32x32x16_bf16 v[144:159], a[152:155], v[88:91], v[144:159]
ds_read_b64_tr_b16 a[148:149], v19 offset:31232
ds_read_b64_tr_b16 a[150:151], v19 offset:32256
buffer_load_dwordx4 v11, s[60:63], s32 offen offset:0 lds
v_mfma_f32_32x32x16_bf16 v[160:175], a[156:159], v[88:91], v[160:175]
ds_read_b64_tr_b16 a[152:153], v19 offset:32768
ds_read_b64_tr_b16 a[154:155], v19 offset:33792
s_waitcnt lgkmcnt(6)
v_mfma_f32_32x32x16_bf16 v[144:159], a[160:163], v[92:95], v[144:159]
ds_read_b64_tr_b16 a[156:157], v19 offset:33280
ds_read_b64_tr_b16 a[158:159], v19 offset:34304
buffer_load_dwordx4 v12, s[60:63], s32 offen offset:1024 lds
v_mfma_f32_32x32x16_bf16 v[160:175], a[164:167], v[92:95], v[160:175]
ds_read_b64_tr_b16 a[160:161], v19 offset:34816
ds_read_b64_tr_b16 a[162:163], v19 offset:35840
v_mfma_f32_32x32x16_bf16 v[144:159], a[168:171], v[96:99], v[144:159]
ds_read_b64_tr_b16 a[164:165], v19 offset:35328
ds_read_b64_tr_b16 a[166:167], v19 offset:36352
v_mfma_f32_32x32x16_bf16 v[160:175], a[172:175], v[96:99], v[160:175]
L_slot20:
s_waitcnt vmcnt(27)
s_barrier
ds_read_b64_tr_b16 a[168:169], v20 offset:0
ds_read_b64_tr_b16 a[170:171], v20 offset:512
s_waitcnt lgkmcnt(6)
v_mfma_f32_32x32x16_bf16 v[144:159], a[144:147], v[100:103], v[144:159]
ds_read_b64_tr_b16 a[172:173], v20 offset:1024
ds_read_b64_tr_b16 a[174:175], v20 offset:1536
buffer_load_dwordx4 a[32:35], v26, s[72:75], s98 offen offset:0 sc1
s_add_u32 m0, s30, 0
s_add_u32 s32, s23, 0
v_mfma_f32_32x32x16_bf16 v[160:175], a[148:151], v[100:103], v[160:175]
ds_read_b64_tr_b16 a[144:145], v20 offset:2048
ds_read_b64_tr_b16 a[146:147], v20 offset:2560
v_mfma_f32_32x32x16_bf16 v[144:159], a[152:155], v[104:107], v[144:159]
ds_read_b64_tr_b16 a[148:149], v20 offset:3072
ds_read_b64_tr_b16 a[150:151], v20 offset:3584
buffer_load_dwordx4 a[36:39], v26, s[72:75], s98 offen offset:1024 sc1
v_mfma_f32_32x32x16_bf16 v[160:175], a[156:159], v[104:107], v[160:175]
ds_read_b64_tr_b16 a[152:153], v20 offset:4096
ds_read_b64_tr_b16 a[154:155], v20 offset:4608
s_waitcnt lgkmcnt(6)
v_mfma_f32_32x32x16_bf16 v[144:159], a[160:163], v[108:111], v[144:159]
ds_read_b64_tr_b16 a[156:157], v20 offset:5120
ds_read_b64_tr_b16 a[158:159], v20 offset:5632
buffer_load_dwordx4 a[40:43], v26, s[72:75], s98 offen offset:2048 sc1
v_mfma_f32_32x32x16_bf16 v[160:175], a[164:167], v[108:111], v[160:175]
ds_read_b64_tr_b16 a[160:161], v20 offset:6144
ds_read_b64_tr_b16 a[162:163], v20 offset:6656
v_mfma_f32_32x32x16_bf16 v[112:127], a[168:171], v[40:43], 0
ds_read_b64_tr_b16 a[164:165], v20 offset:7168
ds_read_b64_tr_b16 a[166:167], v20 offset:7680
buffer_load_dwordx4 a[44:47], v26, s[72:75], s98 offen offset:3072 sc1
v_mfma_f32_32x32x16_bf16 v[112:127], a[172:175], v[44:47], v[112:127]
ds_read_b64_tr_b16 a[168:169], v20 offset:8192
ds_read_b64_tr_b16 a[170:171], v20 offset:8704
s_waitcnt lgkmcnt(6)
v_mfma_f32_32x32x16_bf16 v[112:127], a[144:147], v[48:51], v[112:127]
ds_read_b64_tr_b16 a[172:173], v20 offset:9216
ds_read_b64_tr_b16 a[174:175], v20 offset:9728
s_movk_i32 s100, 22528
v_mfma_f32_32x32x16_bf16 v[112:127], a[148:151], v[52:55], v[112:127]
ds_read_b64_tr_b16 a[144:145], v20 offset:10240
ds_read_b64_tr_b16 a[146:147], v20 offset:10752
buffer_load_dword v39, v30, s[72:75], s100 offen sc1
v_mfma_f32_32x32x16_bf16 v[112:127], a[152:155], v[56:59], v[112:127]
ds_read_b64_tr_b16 a[148:149], v20 offset:11264
ds_read_b64_tr_b16 a[150:151], v20 offset:11776
v_mfma_f32_32x32x16_bf16 v[112:127], a[156:159], v[60:63], v[112:127]
ds_read_b64_tr_b16 a[152:153], v20 offset:12288
ds_read_b64_tr_b16 a[154:155], v20 offset:12800
s_waitcnt lgkmcnt(6)
v_mfma_f32_32x32x16_bf16 v[112:127], a[160:163], v[64:67], v[112:127]
ds_read_b64_tr_b16 a[156:157], v20 offset:13312
ds_read_b64_tr_b16 a[158:159], v20 offset:13824
buffer_load_dwordx4 v14, s[60:63], s32 offen offset:0 lds
s_add_u32 s32, s24, 0
v_mfma_f32_32x32x16_bf16 v[112:127], a[164:167], v[68:71], v[112:127]
ds_read_b64_tr_b16 a[160:161], v20 offset:14336
ds_read_b64_tr_b16 a[162:163], v20 offset:14848
v_mfma_f32_32x32x16_bf16 v[112:127], a[168:171], v[72:75], v[112:127]
ds_read_b64_tr_b16 a[164:165], v20 offset:15360
ds_read_b64_tr_b16 a[166:167], v20 offset:15872
buffer_load_dwordx4 v14, s[60:63], s32 offen offset:1024 lds
s_add_u32 s32, s25, 0
v_mfma_f32_32x32x16_bf16 v[112:127], a[172:175], v[76:79], v[112:127]
ds_read_b64_tr_b16 a[168:169], v20 offset:16384
ds_read_b64_tr_b16 a[170:171], v20 offset:16896
s_waitcnt lgkmcnt(6)
v_mfma_f32_32x32x16_bf16 v[112:127], a[144:147], v[80:83], v[112:127]
ds_read_b64_tr_b16 a[172:173], v20 offset:17408
ds_read_b64_tr_b16 a[174:175], v20 offset:17920
v_mfma_f32_32x32x16_bf16 v[112:127], a[148:151], v[84:87], v[112:127]
ds_read_b64_tr_b16 a[144:145], v31 offset:18432
ds_read_b64_tr_b16 a[146:147], v31 offset:18688
buffer_load_dwordx4 v14, s[60:63], s32 offen offset:2048 lds
v_mfma_f32_32x32x16_bf16 v[112:127], a[152:155], v[88:91], v[112:127]
ds_read_b64_tr_b16 a[148:149], v31 offset:19456
ds_read_b64_tr_b16 a[150:151], v31 offset:19712
v_mfma_f32_32x32x16_bf16 v[112:127], a[156:159], v[92:95], v[112:127]
ds_read_b64_tr_b16 a[152:153], v31 offset:20480
ds_read_b64_tr_b16 a[154:155], v31 offset:20736
s_waitcnt lgkmcnt(6)
v_mfma_f32_32x32x16_bf16 v[112:127], a[160:163], v[96:99], v[112:127]
ds_read_b64_tr_b16 a[156:157], v31 offset:21504
ds_read_b64_tr_b16 a[158:159], v31 offset:21760
v_mfma_f32_32x32x16_bf16 v[112:127], a[164:167], v[100:103], v[112:127]
ds_read_b64_tr_b16 a[160:161], v23 offset:22528
ds_read_b64_tr_b16 a[162:163], v23 offset:23552
v_mfma_f32_32x32x16_bf16 v[112:127], a[168:171], v[104:107], v[112:127]
L_slot21:
s_waitcnt vmcnt(27)
s_barrier
ds_read_b64_tr_b16 a[164:165], v20 offset:24576
ds_read_b64_tr_b16 a[166:167], v20 offset:25600
v_mfma_f32_32x32x16_bf16 v[112:127], a[172:175], v[108:111], v[112:127]
ds_read_b64_tr_b16 a[168:169], v20 offset:25088
ds_read_b64_tr_b16 a[170:171], v20 offset:26112
s_add_u32 m0, s30, 24576
s_add_u32 s32, s23, 128
s_waitcnt lgkmcnt(6)
v_mfma_f32_32x32x16_bf16 v[112:127], a[144:147], a[176:179], v[112:127]
ds_read_b64_tr_b16 a[172:173], v20 offset:26624
ds_read_b64_tr_b16 a[174:175], v20 offset:27648
buffer_load_dwordx4 v14, s[60:63], s32 offen offset:0 lds
s_add_u32 s32, s24, 128
v_mfma_f32_32x32x16_bf16 v[112:127], a[148:151], a[180:183], v[112:127]
ds_read_b64_tr_b16 a[144:145], v20 offset:27136
ds_read_b64_tr_b16 a[146:147], v20 offset:28160
v_mfma_f32_32x32x16_bf16 v[112:127], a[152:155], a[184:187], v[112:127]
ds_read_b64_tr_b16 a[148:149], v20 offset:28672
ds_read_b64_tr_b16 a[150:151], v20 offset:29696
buffer_load_dwordx4 v14, s[60:63], s32 offen offset:1024 lds
s_add_u32 s32, s25, 128
v_mfma_f32_32x32x16_bf16 v[112:127], a[156:159], a[188:191], v[112:127]
ds_read_b64_tr_b16 a[152:153], v20 offset:29184
ds_read_b64_tr_b16 a[154:155], v20 offset:30208
s_waitcnt lgkmcnt(6)
v_mfma_f32_32x32x16_bf16 v[112:127], a[160:163], a[192:195], v[112:127]
ds_read_b64_tr_b16 a[156:157], v20 offset:30720
ds_read_b64_tr_b16 a[158:159], v20 offset:31744
v_mfma_f32_32x32x16_bf16 v[176:191], a[164:167], a[0:3], v[176:191]
ds_read_b64_tr_b16 a[160:161], v20 offset:31232
ds_read_b64_tr_b16 a[162:163], v20 offset:32256
buffer_load_dwordx4 v14, s[60:63], s32 offen offset:2048 lds
v_mfma_f32_32x32x16_bf16 v[192:207], a[168:171], a[0:3], v[192:207]
ds_read_b64_tr_b16 a[164:165], v20 offset:32768
ds_read_b64_tr_b16 a[166:167], v20 offset:33792
v_mfma_f32_32x32x16_bf16 v[176:191], a[172:175], a[4:7], v[176:191]
ds_read_b64_tr_b16 a[168:169], v20 offset:33280
ds_read_b64_tr_b16 a[170:171], v20 offset:34304
s_waitcnt lgkmcnt(6)
v_mfma_f32_32x32x16_bf16 v[192:207], a[144:147], a[4:7], v[192:207]
ds_read_b64_tr_b16 a[172:173], v20 offset:34816
ds_read_b64_tr_b16 a[174:175], v20 offset:35840
s_waitcnt vmcnt(28)
v_mfma_f32_32x32x16_bf16 v[176:191], a[148:151], a[8:11], v[176:191]
ds_read_b64_tr_b16 a[144:145], v20 offset:35328
ds_read_b64_tr_b16 a[146:147], v20 offset:36352
v_mfma_f32_32x32x16_bf16 v[192:207], a[152:155], a[8:11], v[192:207]
ds_read_b64_tr_b16 a[148:149], v20 offset:36864
ds_read_b64_tr_b16 a[150:151], v20 offset:37888
s_waitcnt vmcnt(27)
v_mfma_f32_32x32x16_bf16 v[176:191], a[156:159], a[12:15], v[176:191]
ds_read_b64_tr_b16 a[152:153], v20 offset:37376
ds_read_b64_tr_b16 a[154:155], v20 offset:38400
s_waitcnt lgkmcnt(6)
v_mfma_f32_32x32x16_bf16 v[192:207], a[160:163], a[12:15], v[192:207]
ds_read_b64_tr_b16 a[156:157], v20 offset:38912
ds_read_b64_tr_b16 a[158:159], v20 offset:39936
s_waitcnt vmcnt(25)
v_mfma_f32_32x32x16_bf16 v[176:191], a[164:167], a[16:19], v[176:191]
ds_read_b64_tr_b16 a[160:161], v20 offset:39424
ds_read_b64_tr_b16 a[162:163], v20 offset:40448
v_mfma_f32_32x32x16_bf16 v[192:207], a[168:171], a[16:19], v[192:207]
ds_read_b64_tr_b16 a[164:165], v20 offset:40960
ds_read_b64_tr_b16 a[166:167], v20 offset:41984
s_waitcnt vmcnt(19)
v_mfma_f32_32x32x16_bf16 v[176:191], a[172:175], a[20:23], v[176:191]
ds_read_b64_tr_b16 a[168:169], v20 offset:41472
ds_read_b64_tr_b16 a[170:171], v20 offset:42496
s_waitcnt lgkmcnt(6)
v_mfma_f32_32x32x16_bf16 v[192:207], a[144:147], a[20:23], v[192:207]
ds_read_b64_tr_b16 a[172:173], v20 offset:43008
ds_read_b64_tr_b16 a[174:175], v20 offset:44032
s_waitcnt vmcnt(18)
v_mfma_f32_32x32x16_bf16 v[176:191], a[148:151], a[24:27], v[176:191]
ds_read_b64_tr_b16 a[144:145], v20 offset:43520
ds_read_b64_tr_b16 a[146:147], v20 offset:44544
v_mfma_f32_32x32x16_bf16 v[192:207], a[152:155], a[24:27], v[192:207]
ds_read_b64_tr_b16 a[148:149], v20 offset:45056
ds_read_b64_tr_b16 a[150:151], v20 offset:46080
s_waitcnt vmcnt(17)
v_mfma_f32_32x32x16_bf16 v[176:191], a[156:159], a[28:31], v[176:191]
ds_read_b64_tr_b16 a[152:153], v20 offset:45568
ds_read_b64_tr_b16 a[154:155], v20 offset:46592
s_waitcnt lgkmcnt(6)
v_mfma_f32_32x32x16_bf16 v[192:207], a[160:163], a[28:31], v[192:207]
ds_read_b64_tr_b16 a[156:157], v20 offset:47104
ds_read_b64_tr_b16 a[158:159], v20 offset:48128
s_waitcnt vmcnt(10)
v_mfma_f32_32x32x16_bf16 v[176:191], a[164:167], a[32:35], v[176:191]
ds_read_b64_tr_b16 a[160:161], v20 offset:47616
ds_read_b64_tr_b16 a[162:163], v20 offset:48640
v_mfma_f32_32x32x16_bf16 v[192:207], a[168:171], a[32:35], v[192:207]
L_slot22:
s_barrier
ds_read_b64_tr_b16 a[164:165], v21 offset:0
ds_read_b64_tr_b16 a[166:167], v21 offset:1024
s_waitcnt vmcnt(9)
v_mfma_f32_32x32x16_bf16 v[176:191], a[172:175], a[36:39], v[176:191]
ds_read_b64_tr_b16 a[168:169], v21 offset:512
ds_read_b64_tr_b16 a[170:171], v21 offset:1536
s_add_u32 m0, s30, 49152
s_add_u32 s32, s23, 256
s_waitcnt lgkmcnt(6)
v_mfma_f32_32x32x16_bf16 v[192:207], a[144:147], a[36:39], v[192:207]
ds_read_b64_tr_b16 a[172:173], v21 offset:2048
ds_read_b64_tr_b16 a[174:175], v21 offset:3072
buffer_load_dwordx4 v14, s[60:63], s32 offen offset:0 lds
s_waitcnt vmcnt(7)
v_cmp_ne_u32 vcc, s6, v39
s_cbranch_vccz L_ok_17
s_movk_i32 s100, 22528
s_mov_b32 s96, 0
L_spin_18:
buffer_load_dword v39, v30, s[72:75], s100 offen sc1
s_waitcnt vmcnt(0)
v_cmp_ne_u32 vcc, s6, v39
s_cbranch_vccz L_spun_19
s_add_u32 s96, s96, 1
s_cmp_lt_u32 s96, 262144
s_sleep 1
s_cbranch_scc1 L_spin_18
v_mov_b32 v39, 105
buffer_store_dword v39, v253, s[80:83], 0 offen
s_waitcnt vmcnt(0)
L_spun_19:
s_nop 0
L_ok_17:
v_mfma_f32_32x32x16_bf16 v[176:191], a[148:151], a[40:43], v[176:191]
ds_read_b64_tr_b16 a[144:145], v21 offset:2560
ds_read_b64_tr_b16 a[146:147], v21 offset:3584
s_add_u32 s32, s24, 256
s_add_u32 s98, s101, 12288
v_mfma_f32_32x32x16_bf16 v[192:207], a[152:155], a[40:43], v[192:207]
ds_read_b64_tr_b16 a[148:149], v21 offset:4096
ds_read_b64_tr_b16 a[150:151], v21 offset:5120
buffer_load_dwordx4 v14, s[60:63], s32 offen offset:1024 lds
s_add_u32 s32, s25, 256
v_mfma_f32_32x32x16_bf16 v[176:191], a[156:159], a[44:47], v[176:191]
ds_read_b64_tr_b16 a[152:153], v21 offset:4608
ds_read_b64_tr_b16 a[154:155], v21 offset:5632
s_waitcnt lgkmcnt(6)
v_mfma_f32_32x32x16_bf16 v[192:207], a[160:163], a[44:47], v[192:207]
ds_read_b64_tr_b16 a[156:157], v21 offset:6144
ds_read_b64_tr_b16 a[158:159], v21 offset:7168
v_mfma_f32_32x32x16_bf16 v[208:223], a[164:167], a[0:3], v[208:223]
ds_read_b64_tr_b16 a[160:161], v21 offset:6656
ds_read_b64_tr_b16 a[162:163], v21 offset:7680
buffer_load_dwordx4 a[48:51], v26, s[72:75], s98 offen offset:0 sc1
v_mfma_f32_32x32x16_bf16 v[224:239], a[168:171], a[0:3], v[224:239]
ds_read_b64_tr_b16 a[164:165], v21 offset:8192
ds_read_b64_tr_b16 a[166:167], v21 offset:9216
v_mfma_f32_32x32x16_bf16 v[208:223], a[172:175], a[4:7], v[208:223]
ds_read_b64_tr_b16 a[168:169], v21 offset:8704
ds_read_b64_tr_b16 a[170:171], v21 offset:9728
s_waitcnt lgkmcnt(6)
v_mfma_f32_32x32x16_bf16 v[224:239], a[144:147], a[4:7], v[224:239]
ds_read_b64_tr_b16 a[172:173], v21 offset:10240
ds_read_b64_tr_b16 a[174:175], v21 offset:11264
buffer_load_dwordx4 a[52:55], v26, s[72:75], s98 offen offset:1024 sc1
v_mfma_f32_32x32x16_bf16 v[208:223], a[148:151], a[8:11], v[208:223]
ds_read_b64_tr_b16 a[144:145], v21 offset:10752
ds_read_b64_tr_b16 a[146:147], v21 offset:11776
v_mfma_f32_32x32x16_bf16 v[224:239], a[152:155], a[8:11], v[224:239]
ds_read_b64_tr_b16 a[148:149], v21 offset:12288
ds_read_b64_tr_b16 a[150:151], v21 offset:13312
buffer_load_dwordx4 v14, s[60:63], s32 offen offset:2048 lds
v_mfma_f32_32x32x16_bf16 v[208:223], a[156:159], a[12:15], v[208:223]
ds_read_b64_tr_b16 a[152:153], v21 offset:12800
ds_read_b64_tr_b16 a[154:155], v21 offset:13824
s_waitcnt lgkmcnt(6)
v_mfma_f32_32x32x16_bf16 v[224:239], a[160:163], a[12:15], v[224:239]
ds_read_b64_tr_b16 a[156:157], v21 offset:14336
ds_read_b64_tr_b16 a[158:159], v21 offset:15360
v_mfma_f32_32x32x16_bf16 v[208:223], a[164:167], a[16:19], v[208:223]
ds_read_b64_tr_b16 a[160:161], v21 offset:14848
ds_read_b64_tr_b16 a[162:163], v21 offset:15872
buffer_load_dwordx4 a[56:59], v26, s[72:75], s98 offen offset:2048 sc1
v_mfma_f32_32x32x16_bf16 v[224:239], a[168:171], a[16:19], v[224:239]
ds_read_b64_tr_b16 a[164:165], v21 offset:16384
ds_read_b64_tr_b16 a[166:167], v21 offset:17408
v_mfma_f32_32x32x16_bf16 v[208:223], a[172:175], a[20:23], v[208:223]
ds_read_b64_tr_b16 a[168:169], v21 offset:16896
ds_read_b64_tr_b16 a[170:171], v21 offset:17920
s_waitcnt lgkmcnt(6)
v_mfma_f32_32x32x16_bf16 v[224:239], a[144:147], a[20:23], v[224:239]
ds_read_b64_tr_b16 a[172:173], v21 offset:18432
ds_read_b64_tr_b16 a[174:175], v21 offset:19456
buffer_load_dwordx4 a[60:63], v26, s[72:75], s98 offen offset:3072 sc1
v_mfma_f32_32x32x16_bf16 v[208:223], a[148:151], a[24:27], v[208:223]
ds_read_b64_tr_b16 a[144:145], v21 offset:18944
ds_read_b64_tr_b16 a[146:147], v21 offset:19968
v_mfma_f32_32x32x16_bf16 v[224:239], a[152:155], a[24:27], v[224:239]
ds_read_b64_tr_b16 a[148:149], v21 offset:20480
ds_read_b64_tr_b16 a[150:151], v21 offset:21504
v_mfma_f32_32x32x16_bf16 v[208:223], a[156:159], a[28:31], v[208:223]
ds_read_b64_tr_b16 a[152:153], v21 offset:20992
ds_read_b64_tr_b16 a[154:155], v21 offset:22016
s_add_u32 s98, s101, 16384
s_waitcnt lgkmcnt(6)
v_mfma_f32_32x32x16_bf16 v[224:239], a[160:163], a[28:31], v[224:239]
ds_read_b64_tr_b16 a[156:157], v21 offset:22528
ds_read_b64_tr_b16 a[158:159], v21 offset:23552
v_mfma_f32_32x32x16_bf16 v[208:223], a[164:167], a[32:35], v[208:223]
ds_read_b64_tr_b16 a[160:161], v21 offset:23040
ds_read_b64_tr_b16 a[162:163], v21 offset:24064
v_mfma_f32_32x32x16_bf16 v[224:239], a[168:171], a[32:35], v[224:239]
L_slot23:
s_barrier
ds_read_b64_tr_b16 a[164:165], v21 offset:24576
ds_read_b64_tr_b16 a[166:167], v21 offset:25600
buffer_load_dwordx4 a[64:67], v26, s[72:75], s98 offen offset:0 sc1
v_mfma_f32_32x32x16_bf16 v[208:223], a[172:175], a[36:39], v[208:223]
ds_read_b64_tr_b16 a[168:169], v21 offset:25088
ds_read_b64_tr_b16 a[170:171], v21 offset:26112
s_add_u32 s32, s18, 384
s_add_u32 m0, s29, 73728
s_waitcnt lgkmcnt(6)
v_mfma_f32_32x32x16_bf16 v[224:239], a[144:147], a[36:39], v[224:239]
ds_read_b64_tr_b16 a[172:173], v21 offset:26624
ds_read_b64_tr_b16 a[174:175], v21 offset:27648
buffer_load_dwordx4 v7, s[60:63], s32 offen offset:0 lds
v_mfma_f32_32x32x16_bf16 v[208:223], a[148:151], a[40:43], v[208:223]
ds_read_b64_tr_b16 a[144:145], v21 offset:27136
ds_read_b64_tr_b16 a[146:147], v21 offset:28160
v_mfma_f32_32x32x16_bf16 v[224:239], a[152:155], a[40:43], v[224:239]
ds_read_b64_tr_b16 a[148:149], v21 offset:28672
ds_read_b64_tr_b16 a[150:151], v21 offset:29696
v_mfma_f32_32x32x16_bf16 v[208:223], a[156:159], a[44:47], v[208:223]
ds_read_b64_tr_b16 a[152:153], v21 offset:29184
ds_read_b64_tr_b16 a[154:155], v21 offset:30208
buffer_load_dwordx4 a[68:71], v26, s[72:75], s98 offen offset:1024 sc1
s_waitcnt lgkmcnt(6)
v_mfma_f32_32x32x16_bf16 v[224:239], a[160:163], a[44:47], v[224:239]
ds_read_b64_tr_b16 a[156:157], v21 offset:30720
ds_read_b64_tr_b16 a[158:159], v21 offset:31744
v_mfma_f32_32x32x16_bf16 v[144:159], a[164:167], a[0:3], v[144:159]
ds_read_b64_tr_b16 a[160:161], v21 offset:31232
ds_read_b64_tr_b16 a[162:163], v21 offset:32256
v_mfma_f32_32x32x16_bf16 v[160:175], a[168:171], a[0:3], v[160:175]
ds_read_b64_tr_b16 a[164:165], v21 offset:32768
ds_read_b64_tr_b16 a[166:167], v21 offset:33792
buffer_load_dwordx4 v8, s[60:63], s32 offen offset:1024 lds
v_mfma_f32_32x32x16_bf16 v[144:159], a[172:175], a[4:7], v[144:159]
ds_read_b64_tr_b16 a[168:169], v21 offset:33280
ds_read_b64_tr_b16 a[170:171], v21 offset:34304
s_waitcnt lgkmcnt(6)
v_mfma_f32_32x32x16_bf16 v[160:175], a[144:147], a[4:7], v[160:175]
ds_read_b64_tr_b16 a[172:173], v21 offset:34816
ds_read_b64_tr_b16 a[174:175], v21 offset:35840
buffer_load_dwordx4 v9, s[60:63], s32 offen offset:2048 lds
v_mfma_f32_32x32x16_bf16 v[144:159], a[148:151], a[8:11], v[144:159]
ds_read_b64_tr_b16 a[144:145], v21 offset:35328
ds_read_b64_tr_b16 a[146:147], v21 offset:36352
v_mfma_f32_32x32x16_bf16 v[160:175], a[152:155], a[8:11], v[160:175]
ds_read_b64_tr_b16 a[148:149], v21 offset:36864
ds_read_b64_tr_b16 a[150:151], v21 offset:37888
v_mfma_f32_32x32x16_bf16 v[144:159], a[156:159], a[12:15], v[144:159]
ds_read_b64_tr_b16 a[152:153], v21 offset:37376
ds_read_b64_tr_b16 a[154:155], v21 offset:38400
buffer_load_dwordx4 v10, s[60:63], s32 offen offset:3072 lds
s_add_u32 m0, s29, 77824
s_waitcnt lgkmcnt(6)
v_mfma_f32_32x32x16_bf16 v[160:175], a[160:163], a[12:15], v[160:175]
ds_read_b64_tr_b16 a[156:157], v21 offset:38912
ds_read_b64_tr_b16 a[158:159], v21 offset:39936
v_mfma_f32_32x32x16_bf16 v[144:159], a[164:167], a[16:19], v[144:159]
ds_read_b64_tr_b16 a[160:161], v21 offset:39424
ds_read_b64_tr_b16 a[162:163], v21 offset:40448
v_mfma_f32_32x32x16_bf16 v[160:175], a[168:171], a[16:19], v[160:175]
ds_read_b64_tr_b16 a[164:165], v21 offset:40960
ds_read_b64_tr_b16 a[166:167], v21 offset:41984
buffer_load_dwordx4 v11, s[60:63], s32 offen offset:0 lds
v_mfma_f32_32x32x16_bf16 v[144:159], a[172:175], a[20:23], v[144:159]
ds_read_b64_tr_b16 a[168:169], v21 offset:41472
ds_read_b64_tr_b16 a[170:171], v21 offset:42496
s_waitcnt lgkmcnt(6)
v_mfma_f32_32x32x16_bf16 v[160:175], a[144:147], a[20:23], v[160:175]
ds_read_b64_tr_b16 a[172:173], v21 offset:43008
ds_read_b64_tr_b16 a[174:175], v21 offset:44032
buffer_load_dwordx4 v12, s[60:63], s32 offen offset:1024 lds
v_mfma_f32_32x32x16_bf16 v[144:159], a[148:151], a[24:27], v[144:159]
ds_read_b64_tr_b16 a[144:145], v21 offset:43520
ds_read_b64_tr_b16 a[146:147], v21 offset:44544
v_mfma_f32_32x32x16_bf16 v[160:175], a[152:155], a[24:27], v[160:175]
ds_read_b64_tr_b16 a[148:149], v21 offset:45056
ds_read_b64_tr_b16 a[150:151], v21 offset:46080
v_mfma_f32_32x32x16_bf16 v[144:159], a[156:159], a[28:31], v[144:159]
ds_read_b64_tr_b16 a[152:153], v21 offset:45568
ds_read_b64_tr_b16 a[154:155], v21 offset:46592
s_waitcnt lgkmcnt(6)
v_mfma_f32_32x32x16_bf16 v[160:175], a[160:163], a[28:31], v[160:175]
ds_read_b64_tr_b16 a[156:157], v21 offset:47104
ds_read_b64_tr_b16 a[158:159], v21 offset:48128
v_mfma_f32_32x32x16_bf16 v[144:159], a[164:167], a[32:35], v[144:159]
ds_read_b64_tr_b16 a[160:161], v21 offset:47616
ds_read_b64_tr_b16 a[162:163], v21 offset:48640
v_mfma_f32_32x32x16_bf16 v[160:175], a[168:171], a[32:35], v[160:175]
L_slot24:
s_waitcnt vmcnt(18)
s_barrier
ds_read_b64_tr_b16 a[164:165], v19 offset:0
ds_read_b64_tr_b16 a[166:167], v19 offset:1024
v_mfma_f32_32x32x16_bf16 v[144:159], a[172:175], a[36:39], v[144:159]
ds_read_b64_tr_b16 a[168:169], v19 offset:512
ds_read_b64_tr_b16 a[170:171], v19 offset:1536
s_add_u32 m0, s30, 98304
s_add_u32 s32, s20, 384
s_waitcnt lgkmcnt(6)
v_mfma_f32_32x32x16_bf16 v[160:175], a[144:147], a[36:39], v[160:175]
ds_read_b64_tr_b16 a[172:173], v19 offset:2048
ds_read_b64_tr_b16 a[174:175], v19 offset:3072
buffer_load_dwordx4 v14, s[60:63], s32 offen offset:0 lds
s_add_u32 s32, s21, 384
v_mfma_f32_32x32x16_bf16 v[144:159], a[148:151], a[40:43], v[144:159]
ds_read_b64_tr_b16 a[144:145], v19 offset:2560
ds_read_b64_tr_b16 a[146:147], v19 offset:3584
v_mfma_f32_32x32x16_bf16 v[160:175], a[152:155], a[40:43], v[160:175]
ds_read_b64_tr_b16 a[148:149], v19 offset:4096
ds_read_b64_tr_b16 a[150:151], v19 offset:5120
buffer_load_dwordx4 v14, s[60:63], s32 offen offset:1024 lds
s_add_u32 s32, s22, 384
v_mfma_f32_32x32x16_bf16 v[144:159], a[156:159], a[44:47], v[144:159]
ds_read_b64_tr_b16 a[152:153], v19 offset:4608
ds_read_b64_tr_b16 a[154:155], v19 offset:5632
s_waitcnt lgkmcnt(6)
v_mfma_f32_32x32x16_bf16 v[160:175], a[160:163], a[44:47], v[160:175]
ds_read_b64_tr_b16 a[156:157], v19 offset:6144
ds_read_b64_tr_b16 a[158:159], v19 offset:7168
buffer_load_dwordx4 v14, s[60:63], s32 offen offset:2048 lds
s_add_u32 m0, s31, 110592
s_add_u32 s32, s26, 384
s_waitcnt vmcnt(15)
v_mfma_f32_32x32x16_bf16 v[176:191], a[164:167], a[48:51], v[176:191]
ds_read_b64_tr_b16 a[160:161], v19 offset:6656
ds_read_b64_tr_b16 a[162:163], v19 offset:7680
v_mfma_f32_32x32x16_bf16 v[192:207], a[168:171], a[48:51], v[192:207]
ds_read_b64_tr_b16 a[164:165], v19 offset:8192
ds_read_b64_tr_b16 a[166:167], v19 offset:9216
buffer_load_dwordx4 v14, s[64:67], s32 offen lds
s_add_u32 m0, s31, 114688
s_add_u32 s32, s27, 384
s_waitcnt vmcnt(15)
v_mfma_f32_32x32x16_bf16 v[176:191], a[172:175], a[52:55], v[176:191]
ds_read_b64_tr_b16 a[168:169], v19 offset:8704
ds_read_b64_tr_b16 a[170:171], v19 offset:9728
s_waitcnt lgkmcnt(6)
v_mfma_f32_32x32x16_bf16 v[192:207], a[144:147], a[52:55], v[192:207]
ds_read_b64_tr_b16 a[172:173], v19 offset:10240
ds_read_b64_tr_b16 a[174:175], v19 offset:11264
buffer_load_dwordx4 v14, s[64:67], s32 offen lds
s_waitcnt vmcnt(14)
v_mfma_f32_32x32x16_bf16 v[176:191], a[148:151], a[56:59], v[176:191]
ds_read_b64_tr_b16 a[144:145], v19 offset:10752
ds_read_b64_tr_b16 a[146:147], v19 offset:11776
v_mfma_f32_32x32x16_bf16 v[192:207], a[152:155], a[56:59], v[192:207]
L_slot25:
s_barrier
ds_read_b64_tr_b16 a[148:149], v19 offset:24576
ds_read_b64_tr_b16 a[150:151], v19 offset:25600
s_waitcnt vmcnt(13)
v_mfma_f32_32x32x16_bf16 v[176:191], a[156:159], a[60:63], v[176:191]
ds_read_b64_tr_b16 a[152:153], v19 offset:25088
ds_read_b64_tr_b16 a[154:155], v19 offset:26112
s_and_b32 s94, s31, 1024
s_cmp_ge_u32 s3, 2
s_cselect_b32 s94, 28672, s94
s_add_u32 m0, s94, 118784
s_add_u32 s32, s28, 384
buffer_load_dwordx4 v15, s[64:67], s32 offen lds
s_waitcnt lgkmcnt(6)
v_mfma_f32_32x32x16_bf16 v[192:207], a[160:163], a[60:63], v[192:207]
ds_read_b64_tr_b16 a[156:157], v19 offset:26624
ds_read_b64_tr_b16 a[158:159], v19 offset:27648
s_add_u32 s32, s19, 384
s_add_u32 m0, s29, 122880
s_waitcnt vmcnt(13)
v_mfma_f32_32x32x16_bf16 v[176:191], a[164:167], a[64:67], v[176:191]
ds_read_b64_tr_b16 a[160:161], v19 offset:27136
ds_read_b64_tr_b16 a[162:163], v19 offset:28160
buffer_load_dwordx4 v7, s[60:63], s32 offen offset:0 lds
v_mfma_f32_32x32x16_bf16 v[192:207], a[168:171], a[64:67], v[192:207]
ds_read_b64_tr_b16 a[164:165], v19 offset:28672
ds_read_b64_tr_b16 a[166:167], v19 offset:29696
buffer_load_dwordx4 v8, s[60:63], s32 offen offset:1024 lds
s_waitcnt vmcnt(13)
v_mfma_f32_32x32x16_bf16 v[176:191], a[172:175], a[68:71], v[176:191]
ds_read_b64_tr_b16 a[168:169], v19 offset:29184
ds_read_b64_tr_b16 a[170:171], v19 offset:30208
s_waitcnt lgkmcnt(6)
v_mfma_f32_32x32x16_bf16 v[192:207], a[144:147], a[68:71], v[192:207]
ds_read_b64_tr_b16 a[172:173], v19 offset:30720
ds_read_b64_tr_b16 a[174:175], v19 offset:31744
buffer_load_dwordx4 v9, s[60:63], s32 offen offset:2048 lds
v_mfma_f32_32x32x16_bf16 v[208:223], a[148:151], a[48:51], v[208:223]
ds_read_b64_tr_b16 a[144:145], v19 offset:31232
ds_read_b64_tr_b16 a[146:147], v19 offset:32256
v_mfma_f32_32x32x16_bf16 v[224:239], a[152:155], a[48:51], v[224:239]
ds_read_b64_tr_b16 a[148:149], v19 offset:32768
ds_read_b64_tr_b16 a[150:151], v19 offset:33792
buffer_load_dwordx4 v10, s[60:63], s32 offen offset:3072 lds
s_add_u32 m0, s29, 126976
v_cvt_pk_bf16_f32 v240, v176, v177
v_mfma_f32_32x32x16_bf16 v[208:223], a[156:159], a[52:55], v[208:223]
ds_read_b64_tr_b16 a[152:153], v19 offset:33280
ds_read_b64_tr_b16 a[154:155], v19 offset:34304
v_cvt_pk_bf16_f32 v241, v178, v179
v_cvt_pk_bf16_f32 v242, v180, v181
s_waitcnt lgkmcnt(6)
v_mfma_f32_32x32x16_bf16 v[224:239], a[160:163], a[52:55], v[224:239]
ds_read_b64_tr_b16 a[156:157], v19 offset:34816
ds_read_b64_tr_b16 a[158:159], v19 offset:35840
buffer_load_dwordx4 v11, s[60:63], s32 offen offset:0 lds
v_cvt_pk_bf16_f32 v243, v182, v183
v_cvt_pk_bf16_f32 v244, v184, v185
v_mfma_f32_32x32x16_bf16 v[208:223], a[164:167], a[56:59], v[208:223]
ds_read_b64_tr_b16 a[160:161], v19 offset:35328
ds_read_b64_tr_b16 a[162:163], v19 offset:36352
v_cvt_pk_bf16_f32 v245, v186, v187
v_cvt_pk_bf16_f32 v246, v188, v189
v_cvt_pk_bf16_f32 v247, v190, v191
v_mfma_f32_32x32x16_bf16 v[224:239], a[168:171], a[56:59], v[224:239]
L_slot26:
s_barrier
ds_read_b64_tr_b16 a[164:165], v20 offset:0
ds_read_b64_tr_b16 a[166:167], v20 offset:1024
buffer_load_dwordx4 v12, s[60:63], s32 offen offset:1024 lds
v_mfma_f32_32x32x16_bf16 v[208:223], a[172:175], a[60:63], v[208:223]
ds_read_b64_tr_b16 a[168:169], v20 offset:512
ds_read_b64_tr_b16 a[170:171], v20 offset:1536
v_cvt_pk_bf16_f32 v248, v192, v193
v_cvt_pk_bf16_f32 v249, v194, v195
s_waitcnt lgkmcnt(6)
v_mfma_f32_32x32x16_bf16 v[224:239], a[144:147], a[60:63], v[224:239]
ds_read_b64_tr_b16 a[172:173], v20 offset:2048
ds_read_b64_tr_b16 a[174:175], v20 offset:3072
v_cvt_pk_bf16_f32 v250, v196, v197
v_cvt_pk_bf16_f32 v251, v198, v199
v_cvt_pk_bf16_f32 v128, v200, v201
v_mfma_f32_32x32x16_bf16 v[208:223], a[148:151], a[64:67], v[208:223]
ds_read_b64_tr_b16 a[144:145], v20 offset:2560
ds_read_b64_tr_b16 a[146:147], v20 offset:3584
v_cvt_pk_bf16_f32 v129, v202, v203
v_cvt_pk_bf16_f32 v130, v204, v205
v_cvt_pk_bf16_f32 v131, v206, v207
v_mfma_f32_32x32x16_bf16 v[224:239], a[152:155], a[64:67], v[224:239]
ds_read_b64_tr_b16 a[148:149], v20 offset:4096
ds_read_b64_tr_b16 a[150:151], v20 offset:5120
s_add_u32 m0, s30, 0
s_add_u32 s32, s23, 384
s_add_u32 s95, s33, 0
v_mfma_f32_32x32x16_bf16 v[208:223], a[156:159], a[68:71], v[208:223]
ds_read_b64_tr_b16 a[152:153], v20 offset:4608
ds_read_b64_tr_b16 a[154:155], v20 offset:5632
buffer_load_dwordx4 v14, s[60:63], s32 offen offset:0 lds
s_add_u32 s32, s24, 384
s_waitcnt lgkmcnt(6)
v_mfma_f32_32x32x16_bf16 v[224:239], a[160:163], a[68:71], v[224:239]
ds_read_b64_tr_b16 a[156:157], v20 offset:6144
ds_read_b64_tr_b16 a[158:159], v20 offset:7168
v_mfma_f32_32x32x16_bf16 v[144:159], a[164:167], a[48:51], v[144:159]
ds_read_b64_tr_b16 a[160:161], v20 offset:6656
ds_read_b64_tr_b16 a[162:163], v20 offset:7680
buffer_store_dwordx4 v[240:243], v26, s[72:75], s95 offen offset:0 sc1
v_mfma_f32_32x32x16_bf16 v[160:175], a[168:171], a[48:51], v[160:175]
ds_read_b64_tr_b16 a[164:165], v20 offset:8192
ds_read_b64_tr_b16 a[166:167], v20 offset:9216
v_mfma_f32_32x32x16_bf16 v[144:159], a[172:175], a[52:55], v[144:159]
ds_read_b64_tr_b16 a[168:169], v20 offset:8704
ds_read_b64_tr_b16 a[170:171], v20 offset:9728
s_waitcnt lgkmcnt(6)
v_mfma_f32_32x32x16_bf16 v[160:175], a[144:147], a[52:55], v[160:175]
ds_read_b64_tr_b16 a[172:173], v20 offset:10240
ds_read_b64_tr_b16 a[174:175], v20 offset:11264
buffer_load_dwordx4 v14, s[60:63], s32 offen offset:1024 lds
s_add_u32 s32, s25, 384
v_mfma_f32_32x32x16_bf16 v[144:159], a[148:151], a[56:59], v[144:159]
ds_read_b64_tr_b16 a[144:145], v20 offset:10752
ds_read_b64_tr_b16 a[146:147], v20 offset:11776
v_mfma_f32_32x32x16_bf16 v[160:175], a[152:155], a[56:59], v[160:175]
L_slot27:
s_waitcnt vmcnt(15)
s_barrier
ds_read_b64_tr_b16 a[148:149], v20 offset:24576
ds_read_b64_tr_b16 a[150:151], v20 offset:25600
buffer_load_dwordx4 v14, s[60:63], s32 offen offset:2048 lds
v_mfma_f32_32x32x16_bf16 v[144:159], a[156:159], a[60:63], v[144:159]
ds_read_b64_tr_b16 a[152:153], v20 offset:25088
ds_read_b64_tr_b16 a[154:155], v20 offset:26112
s_mul_i32 s94, s3, 5120
s_add_u32 m0, s94, 24576
s_waitcnt lgkmcnt(6)
v_mfma_f32_32x32x16_bf16 v[160:175], a[160:163], a[60:63], v[160:175]
ds_read_b64_tr_b16 a[156:157], v20 offset:26624
ds_read_b64_tr_b16 a[158:159], v20 offset:27648
v_mfma_f32_32x32x16_bf16 v[144:159], a[164:167], a[64:67], v[144:159]
ds_read_b64_tr_b16 a[160:161], v20 offset:27136
ds_read_b64_tr_b16 a[162:163], v20 offset:28160
buffer_store_dwordx4 v[244:247], v26, s[72:75], s95 offen offset:1024 sc1
v_mfma_f32_32x32x16_bf16 v[160:175], a[168:171], a[64:67], v[160:175]
ds_read_b64_tr_b16 a[164:165], v20 offset:28672
ds_read_b64_tr_b16 a[166:167], v20 offset:29696
v_mfma_f32_32x32x16_bf16 v[144:159], a[172:175], a[68:71], v[144:159]
ds_read_b64_tr_b16 a[168:169], v20 offset:29184
ds_read_b64_tr_b16 a[170:171], v20 offset:30208
s_waitcnt lgkmcnt(6)
v_mfma_f32_32x32x16_bf16 v[160:175], a[144:147], a[68:71], v[160:175]
ds_read_b64_tr_b16 a[172:173], v20 offset:30720
ds_read_b64_tr_b16 a[174:175], v20 offset:31744
buffer_load_dwordx4 v36, s[60:63], s46 offen lds
s_add_u32 m0, s94, 25600
v_mfma_f32_32x32x16_bf16 v[176:191], a[148:151], v[40:43], 0
ds_read_b64_tr_b16 a[144:145], v20 offset:31232
ds_read_b64_tr_b16 a[146:147], v20 offset:32256
v_mfma_f32_32x32x16_bf16 v[192:207], a[152:155], v[40:43], 0
ds_read_b64_tr_b16 a[148:149], v20 offset:32768
ds_read_b64_tr_b16 a[150:151], v20 offset:33792
buffer_store_dwordx4 v[248:251], v26, s[72:75], s95 offen offset:2048 sc1
v_mfma_f32_32x32x16_bf16 v[176:191], a[156:159], v[44:47], v[176:191]
ds_read_b64_tr_b16 a[152:153], v20 offset:33280
ds_read_b64_tr_b16 a[154:155], v20 offset:34304
s_waitcnt lgkmcnt(6)
v_mfma_f32_32x32x16_bf16 v[192:207], a[160:163], v[44:47], v[192:207]
ds_read_b64_tr_b16 a[156:157], v20 offset:34816
ds_read_b64_tr_b16 a[158:159], v20 offset:35840
v_mfma_f32_32x32x16_bf16 v[176:191], a[164:167], v[48:51], v[176:191]
ds_read_b64_tr_b16 a[160:161], v20 offset:35328
ds_read_b64_tr_b16 a[162:163], v20 offset:36352
buffer_load_dwordx4 v36, s[60:63], s47 offen lds
s_add_u32 m0, s94, 26624
v_mfma_f32_32x32x16_bf16 v[192:207], a[168:171], v[48:51], v[192:207]
ds_read_b64_tr_b16 a[164:165], v20 offset:36864
ds_read_b64_tr_b16 a[166:167], v20 offset:37888
v_mfma_f32_32x32x16_bf16 v[176:191], a[172:175], v[52:55], v[176:191]
ds_read_b64_tr_b16 a[168:169], v20 offset:37376
ds_read_b64_tr_b16 a[170:171], v20 offset:38400
s_waitcnt lgkmcnt(6)
v_mfma_f32_32x32x16_bf16 v[192:207], a[144:147], v[52:55], v[192:207]
ds_read_b64_tr_b16 a[172:173], v20 offset:38912
ds_read_b64_tr_b16 a[174:175], v20 offset:39936
buffer_store_dwordx4 v[128:131], v26, s[72:75], s95 offen offset:3072 sc1
v_mfma_f32_32x32x16_bf16 v[176:191], a[148:151], v[56:59], v[176:191]
ds_read_b64_tr_b16 a[144:145], v20 offset:39424
ds_read_b64_tr_b16 a[146:147], v20 offset:40448
v_cvt_pk_bf16_f32 v132, v208, v209
v_cvt_pk_bf16_f32 v133, v210, v211
v_cvt_pk_bf16_f32 v134, v212, v213
v_mfma_f32_32x32x16_bf16 v[192:207], a[152:155], v[56:59], v[192:207]
ds_read_b64_tr_b16 a[148:149], v20 offset:40960
ds_read_b64_tr_b16 a[150:151], v20 offset:41984
buffer_load_dwordx4 v36, s[60:63], s48 offen lds
s_add_u32 m0, s94, 27648
v_cvt_pk_bf16_f32 v135, v214, v215
v_mfma_f32_32x32x16_bf16 v[176:191], a[156:159], v[60:63], v[176:191]
ds_read_b64_tr_b16 a[152:153], v20 offset:41472
ds_read_b64_tr_b16 a[154:155], v20 offset:42496
s_add_u32 s95, s33, 4096
s_waitcnt lgkmcnt(6)
v_mfma_f32_32x32x16_bf16 v[192:207], a[160:163], v[60:63], v[192:207]
ds_read_b64_tr_b16 a[156:157], v20 offset:43008
ds_read_b64_tr_b16 a[158:159], v20 offset:44032
v_mfma_f32_32x32x16_bf16 v[176:191], a[164:167], v[64:67], v[176:191]
ds_read_b64_tr_b16 a[160:161], v20 offset:43520
ds_read_b64_tr_b16 a[162:163], v20 offset:44544
buffer_load_dwordx4 v36, s[60:63], s49 offen lds
s_add_u32 m0, s94, 28672
v_mfma_f32_32x32x16_bf16 v[192:207], a[168:171], v[64:67], v[192:207]
ds_read_b64_tr_b16 a[164:165], v20 offset:45056
ds_read_b64_tr_b16 a[166:167], v20 offset:46080
v_mfma_f32_32x32x16_bf16 v[176:191], a[172:175], v[68:71], v[176:191]
ds_read_b64_tr_b16 a[168:169], v20 offset:45568
ds_read_b64_tr_b16 a[170:171], v20 offset:46592
buffer_load_dwordx4 v36, s[60:63], s50 offen lds
s_waitcnt lgkmcnt(6)
v_mfma_f32_32x32x16_bf16 v[192:207], a[144:147], v[68:71], v[192:207]
ds_read_b64_tr_b16 a[172:173], v20 offset:47104
ds_read_b64_tr_b16 a[174:175], v20 offset:48128
v_mfma_f32_32x32x16_bf16 v[176:191], a[148:151], v[72:75], v[176:191]
ds_read_b64_tr_b16 a[144:145], v20 offset:47616
ds_read_b64_tr_b16 a[146:147], v20 offset:48640
v_mfma_f32_32x32x16_bf16 v[192:207], a[152:155], v[72:75], v[192:207]
L_slot28:
s_waitcnt vmcnt(18)
s_barrier
ds_read_b64_tr_b16 a[148:149], v18 offset:12288
ds_read_b64_tr_b16 a[150:151], v18 offset:12544
buffer_store_dwordx4 v[132:135], v26, s[72:75], s95 offen offset:0 sc1
v_mfma_f32_32x32x16_bf16 v[176:191], a[156:159], v[76:79], v[176:191]
ds_read_b64_tr_b16 a[152:153], v18 offset:12800
ds_read_b64_tr_b16 a[154:155], v18 offset:13056
v_cvt_pk_bf16_f32 v136, v216, v217
v_cvt_pk_bf16_f32 v137, v218, v219
s_waitcnt lgkmcnt(6)
v_mfma_f32_32x32x16_bf16 v[192:207], a[160:163], v[76:79], v[192:207]
ds_read_b64_tr_b16 a[156:157], v18 offset:14336
ds_read_b64_tr_b16 a[158:159], v18 offset:14592
v_cvt_pk_bf16_f32 v138, v220, v221
v_cvt_pk_bf16_f32 v139, v222, v223
v_mfma_f32_32x32x16_bf16 v[176:191], a[164:167], v[80:83], v[176:191]
ds_read_b64_tr_b16 a[160:161], v18 offset:14848
ds_read_b64_tr_b16 a[162:163], v18 offset:15104
buffer_store_dwordx4 v[136:139], v26, s[72:75], s95 offen offset:1024 sc1
v_mfma_f32_32x32x16_bf16 v[192:207], a[168:171], v[80:83], v[192:207]
ds_read_b64_tr_b16 a[164:165], v18 offset:16384
ds_read_b64_tr_b16 a[166:167], v18 offset:16640
v_cvt_pk_bf16_f32 v140, v224, v225
v_cvt_pk_bf16_f32 v141, v226, v227
v_cvt_pk_bf16_f32 v142, v228, v229
v_mfma_f32_32x32x16_bf16 v[176:191], a[172:175], v[84:87], v[176:191]
ds_read_b64_tr_b16 a[168:169], v18 offset:16896
ds_read_b64_tr_b16 a[170:171], v18 offset:17152
v_cvt_pk_bf16_f32 v143, v230, v231
s_waitcnt lgkmcnt(6)
v_mfma_f32_32x32x16_bf16 v[192:207], a[144:147], v[84:87], v[192:207]
ds_read_b64_tr_b16 a[172:173], v18 offset:18432
ds_read_b64_tr_b16 a[174:175], v18 offset:18688
buffer_store_dwordx4 v[140:143], v26, s[72:75], s95 offen offset:2048 sc1
v_mfma_f32_32x32x16_bf16 v[176:191], a[148:151], a[176:179], v[176:191]
ds_read_b64_tr_b16 a[144:145], v18 offset:18944
ds_read_b64_tr_b16 a[146:147], v18 offset:19200
v_cvt_pk_bf16_f32 v240, v232, v233
v_cvt_pk_bf16_f32 v241, v234, v235
v_cvt_pk_bf16_f32 v242, v236, v237
v_mfma_f32_32x32x16_bf16 v[192:207], a[152:155], a[176:179], v[192:207]
ds_read_b64_tr_b16 a[148:149], v24 offset:20480
ds_read_b64_tr_b16 a[150:151], v24 offset:21504
v_cvt_pk_bf16_f32 v243, v238, v239
v_mfma_f32_32x32x16_bf16 v[176:191], a[156:159], a[180:183], v[176:191]
ds_read_b64_tr_b16 a[152:153], v24 offset:20992
ds_read_b64_tr_b16 a[154:155], v24 offset:22016
buffer_store_dwordx4 v[240:243], v26, s[72:75], s95 offen offset:3072 sc1
s_waitcnt lgkmcnt(6)
v_mfma_f32_32x32x16_bf16 v[192:207], a[160:163], a[180:183], v[192:207]
ds_read_b64_tr_b16 a[156:157], v21 offset:0
ds_read_b64_tr_b16 a[158:159], v21 offset:1024
v_cvt_pk_bf16_f32 v244, v144, v145
v_cvt_pk_bf16_f32 v245, v146, v147
v_cvt_pk_bf16_f32 v246, v148, v149
v_mfma_f32_32x32x16_bf16 v[176:191], a[164:167], a[184:187], v[176:191]
ds_read_b64_tr_b16 a[160:161], v21 offset:512
ds_read_b64_tr_b16 a[162:163], v21 offset:1536
v_cvt_pk_bf16_f32 v247, v150, v151
s_add_u32 s95, s33, 8192
v_mfma_f32_32x32x16_bf16 v[192:207], a[168:171], a[184:187], v[192:207]
ds_read_b64_tr_b16 a[164:165], v21 offset:2048
ds_read_b64_tr_b16 a[166:167], v21 offset:3072
v_mfma_f32_32x32x16_bf16 v[176:191], a[172:175], a[188:191], v[176:191]
ds_read_b64_tr_b16 a[168:169], v21 offset:2560
ds_read_b64_tr_b16 a[170:171], v21 offset:3584
buffer_store_dwordx4 v[244:247], v26, s[72:75], s95 offen offset:0 sc1
s_waitcnt lgkmcnt(6)
v_mfma_f32_32x32x16_bf16 v[192:207], a[144:147], a[188:191], v[192:207]
ds_read_b64_tr_b16 a[172:173], v21 offset:4096
ds_read_b64_tr_b16 a[174:175], v21 offset:5120
v_cvt_pk_bf16_f32 v248, v152, v153
v_mfma_f32_32x32x16_bf16 v[176:191], a[148:151], a[192:195], v[176:191]
ds_read_b64_tr_b16 a[144:145], v21 offset:4608
ds_read_b64_tr_b16 a[146:147], v21 offset:5632
v_mfma_f32_32x32x16_bf16 v[192:207], a[152:155], a[192:195], v[192:207]
ds_read_b64_tr_b16 a[148:149], v21 offset:6144
ds_read_b64_tr_b16 a[150:151], v21 offset:7168
v_cvt_pk_bf16_f32 v249, v154, v155
v_mfma_f32_32x32x16_bf16 v[176:191], a[156:159], v[88:91], v[176:191]
ds_read_b64_tr_b16 a[152:153], v21 offset:6656
ds_read_b64_tr_b16 a[154:155], v21 offset:7680
v_cvt_pk_bf16_f32 v250, v156, v157
s_waitcnt lgkmcnt(6)
v_mfma_f32_32x32x16_bf16 v[192:207], a[160:163], v[88:91], v[192:207]
ds_read_b64_tr_b16 a[156:157], v21 offset:8192
ds_read_b64_tr_b16 a[158:159], v21 offset:9216
v_mfma_f32_32x32x16_bf16 v[176:191], a[164:167], v[92:95], v[176:191]
ds_read_b64_tr_b16 a[160:161], v21 offset:8704
ds_read_b64_tr_b16 a[162:163], v21 offset:9728
v_cvt_pk_bf16_f32 v251, v158, v159
v_mfma_f32_32x32x16_bf16 v[192:207], a[168:171], v[92:95], v[192:207]
ds_read_b64_tr_b16 a[164:165], v21 offset:10240
ds_read_b64_tr_b16 a[166:167], v21 offset:11264
buffer_store_dwordx4 v[248:251], v26, s[72:75], s95 offen offset:1024 sc1
v_mfma_f32_32x32x16_bf16 v[176:191], a[172:175], v[96:99], v[176:191]
ds_read_b64_tr_b16 a[168:169], v21 offset:10752
ds_read_b64_tr_b16 a[170:171], v21 offset:11776
s_waitcnt lgkmcnt(6)
v_mfma_f32_32x32x16_bf16 v[192:207], a[144:147], v[96:99], v[192:207]
L_slot29:
s_waitcnt vmcnt(18)
s_barrier
ds_read_b64_tr_b16 a[172:173], v21 offset:24576
ds_read_b64_tr_b16 a[174:175], v21 offset:25600
v_cvt_pk_bf16_f32 v128, v160, v161
v_mfma_f32_32x32x16_bf16 v[176:191], a[148:151], v[100:103], v[176:191]
ds_read_b64_tr_b16 a[144:145], v21 offset:25088
ds_read_b64_tr_b16 a[146:147], v21 offset:26112
v_cvt_pk_bf16_f32 v129, v162, v163
v_mfma_f32_32x32x16_bf16 v[192:207], a[152:155], v[100:103], v[192:207]
ds_read_b64_tr_b16 a[148:149], v21 offset:26624
ds_read_b64_tr_b16 a[150:151], v21 offset:27648
v_mfma_f32_32x32x16_bf16 v[176:191], a[156:159], v[104:107], v[176:191]
ds_read_b64_tr_b16 a[152:153], v21 offset:27136
ds_read_b64_tr_b16 a[154:155], v21 offset:28160
v_cvt_pk_bf16_f32 v130, v164, v165
s_waitcnt lgkmcnt(6)
v_mfma_f32_32x32x16_bf16 v[192:207], a[160:163], v[104:107], v[192:207]
ds_read_b64_tr_b16 a[156:157], v21 offset:28672
ds_read_b64_tr_b16 a[158:159], v21 offset:29696
v_cvt_pk_bf16_f32 v131, v166, v167
v_mfma_f32_32x32x16_bf16 v[176:191], a[164:167], v[108:111], v[176:191]
ds_read_b64_tr_b16 a[160:161], v21 offset:29184
ds_read_b64_tr_b16 a[162:163], v21 offset:30208
v_mfma_f32_32x32x16_bf16 v[192:207], a[168:171], v[108:111], v[192:207]
ds_read_b64_tr_b16 a[164:165], v21 offset:30720
ds_read_b64_tr_b16 a[166:167], v21 offset:31744
buffer_store_dwordx4 v[128:131], v26, s[72:75], s95 offen offset:2048 sc1
v_mfma_f32_32x32x16_bf16 v[176:191], a[172:175], a[0:3], v[176:191]
ds_read_b64_tr_b16 a[168:169], v21 offset:31232
ds_read_b64_tr_b16 a[170:171], v21 offset:32256
v_cvt_pk_bf16_f32 v132, v168, v169
s_waitcnt lgkmcnt(6)
v_mfma_f32_32x32x16_bf16 v[192:207], a[144:147], a[0:3], v[192:207]
ds_read_b64_tr_b16 a[172:173], v21 offset:32768
ds_read_b64_tr_b16 a[174:175], v21 offset:33792
v_mfma_f32_32x32x16_bf16 v[176:191], a[148:151], a[4:7], v[176:191]
ds_read_b64_tr_b16 a[144:145], v21 offset:33280
ds_read_b64_tr_b16 a[146:147], v21 offset:34304
v_cvt_pk_bf16_f32 v133, v170, v171
v_mfma_f32_32x32x16_bf16 v[192:207], a[152:155], a[4:7], v[192:207]
ds_read_b64_tr_b16 a[148:149], v21 offset:34816
ds_read_b64_tr_b16 a[150:151], v21 offset:35840
v_cvt_pk_bf16_f32 v134, v172, v173
v_mfma_f32_32x32x16_bf16 v[176:191], a[156:159], a[8:11], v[176:191]
ds_read_b64_tr_b16 a[152:153], v21 offset:35328
ds_read_b64_tr_b16 a[154:155], v21 offset:36352
s_waitcnt lgkmcnt(6)
v_mfma_f32_32x32x16_bf16 v[192:207], a[160:163], a[8:11], v[192:207]
ds_read_b64_tr_b16 a[156:157], v21 offset:36864
ds_read_b64_tr_b16 a[158:159], v21 offset:37888
v_cvt_pk_bf16_f32 v135, v174, v175
v_mfma_f32_32x32x16_bf16 v[176:191], a[164:167], a[12:15], v[176:191]
ds_read_b64_tr_b16 a[160:161], v21 offset:37376
ds_read_b64_tr_b16 a[162:163], v21 offset:38400
buffer_store_dwordx4 v[132:135], v26, s[72:75], s95 offen offset:3072 sc1
v_mfma_f32_32x32x16_bf16 v[192:207], a[168:171], a[12:15], v[192:207]
ds_read_b64_tr_b16 a[164:165], v21 offset:38912
ds_read_b64_tr_b16 a[166:167], v21 offset:39936
v_mfma_f32_32x32x16_bf16 v[176:191], a[172:175], a[16:19], v[176:191]
ds_read_b64_tr_b16 a[168:169], v21 offset:39424
ds_read_b64_tr_b16 a[170:171], v21 offset:40448
s_waitcnt lgkmcnt(6)
v_mfma_f32_32x32x16_bf16 v[192:207], a[144:147], a[16:19], v[192:207]
ds_read_b64_tr_b16 a[172:173], v21 offset:40960
ds_read_b64_tr_b16 a[174:175], v21 offset:41984
v_and_b32 v224, 15, v0
v_lshrrev_b32 v225, 4, v0
v_lshrrev_b32 v226, 3, v224
v_mfma_f32_32x32x16_bf16 v[176:191], a[148:151], a[20:23], v[176:191]
ds_read_b64_tr_b16 a[144:145], v21 offset:41472
ds_read_b64_tr_b16 a[146:147], v21 offset:42496
v_and_b32 v227, 3, v224
v_lshl_add_u32 v226, v226, 2, v227
v_bfe_u32 v227, v224, 2, 1
v_mfma_f32_32x32x16_bf16 v[192:207], a[152:155], a[20:23], v[192:207]
ds_read_b64_tr_b16 a[148:149], v21 offset:43008
ds_read_b64_tr_b16 a[150:151], v21 offset:44032
v_and_b32 v228, 1, v225
v_cmp_eq_u32 s[84:85], v227, v228
v_and_b32 v227, 1, v226
v_mfma_f32_32x32x16_bf16 v[176:191], a[156:159], a[24:27], v[176:191]
ds_read_b64_tr_b16 a[152:153], v21 offset:43520
ds_read_b64_tr_b16 a[154:155], v21 offset:44544
v_lshlrev_b32 v227, 4, v227
v_mov_b32 v229, 0x3f80
s_waitcnt lgkmcnt(6)
v_mfma_f32_32x32x16_bf16 v[192:207], a[160:163], a[24:27], v[192:207]
ds_read_b64_tr_b16 a[156:157], v21 offset:45056
ds_read_b64_tr_b16 a[158:159], v21 offset:46080
v_lshlrev_b32 v227, v227, v229
v_cndmask_b32 v227, 0, v227, s[84:85]
v_lshrrev_b32 v226, 1, v226
v_mfma_f32_32x32x16_bf16 v[176:191], a[164:167], a[28:31], v[176:191]
ds_read_b64_tr_b16 a[160:161], v21 offset:45568
ds_read_b64_tr_b16 a[162:163], v21 offset:46592
v_cmp_eq_u32 s[84:85], 0, v226
v_cmp_eq_u32 s[86:87], 1, v226
v_cmp_eq_u32 s[88:89], 2, v226
v_mfma_f32_32x32x16_bf16 v[192:207], a[168:171], a[28:31], v[192:207]
ds_read_b64_tr_b16 a[164:165], v21 offset:47104
ds_read_b64_tr_b16 a[166:167], v21 offset:48128
v_cmp_eq_u32 vcc, 3, v226
s_lshr_b32 s96, s5, 3
s_lshl_b32 s96, s96, 4
v_mfma_f32_32x32x16_bf16 v[176:191], a[172:175], a[32:35], v[176:191]
ds_read_b64_tr_b16 a[168:169], v21 offset:47616
ds_read_b64_tr_b16 a[170:171], v21 offset:48640
v_add_u32 v224, s96, v224
v_cndmask_b32 v220, 0, v227, s[84:85]
s_waitcnt lgkmcnt(6)
v_mfma_f32_32x32x16_bf16 v[192:207], a[144:147], a[32:35], v[192:207]
L_slot30:
s_waitcnt vmcnt(16)
s_barrier
ds_read_b64_tr_b16 a[172:173], v19 offset:0
ds_read_b64_tr_b16 a[174:175], v19 offset:1024
v_cndmask_b32 v221, 0, v227, s[86:87]
v_cndmask_b32 v222, 0, v227, s[88:89]
v_mfma_f32_32x32x16_bf16 v[176:191], a[148:151], a[36:39], v[176:191]
ds_read_b64_tr_b16 a[144:145], v19 offset:512
ds_read_b64_tr_b16 a[146:147], v19 offset:1536
v_cndmask_b32 v223, 0, v227, vcc
v_lshrrev_b32 v226, 1, v225
v_lshlrev_b32 v229, 4, v224
v_mfma_f32_32x32x16_bf16 v[192:207], a[152:155], a[36:39], v[192:207]
ds_read_b64_tr_b16 a[148:149], v19 offset:2048
ds_read_b64_tr_b16 a[150:151], v19 offset:3072
v_mul_u32_u24 v227, 147456, v226
v_lshl_add_u32 v227, v228, 9, v227
v_add_u32 v145, v227, v229
v_mfma_f32_32x32x16_bf16 v[176:191], a[156:159], a[40:43], v[176:191]
ds_read_b64_tr_b16 a[152:153], v19 offset:2560
ds_read_b64_tr_b16 a[154:155], v19 offset:3584
v_lshl_add_u32 v227, v226, 9, v229
v_lshl_add_u32 v146, v228, 3, v227
s_waitcnt lgkmcnt(6)
v_mfma_f32_32x32x16_bf16 v[192:207], a[160:163], a[40:43], v[192:207]
ds_read_b64_tr_b16 a[156:157], v19 offset:4096
ds_read_b64_tr_b16 a[158:159], v19 offset:5120
v_lshlrev_b32 v147, 3, v224
s_bfe_u32 s76, s5, 0x20001
s_lshl_b32 s78, s4, 2
v_mfma_f32_32x32x16_bf16 v[176:191], a[164:167], a[44:47], v[176:191]
ds_read_b64_tr_b16 a[160:161], v19 offset:4608
ds_read_b64_tr_b16 a[162:163], v19 offset:5632
s_add_u32 s78, s78, s76
s_lshl_b32 s78, s78, 5
v_add_u32 v224, s78, v224
v_mfma_f32_32x32x16_bf16 v[192:207], a[168:171], a[44:47], v[192:207]
ds_read_b64_tr_b16 a[164:165], v19 offset:6144
ds_read_b64_tr_b16 a[166:167], v19 offset:7168
v_mul_u32_u24 v224, 1152, v224
v_lshl_add_u32 v148, v225, 3, v224
s_lshl_b32 s96, s76, 8
v_mfma_f32_32x32x16_bf16 v[176:191], a[172:175], a[48:51], v[176:191]
ds_read_b64_tr_b16 a[168:169], v19 offset:6656
ds_read_b64_tr_b16 a[170:171], v19 offset:7680
s_add_u32 s96, s96, 8192
s_waitcnt lgkmcnt(6)
v_mfma_f32_32x32x16_bf16 v[192:207], a[144:147], a[48:51], v[192:207]
ds_read_b64_tr_b16 a[172:173], v19 offset:8192
ds_read_b64_tr_b16 a[174:175], v19 offset:9216
buffer_load_dword v144, v147, s[72:75], s96 offen offset:4 sc1
s_mul_i32 s77, s76, 36864
s_add_u32 s77, s77, 262144
v_mfma_f32_32x32x16_bf16 v[176:191], a[148:151], a[52:55], v[176:191]
ds_read_b64_tr_b16 a[144:145], v19 offset:8704
ds_read_b64_tr_b16 a[146:147], v19 offset:9728
s_mul_i32 s76, s76, 18432
s_mul_i32 s96, s91, 73728
s_add_u32 s76, s76, s96
v_mfma_f32_32x32x16_bf16 v[192:207], a[152:155], a[52:55], v[192:207]
ds_read_b64_tr_b16 a[148:149], v19 offset:10240
ds_read_b64_tr_b16 a[150:151], v19 offset:11264
s_add_u32 s76, s76, 1835008
v_mfma_f32_32x32x16_bf16 v[176:191], a[156:159], a[56:59], v[176:191]
ds_read_b64_tr_b16 a[152:153], v19 offset:10752
ds_read_b64_tr_b16 a[154:155], v19 offset:11776
s_waitcnt lgkmcnt(6)
v_mfma_f32_32x32x16_bf16 v[192:207], a[160:163], a[56:59], v[192:207]
L_slot31:
s_waitcnt vmcnt(9)
s_waitcnt vmcnt(1)
s_barrier
s_add_u32 s100, s12, 24576
buffer_store_dword a255, v253, s[72:75], s100 offen sc1
ds_read_b64_tr_b16 a[156:157], v19 offset:24576
ds_read_b64_tr_b16 a[158:159], v19 offset:25088
v_mfma_f32_32x32x16_bf16 v[176:191], a[164:167], a[60:63], v[176:191]
ds_read_b64_tr_b16 a[160:161], v19 offset:25600
ds_read_b64_tr_b16 a[162:163], v19 offset:26112
v_mfma_f32_32x32x16_bf16 v[192:207], a[168:171], a[60:63], v[192:207]
ds_read_b64_tr_b16 a[164:165], v19 offset:26624
ds_read_b64_tr_b16 a[166:167], v19 offset:27136
v_mfma_f32_32x32x16_bf16 v[176:191], a[172:175], a[64:67], v[176:191]
ds_read_b64_tr_b16 a[168:169], v19 offset:27648
ds_read_b64_tr_b16 a[170:171], v19 offset:28160
s_waitcnt lgkmcnt(6)
v_mfma_f32_32x32x16_bf16 v[192:207], a[144:147], a[64:67], v[192:207]
ds_read_b64_tr_b16 a[172:173], v19 offset:28672
ds_read_b64_tr_b16 a[174:175], v19 offset:29184
v_mfma_f32_32x32x16_bf16 v[176:191], a[148:151], a[68:71], v[176:191]
ds_read_b64_tr_b16 a[144:145], v19 offset:29696
ds_read_b64_tr_b16 a[146:147], v19 offset:30208
v_mfma_f32_32x32x16_bf16 v[192:207], a[152:155], a[68:71], v[192:207]
ds_read_b64_tr_b16 a[148:149], v19 offset:30720
ds_read_b64_tr_b16 a[150:151], v19 offset:31232
v_mfma_f32_32x32x16_bf16 v[112:127], a[156:159], a[0:3], v[112:127]
ds_read_b64_tr_b16 a[152:153], v19 offset:31744
ds_read_b64_tr_b16 a[154:155], v19 offset:32256
s_waitcnt lgkmcnt(6)
v_mfma_f32_32x32x16_bf16 v[112:127], a[160:163], a[4:7], v[112:127]
ds_read_b64_tr_b16 a[156:157], v19 offset:32768
ds_read_b64_tr_b16 a[158:159], v19 offset:33280
v_cvt_pk_bf16_f32 v136, v176, v177
v_cvt_pk_bf16_f32 v137, v178, v179
v_mfma_f32_32x32x16_bf16 v[112:127], a[164:167], a[8:11], v[112:127]
ds_read_b64_tr_b16 a[160:161], v19 offset:33792
ds_read_b64_tr_b16 a[162:163], v19 offset:34304
v_cvt_pk_bf16_f32 v138, v180, v181
v_mfma_f32_32x32x16_bf16 v[112:127], a[168:171], a[12:15], v[112:127]
ds_read_b64_tr_b16 a[164:165], v19 offset:34816
ds_read_b64_tr_b16 a[166:167], v19 offset:35328
v_cvt_pk_bf16_f32 v139, v182, v183
v_mfma_f32_32x32x16_bf16 v[112:127], a[172:175], a[16:19], v[112:127]
ds_read_b64_tr_b16 a[168:169], v19 offset:35840
ds_read_b64_tr_b16 a[170:171], v19 offset:36352
s_add_u32 s95, s33, 12288
s_waitcnt lgkmcnt(6)
v_mfma_f32_32x32x16_bf16 v[112:127], a[144:147], a[20:23], v[112:127]
ds_read_b64_tr_b16 a[172:173], v19 offset:36864
ds_read_b64_tr_b16 a[174:175], v19 offset:37376
buffer_store_dwordx4 v[136:139], v26, s[72:75], s95 offen offset:0 sc1
v_cvt_pk_bf16_f32 v140, v184, v185
v_mfma_f32_32x32x16_bf16 v[112:127], a[148:151], a[24:27], v[112:127]
ds_read_b64_tr_b16 a[144:145], v19 offset:37888
ds_read_b64_tr_b16 a[146:147], v19 offset:38400
v_cvt_pk_bf16_f32 v141, v186, v187
v_mfma_f32_32x32x16_bf16 v[112:127], a[152:155], a[28:31], v[112:127]
ds_read_b64_tr_b16 a[148:149], v19 offset:38912
ds_read_b64_tr_b16 a[150:151], v19 offset:39424
s_mul_i32 s97, s3, 3
s_add_u32 s97, s97, 0
s_mul_i32 s88, s91, 20
s_add_u32 s88, s88, s97
s_lshl_b32 s96, s88, 10
s_add_u32 s96, s96, s77
v_mfma_f32_32x32x16_bf16 v[112:127], a[156:159], a[32:35], v[112:127]
ds_read_b64_tr_b16 a[152:153], v19 offset:39936
ds_read_b64_tr_b16 a[154:155], v19 offset:40448
buffer_load_dwordx2 v[152:153], v146, s[72:75], s96 offen sc1
v_cvt_pk_bf16_f32 v142, v188, v189
v_cvt_pk_bf16_f32 v143, v190, v191
s_waitcnt lgkmcnt(6)
v_mfma_f32_32x32x16_bf16 v[112:127], a[160:163], a[36:39], v[112:127]
ds_read_b64_tr_b16 a[156:157], v19 offset:40960
ds_read_b64_tr_b16 a[158:159], v19 offset:41472
s_mul_i32 s98, s3, 3
s_add_u32 s98, s98, 1
s_mul_i32 s89, s91, 20
s_add_u32 s89, s89, s98
s_lshl_b32 s96, s89, 10
s_add_u32 s96, s96, s77
v_mfma_f32_32x32x16_bf16 v[112:127], a[164:167], a[40:43], v[112:127]
ds_read_b64_tr_b16 a[160:161], v19 offset:41984
ds_read_b64_tr_b16 a[162:163], v19 offset:42496
buffer_load_dwordx2 v[154:155], v146, s[72:75], s96 offen sc1
v_mfma_f32_32x32x16_bf16 v[112:127], a[168:171], a[44:47], v[112:127]
s_mul_i32 s99, s3, 3
s_add_u32 s99, s99, 2
s_mul_i32 s90, s91, 20
s_add_u32 s90, s90, s99
s_lshl_b32 s96, s90, 10
s_add_u32 s96, s96, s77
v_mfma_f32_32x32x16_bf16 v[112:127], a[172:175], a[48:51], v[112:127]
buffer_load_dwordx2 v[156:157], v146, s[72:75], s96 offen sc1
s_add_u32 s7, s3, 12
s_mul_i32 s9, s91, 20
s_add_u32 s9, s9, s7
s_lshl_b32 s96, s9, 10
s_add_u32 s96, s96, s77
s_waitcnt lgkmcnt(2)
v_mfma_f32_32x32x16_bf16 v[112:127], a[144:147], a[52:55], v[112:127]
buffer_load_dwordx2 v[158:159], v146, s[72:75], s96 offen sc1
s_add_u32 s8, s3, 16
s_lshl_b32 s10, s91, 1
s_add_u32 s10, s10, s8
s_cmp_ge_u32 s3, 2
s_cselect_b32 s8, 0x40000, s8
s_cselect_b32 s10, 0x40000, s10
s_lshl_b32 s96, s10, 10
s_add_u32 s96, s96, s77
buffer_load_dwordx2 v[160:161], v146, s[72:75], s96 offen sc1
v_mfma_f32_32x32x16_bf16 v[112:127], a[148:151], a[56:59], v[112:127]
buffer_store_dwordx4 v[140:143], v26, s[72:75], s95 offen offset:1024 sc1
v_cvt_pk_bf16_f32 v240, v192, v193
v_cvt_pk_bf16_f32 v241, v194, v195
v_mfma_f32_32x32x16_bf16 v[112:127], a[152:155], a[60:63], v[112:127]
v_cvt_pk_bf16_f32 v242, v196, v197
v_cvt_pk_bf16_f32 v243, v198, v199
v_mfma_f32_32x32x16_bf16 v[112:127], a[156:159], a[64:67], v[112:127]
buffer_store_dwordx4 v[240:243], v26, s[72:75], s95 offen offset:2048 sc1
v_cvt_pk_bf16_f32 v244, v200, v201
v_cvt_pk_bf16_f32 v245, v202, v203
v_cvt_pk_bf16_f32 v246, v204, v205
s_waitcnt lgkmcnt(0)
v_mfma_f32_32x32x16_bf16 v[112:127], a[160:163], a[68:71], v[112:127]
v_cvt_pk_bf16_f32 v247, v206, v207
buffer_store_dwordx4 v[244:247], v26, s[72:75], s95 offen offset:3072 sc1
s_nop 9
v_cvt_pk_bf16_f32 v248, v112, v113
v_cvt_pk_bf16_f32 v249, v114, v115
v_cvt_pk_bf16_f32 v250, v116, v117
v_cvt_pk_bf16_f32 v251, v118, v119
s_add_u32 s95, s33, 16384
buffer_store_dwordx4 v[248:251], v26, s[72:75], s95 offen offset:0 sc1
v_cvt_pk_bf16_f32 v128, v120, v121
v_cvt_pk_bf16_f32 v129, v122, v123
v_cvt_pk_bf16_f32 v130, v124, v125
v_cvt_pk_bf16_f32 v131, v126, v127
buffer_store_dwordx4 v[128:131], v26, s[72:75], s95 offen offset:1024 sc1
L_slot32:
s_movk_i32 s100, 24576
buffer_load_dword v39, v28, s[72:75], s100 offen sc1
s_waitcnt vmcnt(1)
s_barrier
s_add_u32 s100, s12, 26624
buffer_store_dword a255, v253, s[72:75], s100 offen sc1
s_waitcnt vmcnt(1)
v_cmp_ne_u32 vcc, s6, v39
s_cbranch_vccz L_ok_20
s_movk_i32 s100, 24576
s_mov_b32 s96, 0
L_spin_21:
buffer_load_dword v39, v28, s[72:75], s100 offen sc1
s_waitcnt vmcnt(0)
v_cmp_ne_u32 vcc, s6, v39
s_cbranch_vccz L_spun_22
s_add_u32 s96, s96, 1
s_cmp_lt_u32 s96, 262144
s_sleep 1
s_cbranch_scc1 L_spin_21
v_mov_b32 v39, 106
buffer_store_dword v39, v253, s[80:83], 0 offen
s_waitcnt vmcnt(0)
L_spun_22:
s_nop 0
L_ok_20:
s_lshl_b32 s100, s97, 10
s_add_u32 s100, s100, s76
buffer_load_dwordx4 a[200:203], v145, s[72:75], s100 offen sc1
s_add_u32 s100, s100, 294912
buffer_load_dwordx4 a[204:207], v145, s[72:75], s100 offen sc1
s_add_u32 s100, s100, 294912
buffer_load_dwordx4 a[208:211], v145, s[72:75], s100 offen sc1
s_add_u32 s100, s100, 294912
buffer_load_dwordx4 a[212:215], v145, s[72:75], s100 offen sc1
s_lshl_b32 s100, s98, 10
s_add_u32 s100, s100, s76
buffer_load_dwordx4 a[216:219], v145, s[72:75], s100 offen sc1
s_add_u32 s100, s100, 294912
buffer_load_dwordx4 a[220:223], v145, s[72:75], s100 offen sc1
s_add_u32 s100, s100, 294912
buffer_load_dwordx4 a[224:227], v145, s[72:75], s100 offen sc1
s_add_u32 s100, s100, 294912
buffer_load_dwordx4 a[228:231], v145, s[72:75], s100 offen sc1
s_lshl_b32 s100, s99, 10
s_add_u32 s100, s100, s76
buffer_load_dwordx4 a[232:235], v145, s[72:75], s100 offen sc1
s_add_u32 s100, s100, 294912
buffer_load_dwordx4 a[236:239], v145, s[72:75], s100 offen sc1
s_add_u32 s100, s100, 294912
buffer_load_dwordx4 a[240:243], v145, s[72:75], s100 offen sc1
s_add_u32 s100, s100, 294912
buffer_load_dwordx4 a[244:247], v145, s[72:75], s100 offen sc1
s_waitcnt vmcnt(11)
v_mfma_f32_16x16x32_bf16 v[208:211], v[220:223], a[200:203], 0
s_waitcnt vmcnt(7)
v_mfma_f32_16x16x32_bf16 v[212:215], v[220:223], a[216:219], 0
s_waitcnt vmcnt(3)
v_mfma_f32_16x16x32_bf16 v[216:219], v[220:223], a[232:235], 0
s_movk_i32 s100, 26624
buffer_load_dword v39, v28, s[72:75], s100 offen sc1
v_mfma_f32_16x16x32_bf16 v[208:211], v[220:223], a[204:207], v[208:211]
v_mfma_f32_16x16x32_bf16 v[212:215], v[220:223], a[220:223], v[212:215]
s_waitcnt vmcnt(3)
v_mfma_f32_16x16x32_bf16 v[216:219], v[220:223], a[236:239], v[216:219]
v_mfma_f32_16x16x32_bf16 v[208:211], v[220:223], a[208:211], v[208:211]
v_mfma_f32_16x16x32_bf16 v[212:215], v[220:223], a[224:227], v[212:215]
s_waitcnt vmcnt(2)
v_mfma_f32_16x16x32_bf16 v[216:219], v[220:223], a[240:243], v[216:219]
v_mfma_f32_16x16x32_bf16 v[208:211], v[220:223], a[212:215], v[208:211]
v_mfma_f32_16x16x32_bf16 v[212:215], v[220:223], a[228:231], v[212:215]
s_waitcnt vmcnt(1)
v_mfma_f32_16x16x32_bf16 v[216:219], v[220:223], a[244:247], v[216:219]
v_lshlrev_b32 v224, 16, v152
v_and_b32 v225, 0xffff0000, v152
v_lshlrev_b32 v226, 16, v153
v_and_b32 v227, 0xffff0000, v153
s_nop 0
v_fma_f32 v224, v224, v144, v208
v_fma_f32 v225, v225, v144, v209
v_fma_f32 v226, v226, v144, v210
v_fma_f32 v227, v227, v144, v211
v_cvt_pk_bf16_f32 v228, v224, v225
v_cvt_pk_bf16_f32 v229, v226, v227
s_lshl_b32 s96, s88, 5
buffer_store_dwordx2 v[228:229], v148, s[68:71], s96 offen
v_lshlrev_b32 v224, 16, v154
v_and_b32 v225, 0xffff0000, v154
v_lshlrev_b32 v226, 16, v155
v_and_b32 v227, 0xffff0000, v155
v_fma_f32 v224, v224, v144, v212
v_fma_f32 v225, v225, v144, v213
v_fma_f32 v226, v226, v144, v214
v_fma_f32 v227, v227, v144, v215
v_cvt_pk_bf16_f32 v230, v224, v225
v_cvt_pk_bf16_f32 v231, v226, v227
s_lshl_b32 s96, s89, 5
buffer_store_dwordx2 v[230:231], v148, s[68:71], s96 offen
v_lshlrev_b32 v224, 16, v156
v_and_b32 v225, 0xffff0000, v156
v_lshlrev_b32 v226, 16, v157
v_and_b32 v227, 0xffff0000, v157
v_fma_f32 v224, v224, v144, v216
v_fma_f32 v225, v225, v144, v217
v_fma_f32 v226, v226, v144, v218
v_fma_f32 v227, v227, v144, v219
v_cvt_pk_bf16_f32 v228, v224, v225
v_cvt_pk_bf16_f32 v229, v226, v227
s_lshl_b32 s96, s90, 5
buffer_store_dwordx2 v[228:229], v148, s[68:71], s96 offen
s_waitcnt vmcnt(3)
v_cmp_ne_u32 vcc, s6, v39
s_cbranch_vccz L_ok_23
s_movk_i32 s100, 26624
s_mov_b32 s96, 0
L_spin_24:
buffer_load_dword v39, v28, s[72:75], s100 offen sc1
s_waitcnt vmcnt(0)
v_cmp_ne_u32 vcc, s6, v39
s_cbranch_vccz L_spun_25
s_add_u32 s96, s96, 1
s_cmp_lt_u32 s96, 262144
s_sleep 1
s_cbranch_scc1 L_spin_24
v_mov_b32 v39, 107
buffer_store_dword v39, v253, s[80:83], 0 offen
s_waitcnt vmcnt(0)
L_spun_25:
s_nop 0
L_ok_23:
s_lshl_b32 s100, s7, 10
s_add_u32 s100, s100, s76
buffer_load_dwordx4 a[0:3], v145, s[72:75], s100 offen sc1
s_add_u32 s100, s100, 294912
buffer_load_dwordx4 a[4:7], v145, s[72:75], s100 offen sc1
s_add_u32 s100, s100, 294912
buffer_load_dwordx4 a[8:11], v145, s[72:75], s100 offen sc1
s_add_u32 s100, s100, 294912
buffer_load_dwordx4 a[12:15], v145, s[72:75], s100 offen sc1
s_lshl_b32 s100, s8, 10
s_add_u32 s100, s100, s76
buffer_load_dwordx4 a[16:19], v145, s[72:75], s100 offen sc1
s_add_u32 s100, s100, 294912
buffer_load_dwordx4 a[20:23], v145, s[72:75], s100 offen sc1
s_add_u32 s100, s100, 294912
buffer_load_dwordx4 a[24:27], v145, s[72:75], s100 offen sc1
s_add_u32 s100, s100, 294912
buffer_load_dwordx4 a[28:31], v145, s[72:75], s100 offen sc1
s_cmp_eq_u32 s5, 0
s_cselect_b32 s11, 0, 1073741824
buffer_store_dword a255, v253, s[72:75], s11 offen sc1
s_waitcnt vmcnt(8)
v_mfma_f32_16x16x32_bf16 v[208:211], v[220:223], a[0:3], 0
s_waitcnt vmcnt(4)
v_mfma_f32_16x16x32_bf16 v[212:215], v[220:223], a[16:19], 0
v_mfma_f32_16x16x32_bf16 v[208:211], v[220:223], a[4:7], v[208:211]
s_waitcnt vmcnt(3)
v_mfma_f32_16x16x32_bf16 v[212:215], v[220:223], a[20:23], v[212:215]
v_mfma_f32_16x16x32_bf16 v[208:211], v[220:223], a[8:11], v[208:211]
s_waitcnt vmcnt(2)
v_mfma_f32_16x16x32_bf16 v[212:215], v[220:223], a[24:27], v[212:215]
v_mfma_f32_16x16x32_bf16 v[208:211], v[220:223], a[12:15], v[208:211]
s_waitcnt vmcnt(1)
v_mfma_f32_16x16x32_bf16 v[212:215], v[220:223], a[28:31], v[212:215]
v_lshlrev_b32 v224, 16, v158
v_and_b32 v225, 0xffff0000, v158
v_lshlrev_b32 v226, 16, v159
v_and_b32 v227, 0xffff0000, v159
s_nop 1
v_fma_f32 v224, v224, v144, v208
v_fma_f32 v225, v225, v144, v209
v_fma_f32 v226, v226, v144, v210
v_fma_f32 v227, v227, v144, v211
v_cvt_pk_bf16_f32 v228, v224, v225
v_cvt_pk_bf16_f32 v229, v226, v227
s_lshl_b32 s96, s9, 5
buffer_store_dwordx2 v[228:229], v148, s[68:71], s96 offen
v_lshlrev_b32 v224, 16, v160
v_and_b32 v225, 0xffff0000, v160
v_lshlrev_b32 v226, 16, v161
v_and_b32 v227, 0xffff0000, v161
v_fma_f32 v224, v224, v144, v212
v_fma_f32 v225, v225, v144, v213
v_fma_f32 v226, v226, v144, v214
v_fma_f32 v227, v227, v144, v215
v_cvt_pk_bf16_f32 v230, v224, v225
v_cvt_pk_bf16_f32 v231, v226, v227
s_lshl_b32 s96, s10, 5
buffer_store_dwordx2 v[230:231], v148, s[68:71], s96 offen
s_waitcnt vmcnt(0)
L_end:
s_endpgm
.section .rodata,"a"
.p2align 6
.amdhsa_kernel gated_mix__sliding_local_dilated__mixer_s_mlp__prompt_kernel
  .amdhsa_next_free_vgpr 512
  .amdhsa_next_free_sgpr 102
  .amdhsa_accum_offset 256
  .amdhsa_group_segment_fixed_size 0
  .amdhsa_kernarg_size 96
  .amdhsa_user_sgpr_count 2
  .amdhsa_user_sgpr_kernarg_segment_ptr 1
  .amdhsa_system_sgpr_workgroup_id_x 1
  .amdhsa_float_denorm_mode_32 3
.end_amdhsa_kernel
```
